```python
import torch

def _softmax(x, axis=-1):
    return torch.softmax(x, dim=axis)

def _gelu(x):
    return torch.nn.functional.gelu(x, approximate='tanh')

def _silu(x):
    return torch.nn.functional.silu(x)

def _sigmoid(x):
    return torch.sigmoid(x)

def _layernorm(x, axis=-1, eps=1e-05):
    m = x.mean(dim=axis, keepdim=True)
    v = x.var(dim=axis, keepdim=True, unbiased=False)
    return (x - m) / torch.sqrt(v + eps)

def _scatter_add(tgt, idx, src, axis=0):
    return tgt.clone().index_add_(axis, idx, src)

def _segment_sum(src, seg, n):
    out = torch.zeros((n,) + src.shape[1:], dtype=src.dtype)
    return out.index_add_(0, seg, src)

def _pad(x, pw):
    flat = tuple((v for pair in reversed(pw) for v in pair))
    return torch.nn.functional.pad(x, flat)
kernel_name = 'gated_mix__memory_aug_recurrent_mem_tr__swiglu_ffn__prompt'

def setup_inputs():

    _w = lambda a: (lambda t: t.to(torch.bfloat16) if t.is_floating_point() else t)(torch.as_tensor(a))

    def _A_setup():
        B, S, Dm = (1, 2048, 512)
        H, Dh = (32, 128)
        M, seg = (8, 32)
        seg = min(seg, S)
        S = S // seg * seg
        return {'x': _w((lambda *s: torch.randn(*s, dtype=torch.bfloat16) * 0.05)(B, S, Dm)), 'mem0': _w((lambda *s: torch.randn(*s, dtype=torch.bfloat16) * 0.4)(B, M, Dm)), 'Wq': _w((lambda *s: torch.randn(*s, dtype=torch.bfloat16) * 6.4)(Dm, H, Dh) * Dm ** (-0.5)), 'Wk': _w((lambda *s: torch.randn(*s, dtype=torch.bfloat16) * 6.4)(Dm, H, Dh) * Dm ** (-0.5)), 'Wv': _w((lambda *s: torch.randn(*s, dtype=torch.bfloat16) * 0.4)(Dm, H, Dh) * Dm ** (-0.5)), 'Wo': _w((lambda *s: torch.randn(*s, dtype=torch.bfloat16) * 0.4)(H, Dh, Dm) * (H * Dh) ** (-0.5)), 'seg_len': seg}
    _A_in = _A_setup()

    def _B_setup():
        B, S, D, F = (1, 2048, 512, 1376)
        return {'x': _w((lambda *s: torch.randn(*s, dtype=torch.bfloat16) * 0.05)(B, S, D)), 'w_gate': _w((lambda *s: torch.randn(*s, dtype=torch.bfloat16) * 0.05)(D, F)), 'w_up': _w((lambda *s: torch.randn(*s, dtype=torch.bfloat16) * 0.05)(D, F)), 'w_down': _w((lambda *s: torch.randn(*s, dtype=torch.bfloat16) * 0.05)(F, D))}
    _B_in = _B_setup()
    return {'A_x': _A_in['x'], 'A_mem0': _A_in['mem0'], 'A_Wq': _A_in['Wq'], 'A_Wk': _A_in['Wk'], 'A_Wv': _A_in['Wv'], 'A_Wo': _A_in['Wo'], 'A_seg_len': _A_in['seg_len'], 'B_x': _B_in['x'], 'B_w_gate': _B_in['w_gate'], 'B_w_up': _B_in['w_up'], 'B_w_down': _B_in['w_down'], 'gate_w': _w((lambda *s: torch.randn(*s, dtype=torch.bfloat16) * 0.05)(512) * 16.0)}

def reference(A_x, A_mem0, A_Wq, A_Wk, A_Wv, A_Wo, A_seg_len, B_x, B_w_gate, B_w_up, B_w_down, gate_w):

    def _A_ref(x, mem0, Wq, Wk, Wv, Wo, seg_len):
        B, S, Dm = x.shape
        H, Dh = (Wq.shape[1], Wq.shape[2])
        M = mem0.shape[1]
        scale = Dh ** (-0.5)
        n_seg = S // seg_len
        L = M + seg_len
        idx = torch.arange(L)
        mask = (idx[:, None] < M) | (idx[:, None] >= idx[None, :])
        mem = mem0
        outs = []
        for s in range(n_seg):
            xs = x[:, s * seg_len:(s + 1) * seg_len, :].clone()
            h = torch.concatenate([mem, xs], axis=1)
            q = torch.einsum('btd,dhe->bhte', h, Wq)
            k = torch.einsum('btd,dhe->bhte', h, Wk)
            v = torch.einsum('btd,dhe->bhte', h, Wv)
            scores = torch.einsum('bhqe,bhke->bhqk', q, k) * scale
            scores = torch.where(mask[None, None], scores, -1000000000.0)
            p = _softmax(scores, axis=-1)
            o = torch.einsum('bhqk,bhke->bhqe', p, v)
            o = torch.einsum('bhte,hed->btd', o, Wo)
            mem = o[:, :M, :].clone()
            outs.append(o[:, M:, :])
        return torch.concatenate(outs, axis=1)

    def _B_ref(x, w_gate, w_up, w_down):
        g = _silu(x @ w_gate)
        u = x @ w_up
        return g * u @ w_down
    x = A_x
    g = _sigmoid((x * gate_w).sum(-1, keepdims=True))
    a = _A_ref(x, A_mem0, A_Wq, A_Wk, A_Wv, A_Wo, A_seg_len)
    b = _B_ref(x, B_w_gate, B_w_up, B_w_down)
    return g * a + (1 - g) * b
```

```asm
; @launch grid=(256,1,1) block=(256,1,1) lds=163840
.amdgcn_target "amdgcn-amd-amdhsa--gfx950"
.text
.globl gated_mix__memory_aug_recurrent_mem_tr__swiglu_ffn__prompt_kernel
.p2align 8
.type gated_mix__memory_aug_recurrent_mem_tr__swiglu_ffn__prompt_kernel,@function
gated_mix__memory_aug_recurrent_mem_tr__swiglu_ffn__prompt_kernel:
    s_cmp_ge_u32 s2, 256
    s_cbranch_scc1 L_end
    s_load_dwordx2 s[4:5], s[0:1], 112
    s_load_dwordx2 s[8:9], s[0:1], 104
    s_load_dwordx2 s[12:13], s[0:1], 0
    s_load_dwordx2 s[32:33], s[0:1], 8
    s_load_dwordx2 s[16:17], s[0:1], 16
    s_load_dwordx2 s[20:21], s[0:1], 24
    s_load_dwordx2 s[24:25], s[0:1], 32
    s_load_dwordx2 s[28:29], s[0:1], 40
    s_load_dwordx2 s[36:37], s[0:1], 64
    s_load_dwordx2 s[40:41], s[0:1], 72
    s_load_dwordx2 s[44:45], s[0:1], 80
    s_load_dwordx2 s[48:49], s[0:1], 88
    s_load_dwordx2 s[52:53], s[0:1], 96
    s_getreg_b32 s56, hwreg(HW_REG_XCC_ID)
    s_xor_b32 s56, s56, 3
    s_and_b32 s56, s56, 7
    s_lshl_b32 s56, s56, 2
    s_lshr_b32 s56, 0x65432170, s56
    s_and_b32 s56, s56, 7
    v_lshrrev_b32 v1, 6, v0
    s_nop 0
    v_readfirstlane_b32 s3, v1
    s_mov_b32 s6, 268435456
    s_mov_b32 s7, 0x20000
    s_mov_b32 s10, 256
    s_mov_b32 s11, 0x20000
    s_mov_b32 s14, 2097152
    s_mov_b32 s15, 0x20000
    s_mov_b32 s34, 8192
    s_mov_b32 s35, 0x20000
    s_mov_b32 s18, 4194304
    s_mov_b32 s19, 0x20000
    s_mov_b32 s22, 4194304
    s_mov_b32 s23, 0x20000
    s_mov_b32 s26, 4194304
    s_mov_b32 s27, 0x20000
    s_mov_b32 s30, 4194304
    s_mov_b32 s31, 0x20000
    s_mov_b32 s38, 1409024
    s_mov_b32 s39, 0x20000
    s_mov_b32 s42, 1409024
    s_mov_b32 s43, 0x20000
    s_mov_b32 s46, 1409024
    s_mov_b32 s47, 0x20000
    s_mov_b32 s50, 1024
    s_mov_b32 s51, 0x20000
    s_mov_b32 s54, 2097152
    s_mov_b32 s55, 0x20000
    s_waitcnt lgkmcnt(0)
    s_cmp_lg_u32 s3, 0
    s_cbranch_scc1 L_noticket
    s_lshl_b32 s60, s56, 2
    s_cmp_eq_u32 s56, 0
    s_cselect_b32 s60, 192, s60
    v_mov_b32 v4, 1
    s_mov_b64 exec, 1
    buffer_atomic_add v4, off, s[8:11], s60 sc0
    s_mov_b64 exec, -1
L_noticket:
    s_cmp_lg_u32 s2, 0
    s_cbranch_scc1 L_nozero
    v_lshlrev_b32 v2, 4, v0
    v_mov_b32 v8, 0
    v_mov_b32 v9, 0
    v_mov_b32 v10, 0
    v_mov_b32 v11, 0
    s_mov_b32 s60, 262144
    s_mov_b32 s61, 266240
    s_mov_b32 s62, 270336
    s_mov_b32 s63, 274432
    buffer_store_dwordx4 v[8:11], v2, s[4:7], s60 offen sc1
    buffer_store_dwordx4 v[8:11], v2, s[4:7], s61 offen sc1
    buffer_store_dwordx4 v[8:11], v2, s[4:7], s62 offen sc1
    buffer_store_dwordx4 v[8:11], v2, s[4:7], s63 offen sc1
    s_waitcnt vmcnt(0)
L_nozero:
    s_waitcnt vmcnt(0)
    s_cmp_lg_u32 s56, 0
    s_cbranch_scc1 L_tw
    s_waitcnt vmcnt(0)
L_tw:
    s_cmp_lg_u32 s3, 0
    s_cbranch_scc1 L_noticket2
    v_mov_b32 v5, 0
    s_mov_b64 exec, 1
    ds_write_b32 v5, v4
    s_mov_b64 exec, -1
    s_waitcnt lgkmcnt(0)
L_noticket2:
    s_barrier
    v_mov_b32 v5, 0
    ds_read_b32 v4, v5
    s_cmp_lg_u32 s2, 0
    s_cbranch_scc1 L_nozero2
    v_mov_b32 v6, 1
    s_mov_b64 exec, 1
    buffer_store_dword v6, off, s[8:11], 0 offset:200 sc1
    s_mov_b64 exec, -1
L_nozero2:
    s_waitcnt lgkmcnt(0)
    v_readfirstlane_b32 s57, v4
    s_mov_b32 s58, s56
    s_barrier
    v_and_b32 v0, 63, v0
    s_cmp_lt_u32 s57, 32
    s_cbranch_scc0 L_overflow
L_role:
    s_cmp_eq_u32 s58, 0
    s_cbranch_scc1 L_chain
    s_cmp_eq_u32 s58, 7
    s_cbranch_scc1 L_frole
    s_cmp_ge_u32 s58, 5
    s_cbranch_scc1 L_arole
    s_cmp_lt_u32 s57, 16
    s_cbranch_scc1 L_arole
    s_branch L_frole2
L_overflow:
    s_mov_b32 s59, 1000000
    v_lshlrev_b32 v2, 2, v0
L_ovf_wait:
    buffer_load_dword v3, v2, s[8:11], 0 offen sc1
    s_sub_u32 s59, s59, 1
    s_cbranch_scc1 L_fail
    s_waitcnt vmcnt(0)
    s_mov_b32 s60, 0
    v_readlane_b32 s62, v3, 48
    s_nop 0
    s_add_u32 s60, s60, s62
    v_readlane_b32 s63, v3, 1
    s_nop 0
    s_add_u32 s60, s60, s63
    v_readlane_b32 s64, v3, 2
    s_nop 0
    s_add_u32 s60, s60, s64
    v_readlane_b32 s65, v3, 3
    s_nop 0
    s_add_u32 s60, s60, s65
    v_readlane_b32 s66, v3, 4
    s_nop 0
    s_add_u32 s60, s60, s66
    v_readlane_b32 s67, v3, 5
    s_nop 0
    s_add_u32 s60, s60, s67
    v_readlane_b32 s68, v3, 6
    s_nop 0
    s_add_u32 s60, s60, s68
    v_readlane_b32 s69, v3, 7
    s_nop 0
    s_add_u32 s60, s60, s69
    s_cmp_lt_u32 s60, 256
    s_cbranch_scc1 L_ovf_wait
    s_cmp_lg_u32 s3, 0
    s_cbranch_scc1 L_ovf_t
    v_mov_b32 v4, 1
    v_mov_b32 v5, 0
    s_mov_b64 exec, 1
    buffer_atomic_add v4, off, s[8:11], 0 offset:32 sc0
    s_waitcnt vmcnt(0)
    ds_write_b32 v5, v4
    s_mov_b64 exec, -1
    s_waitcnt lgkmcnt(0)
L_ovf_t:
    s_barrier
    v_mov_b32 v5, 0
    ds_read_b32 v4, v5
    s_waitcnt lgkmcnt(0)
    v_readfirstlane_b32 s61, v4
    s_barrier
    s_min_u32 s70, s62, 32
    s_sub_u32 s71, 32, s70
    s_mov_b32 s58, 0
    s_add_u32 s57, s70, s61
    s_cmp_lt_u32 s61, s71
    s_cbranch_scc1 L_role
    s_sub_u32 s61, s61, s71
    s_min_u32 s70, s63, 32
    s_sub_u32 s71, 32, s70
    s_mov_b32 s58, 1
    s_add_u32 s57, s70, s61
    s_cmp_lt_u32 s61, s71
    s_cbranch_scc1 L_role
    s_sub_u32 s61, s61, s71
    s_min_u32 s70, s64, 32
    s_sub_u32 s71, 32, s70
    s_mov_b32 s58, 2
    s_add_u32 s57, s70, s61
    s_cmp_lt_u32 s61, s71
    s_cbranch_scc1 L_role
    s_sub_u32 s61, s61, s71
    s_min_u32 s70, s65, 32
    s_sub_u32 s71, 32, s70
    s_mov_b32 s58, 3
    s_add_u32 s57, s70, s61
    s_cmp_lt_u32 s61, s71
    s_cbranch_scc1 L_role
    s_sub_u32 s61, s61, s71
    s_min_u32 s70, s66, 32
    s_sub_u32 s71, 32, s70
    s_mov_b32 s58, 4
    s_add_u32 s57, s70, s61
    s_cmp_lt_u32 s61, s71
    s_cbranch_scc1 L_role
    s_sub_u32 s61, s61, s71
    s_min_u32 s70, s67, 32
    s_sub_u32 s71, 32, s70
    s_mov_b32 s58, 5
    s_add_u32 s57, s70, s61
    s_cmp_lt_u32 s61, s71
    s_cbranch_scc1 L_role
    s_sub_u32 s61, s61, s71
    s_min_u32 s70, s68, 32
    s_sub_u32 s71, 32, s70
    s_mov_b32 s58, 6
    s_add_u32 s57, s70, s61
    s_cmp_lt_u32 s61, s71
    s_cbranch_scc1 L_role
    s_sub_u32 s61, s61, s71
    s_min_u32 s70, s69, 32
    s_sub_u32 s71, 32, s70
    s_mov_b32 s58, 7
    s_add_u32 s57, s70, s61
    s_cmp_lt_u32 s61, s71
    s_cbranch_scc1 L_role
    s_sub_u32 s61, s61, s71
    s_branch L_end
L_fail:
    s_waitcnt vmcnt(0) lgkmcnt(0)
    s_mov_b64 exec, -1
    s_lshl_b32 s60, s58, 8
    s_add_u32 s60, s60, s57
    s_add_u32 s60, s60, 0x10000
    v_mov_b32 v4, s60
    s_mov_b64 exec, 1
    buffer_store_dword v4, off, s[8:11], 0 offset:60 sc1
L_end:
    s_endpgm
L_chain:
    s_mov_b32 s60, s57
    v_and_b32 v20, 15, v0
    v_lshrrev_b32 v21, 4, v0
    v_and_b32 v22, 3, v0
    v_bfe_u32 v23, v0, 2, 2
    s_lshl_b32 s75, s60, 13
    s_lshl_b32 s76, s3, 11
    v_lshrrev_b32 v24, 5, v0
    v_lshlrev_b32 v24, 3, v24
    s_lshl_b32 s73, s3, 1
    v_add_u32 v24, s73, v24
    v_xor_b32 v24, v24, v20
    s_lshl_b32 s73, s3, 4
    v_add_u32 v25, s73, v21
    v_lshlrev_b32 v27, 10, v25
    v_lshrrev_b32 v28, 3, v24
    v_lshl_add_u32 v27, v28, 8, v27
    v_and_b32 v28, 7, v24
    v_lshl_add_u32 v27, v28, 4, v27
    s_lshl_b32 s73, s60, 17
    v_add_u32 v27, s73, v27
    s_and_b32 s69, s3, 1
    s_lshr_b32 s73, s3, 1
    s_lshl_b32 s73, s73, 7
    s_lshl_b32 s74, s69, 4
    s_add_u32 s73, s73, s74
    v_add_u32 v25, s73, v21
    v_and_b32 v24, 1, v21
    v_lshlrev_b32 v24, 1, v24
    s_lshl_b32 s74, s69, 2
    v_add_u32 v24, s74, v24
    v_xor_b32 v24, v24, v20
    v_lshlrev_b32 v26, 13, v25
    v_lshl_add_u32 v26, v24, 4, v26
    s_lshl_b32 s73, s60, 8
    v_add_u32 v26, s73, v26
    v_xor_b32 v34, 128, v26
    s_lshl_b32 s74, s3, 12
    v_lshrrev_b32 v28, 1, v21
    s_bfe_u32 s73, s60, 0x20001
    s_lshl_b32 s73, s73, 1
    v_add_u32 v28, s73, v28
    v_lshlrev_b32 v28, 10, v28
    v_and_b32 v29, 1, v21
    v_lshl_add_u32 v28, v29, 1, v28
    v_lshl_add_u32 v28, v22, 2, v28
    s_lshr_b32 s73, s60, 3
    s_lshl_b32 s73, s73, 8
    s_lshl_b32 s69, s3, 6
    s_add_u32 s73, s73, s69
    s_and_b32 s69, s60, 1
    s_lshl_b32 s69, s69, 4
    s_add_u32 s73, s73, s69
    buffer_load_ushort v30, v28, s[32:35], s73 offen
    buffer_load_ushort v31, v28, s[32:35], s73 offen offset:32
    s_add_u32 m0, s74, 32768
    s_mov_b32 s73, 0
    buffer_load_dwordx4 v27, s[28:31], s73 offen lds
    s_add_u32 m0, s74, 33792
    s_mov_b32 s73, 4096
    buffer_load_dwordx4 v27, s[28:31], s73 offen lds
    s_add_u32 m0, s74, 34816
    s_mov_b32 s73, 8192
    buffer_load_dwordx4 v27, s[28:31], s73 offen lds
    s_add_u32 m0, s74, 35840
    s_mov_b32 s73, 12288
    buffer_load_dwordx4 v27, s[28:31], s73 offen lds
    s_add_u32 m0, s74, 49152
    s_mov_b32 s73, 512
    buffer_load_dwordx4 v27, s[28:31], s73 offen lds
    s_add_u32 m0, s74, 50176
    s_mov_b32 s73, 4608
    buffer_load_dwordx4 v27, s[28:31], s73 offen lds
    s_add_u32 m0, s74, 51200
    s_mov_b32 s73, 8704
    buffer_load_dwordx4 v27, s[28:31], s73 offen lds
    s_add_u32 m0, s74, 52224
    s_mov_b32 s73, 12800
    buffer_load_dwordx4 v27, s[28:31], s73 offen lds
    s_add_u32 m0, s74, 65536
    s_mov_b32 s73, 65536
    buffer_load_dwordx4 v27, s[28:31], s73 offen lds
    s_add_u32 m0, s74, 66560
    s_mov_b32 s73, 69632
    buffer_load_dwordx4 v27, s[28:31], s73 offen lds
    s_add_u32 m0, s74, 67584
    s_mov_b32 s73, 73728
    buffer_load_dwordx4 v27, s[28:31], s73 offen lds
    s_add_u32 m0, s74, 68608
    s_mov_b32 s73, 77824
    buffer_load_dwordx4 v27, s[28:31], s73 offen lds
    s_add_u32 m0, s74, 81920
    s_mov_b32 s73, 66048
    buffer_load_dwordx4 v27, s[28:31], s73 offen lds
    s_add_u32 m0, s74, 82944
    s_mov_b32 s73, 70144
    buffer_load_dwordx4 v27, s[28:31], s73 offen lds
    s_add_u32 m0, s74, 83968
    s_mov_b32 s73, 74240
    buffer_load_dwordx4 v27, s[28:31], s73 offen lds
    s_add_u32 m0, s74, 84992
    s_mov_b32 s73, 78336
    buffer_load_dwordx4 v27, s[28:31], s73 offen lds
    v_and_b32 v28, 1, v0
    v_mov_b32 v1, 0x4444
    v_mov_b32 v29, 0xeeee
    v_cmp_eq_u32 vcc, 1, v28
    s_nop 1
    v_cndmask_b32 v1, v1, v29, vcc
    v_lshrrev_b32 v28, 3, v0
    v_lshlrev_b32 v2, 13, v28
    v_and_b32 v28, 7, v20
    v_lshl_add_u32 v2, v28, 3, v2
    s_lshl_b32 s73, s3, 16
    s_lshl_b32 s69, s60, 6
    s_add_u32 s73, s73, s69
    v_add_u32 v2, s73, v2
    v_lshlrev_b32 v3, 4, v21
    v_lshl_add_u32 v3, v22, 2, v3
    s_lshr_b32 s73, s60, 3
    s_lshl_b32 s73, s73, 9
    s_add_u32 s73, s73, s76
    s_and_b32 s69, s60, 1
    s_lshl_b32 s69, s69, 8
    s_add_u32 s73, s73, s69
    s_bfe_u32 s69, s60, 0x20001
    s_lshl_b32 s69, s69, 6
    s_add_u32 s73, s73, s69
    v_add_u32 v3, s73, v3
    v_mov_b32 v29, 0x7fffff00
    v_cmp_le_u32 vcc, 12, v20
    s_nop 1
    v_cndmask_b32 v3, v29, v3, vcc
    v_and_b32 v28, 1, v23
    v_lshlrev_b32 v28, 6, v28
    v_lshlrev_b32 v29, 5, v21
    v_xor_b32 v28, v28, v29
    v_lshl_add_u32 v4, v23, 7, v28
    v_lshl_add_u32 v4, v22, 2, v4
    s_lshl_b32 s73, s3, 9
    s_add_u32 s73, s73, 40960
    v_add_u32 v4, s73, v4
    v_and_b32 v28, 1, v21
    v_lshlrev_b32 v28, 2, v28
    v_and_b32 v29, 7, v20
    v_xor_b32 v29, v29, v28
    v_lshlrev_b32 v29, 4, v29
    v_lshl_add_u32 v5, v21, 7, v29
    v_add_u32 v5, 40960, v5
    v_lshrrev_b32 v28, 1, v23
    v_lshlrev_b32 v6, 8, v28
    v_lshl_add_u32 v6, v21, 6, v6
    v_and_b32 v28, 1, v22
    v_lshl_add_u32 v6, v28, 4, v6
    v_and_b32 v28, 1, v23
    v_lshl_add_u32 v6, v28, 3, v6
    v_lshrrev_b32 v28, 1, v22
    v_lshl_add_u32 v6, v28, 2, v6
    s_add_u32 s73, s73, 2048
    v_add_u32 v6, s73, v6
    v_lshlrev_b32 v7, 8, v21
    v_and_b32 v29, 7, v20
    v_lshl_add_u32 v7, v29, 4, v7
    s_lshr_b32 s73, s3, 1
    s_lshl_b32 s73, s73, 10
    s_and_b32 s69, s3, 1
    s_lshl_b32 s69, s69, 7
    s_add_u32 s73, s73, s69
    s_add_u32 s73, s73, 45568
    v_add_u32 v7, s73, v7
    v_lshlrev_b32 v13, 8, v21
    v_and_b32 v29, 1, v20
    v_lshl_add_u32 v13, v29, 7, v13
    v_lshrrev_b32 v29, 1, v20
    v_lshl_add_u32 v13, v29, 4, v13
    v_lshlrev_b32 v28, 12, v23
    v_lshl_add_u32 v28, v21, 9, v28
    v_and_b32 v29, 1, v22
    v_lshl_add_u32 v28, v29, 3, v28
    v_and_b32 v29, 1, v21
    v_lshlrev_b32 v29, 3, v29
    v_lshl_add_u32 v29, v23, 1, v29
    v_lshrrev_b32 v32, 1, v22
    s_and_b32 s73, s3, 1
    s_lshl_b32 s73, s73, 3
    v_add_u32 v33, s73, v32
    v_xor_b32 v33, v33, v29
    v_lshl_add_u32 v9, v33, 4, v28
    s_lshr_b32 s73, s3, 1
    s_lshl_b32 s73, s73, 14
    s_add_u32 s73, s73, 32768
    v_add_u32 v9, s73, v9
    v_and_b32 v28, 1, v23
    v_lshrrev_b32 v29, 1, v23
    v_lshl_add_u32 v33, v28, 4, v29
    v_lshl_add_u32 v33, v21, 2, v33
    v_lshlrev_b32 v33, 8, v33
    v_lshl_add_u32 v29, v28, 1, v29
    v_and_b32 v28, 1, v21
    v_lshl_add_u32 v29, v28, 2, v29
    v_lshlrev_b32 v29, 1, v29
    s_lshl_b32 s73, s3, 2
    v_add_u32 v28, s73, v32
    v_xor_b32 v28, v28, v29
    v_lshl_add_u32 v33, v28, 4, v33
    v_and_b32 v28, 1, v22
    v_lshl_add_u32 v8, v28, 3, v33
    s_lshl_b32 s73, s3, 14
    v_add_u32 v8, s73, v8
    v_mov_b32 v28, 0x3f80
    v_mov_b32 v29, 0x3f800000
    v_cmp_le_u32 vcc, 8, v20
    s_nop 1
    v_cndmask_b32 v28, v28, v29, vcc
    v_and_b32 v29, 7, v20
    v_mov_b32 v33, 0
    v_cmp_eq_u32 vcc, 0, v29
    s_nop 1
    v_cndmask_b32 v36, v33, v28, vcc
    v_cmp_eq_u32 vcc, 1, v29
    s_nop 1
    v_cndmask_b32 v37, v33, v28, vcc
    v_cmp_eq_u32 vcc, 4, v29
    s_nop 1
    v_cndmask_b32 v38, v33, v28, vcc
    v_cmp_eq_u32 vcc, 5, v29
    s_nop 1
    v_cndmask_b32 v39, v33, v28, vcc
    v_lshlrev_b32 v0, 4, v0
    v_add_u32 v10, s76, v0
    v_xor_b32 v11, 2048, v10
    v_xor_b32 v12, 4096, v10
    s_add_u32 m0, s74, 98304
    s_mov_b32 s73, 0
    buffer_load_dwordx4 v26, s[16:19], s73 offen lds
    s_add_u32 m0, s74, 99328
    s_mov_b32 s73, 32768
    buffer_load_dwordx4 v34, s[16:19], s73 offen lds
    s_add_u32 m0, s74, 100352
    s_mov_b32 s73, 65536
    buffer_load_dwordx4 v26, s[16:19], s73 offen lds
    s_add_u32 m0, s74, 101376
    s_mov_b32 s73, 98304
    buffer_load_dwordx4 v34, s[16:19], s73 offen lds
    s_add_u32 m0, s74, 114688
    s_mov_b32 s73, 262144
    buffer_load_dwordx4 v26, s[16:19], s73 offen lds
    s_add_u32 m0, s74, 115712
    s_mov_b32 s73, 294912
    buffer_load_dwordx4 v34, s[16:19], s73 offen lds
    s_add_u32 m0, s74, 116736
    s_mov_b32 s73, 327680
    buffer_load_dwordx4 v26, s[16:19], s73 offen lds
    s_add_u32 m0, s74, 117760
    s_mov_b32 s73, 360448
    buffer_load_dwordx4 v34, s[16:19], s73 offen lds
    s_add_u32 m0, s74, 131072
    s_mov_b32 s73, 524288
    buffer_load_dwordx4 v26, s[16:19], s73 offen lds
    s_add_u32 m0, s74, 132096
    s_mov_b32 s73, 557056
    buffer_load_dwordx4 v34, s[16:19], s73 offen lds
    s_add_u32 m0, s74, 133120
    s_mov_b32 s73, 589824
    buffer_load_dwordx4 v26, s[16:19], s73 offen lds
    s_add_u32 m0, s74, 134144
    s_mov_b32 s73, 622592
    buffer_load_dwordx4 v34, s[16:19], s73 offen lds
    s_add_u32 m0, s74, 147456
    s_mov_b32 s73, 786432
    buffer_load_dwordx4 v26, s[16:19], s73 offen lds
    s_add_u32 m0, s74, 148480
    s_mov_b32 s73, 819200
    buffer_load_dwordx4 v34, s[16:19], s73 offen lds
    s_add_u32 m0, s74, 149504
    s_mov_b32 s73, 851968
    buffer_load_dwordx4 v26, s[16:19], s73 offen lds
    s_add_u32 m0, s74, 150528
    s_mov_b32 s73, 884736
    buffer_load_dwordx4 v34, s[16:19], s73 offen lds
    v_mov_b32 v40, -1
    v_mov_b32 v41, -1
    v_mov_b32 v42, -1
    v_mov_b32 v43, -1
    s_lshl_b32 s69, s60, 13
    s_add_u32 s73, s69, 1048576
    buffer_store_dwordx4 v[40:43], v10, s[4:7], s73 offen sc1
    buffer_store_dwordx4 v[40:43], v10, s[4:7], s73 offen offset:1024 sc1
    s_add_u32 s73, s69, 1310720
    buffer_store_dwordx4 v[40:43], v10, s[4:7], s73 offen sc1
    buffer_store_dwordx4 v[40:43], v10, s[4:7], s73 offen offset:1024 sc1
    s_mov_b32 s73, 8192
    buffer_store_dword v40, v3, s[4:7], s73 offen sc1
    s_mov_b32 s73, 16384
    buffer_store_dword v40, v3, s[4:7], s73 offen sc1
    s_mov_b32 s73, 24576
    buffer_store_dword v40, v3, s[4:7], s73 offen sc1
    s_waitcnt vmcnt(39)
    v_lshl_or_b32 v14, v31, 16, v30
    v_min_u32 v14, -2, v14
    s_mov_b32 s73, 0
    buffer_store_dword v14, v3, s[4:7], s73 offen sc1
    s_waitcnt vmcnt(24)
    s_barrier
    v_xor_b32 v76, 0, v9
    ds_read_b64_tr_b16 v[176:177], v76 offset:0
    ds_read_b64_tr_b16 v[178:179], v76 offset:256
    ds_read_b64_tr_b16 v[180:181], v76 offset:2048
    ds_read_b64_tr_b16 v[182:183], v76 offset:2304
    ds_read_b64_tr_b16 v[184:185], v76 offset:32768
    ds_read_b64_tr_b16 v[186:187], v76 offset:33024
    ds_read_b64_tr_b16 v[188:189], v76 offset:34816
    ds_read_b64_tr_b16 v[190:191], v76 offset:35072
    v_xor_b32 v76, 32, v9
    ds_read_b64_tr_b16 v[192:193], v76 offset:0
    ds_read_b64_tr_b16 v[194:195], v76 offset:256
    ds_read_b64_tr_b16 v[196:197], v76 offset:2048
    ds_read_b64_tr_b16 v[198:199], v76 offset:2304
    ds_read_b64_tr_b16 v[200:201], v76 offset:32768
    ds_read_b64_tr_b16 v[202:203], v76 offset:33024
    ds_read_b64_tr_b16 v[204:205], v76 offset:34816
    ds_read_b64_tr_b16 v[206:207], v76 offset:35072
    v_xor_b32 v76, 64, v9
    ds_read_b64_tr_b16 v[208:209], v76 offset:0
    ds_read_b64_tr_b16 v[210:211], v76 offset:256
    ds_read_b64_tr_b16 v[212:213], v76 offset:2048
    ds_read_b64_tr_b16 v[214:215], v76 offset:2304
    ds_read_b64_tr_b16 v[216:217], v76 offset:32768
    ds_read_b64_tr_b16 v[218:219], v76 offset:33024
    ds_read_b64_tr_b16 v[220:221], v76 offset:34816
    ds_read_b64_tr_b16 v[222:223], v76 offset:35072
    v_xor_b32 v76, 96, v9
    ds_read_b64_tr_b16 v[224:225], v76 offset:0
    ds_read_b64_tr_b16 v[226:227], v76 offset:256
    ds_read_b64_tr_b16 v[228:229], v76 offset:2048
    ds_read_b64_tr_b16 v[230:231], v76 offset:2304
    ds_read_b64_tr_b16 v[232:233], v76 offset:32768
    ds_read_b64_tr_b16 v[234:235], v76 offset:33024
    ds_read_b64_tr_b16 v[236:237], v76 offset:34816
    ds_read_b64_tr_b16 v[238:239], v76 offset:35072
    s_waitcnt lgkmcnt(0)
    s_barrier
    s_add_u32 m0, s74, 32768
    s_mov_b32 s73, 0
    buffer_load_dwordx4 v26, s[20:23], s73 offen lds
    s_add_u32 m0, s74, 33792
    s_mov_b32 s73, 32768
    buffer_load_dwordx4 v34, s[20:23], s73 offen lds
    s_add_u32 m0, s74, 34816
    s_mov_b32 s73, 65536
    buffer_load_dwordx4 v26, s[20:23], s73 offen lds
    s_add_u32 m0, s74, 35840
    s_mov_b32 s73, 98304
    buffer_load_dwordx4 v34, s[20:23], s73 offen lds
    s_add_u32 m0, s74, 49152
    s_mov_b32 s73, 262144
    buffer_load_dwordx4 v26, s[20:23], s73 offen lds
    s_add_u32 m0, s74, 50176
    s_mov_b32 s73, 294912
    buffer_load_dwordx4 v34, s[20:23], s73 offen lds
    s_add_u32 m0, s74, 51200
    s_mov_b32 s73, 327680
    buffer_load_dwordx4 v26, s[20:23], s73 offen lds
    s_add_u32 m0, s74, 52224
    s_mov_b32 s73, 360448
    buffer_load_dwordx4 v34, s[20:23], s73 offen lds
    s_add_u32 m0, s74, 65536
    s_mov_b32 s73, 524288
    buffer_load_dwordx4 v26, s[20:23], s73 offen lds
    s_add_u32 m0, s74, 66560
    s_mov_b32 s73, 557056
    buffer_load_dwordx4 v34, s[20:23], s73 offen lds
    s_add_u32 m0, s74, 67584
    s_mov_b32 s73, 589824
    buffer_load_dwordx4 v26, s[20:23], s73 offen lds
    s_add_u32 m0, s74, 68608
    s_mov_b32 s73, 622592
    buffer_load_dwordx4 v34, s[20:23], s73 offen lds
    s_add_u32 m0, s74, 81920
    s_mov_b32 s73, 786432
    buffer_load_dwordx4 v26, s[20:23], s73 offen lds
    s_add_u32 m0, s74, 82944
    s_mov_b32 s73, 819200
    buffer_load_dwordx4 v34, s[20:23], s73 offen lds
    s_add_u32 m0, s74, 83968
    s_mov_b32 s73, 851968
    buffer_load_dwordx4 v26, s[20:23], s73 offen lds
    s_add_u32 m0, s74, 84992
    s_mov_b32 s73, 884736
    buffer_load_dwordx4 v34, s[20:23], s73 offen lds
    s_waitcnt vmcnt(16)
    s_barrier
    s_cmp_lg_u32 s3, 0
    s_cbranch_scc1 L_c_na
    v_mov_b32 v30, 1
    s_mov_b64 exec, 1
    buffer_atomic_add v30, off, s[8:11], 0 offset:196
    s_mov_b64 exec, -1
L_c_na:
    v_mov_b32 v76, v8
    v_add_u32 v76, 0x10000, v76
    ds_read_b64_tr_b16 v[112:113], v76 offset:32768
    ds_read_b64_tr_b16 v[114:115], v76 offset:33280
    ds_read_b64_tr_b16 v[116:117], v76 offset:40960
    ds_read_b64_tr_b16 v[118:119], v76 offset:41472
    v_xor_b32 v76, 32, v76
    ds_read_b64_tr_b16 v[120:121], v76 offset:32768
    ds_read_b64_tr_b16 v[122:123], v76 offset:33280
    ds_read_b64_tr_b16 v[124:125], v76 offset:40960
    ds_read_b64_tr_b16 v[126:127], v76 offset:41472
    v_xor_b32 v76, 16384, v8
    v_add_u32 v76, 0x10000, v76
    ds_read_b64_tr_b16 v[128:129], v76 offset:32768
    ds_read_b64_tr_b16 v[130:131], v76 offset:33280
    ds_read_b64_tr_b16 v[132:133], v76 offset:40960
    ds_read_b64_tr_b16 v[134:135], v76 offset:41472
    v_xor_b32 v76, 32, v76
    ds_read_b64_tr_b16 v[136:137], v76 offset:32768
    ds_read_b64_tr_b16 v[138:139], v76 offset:33280
    ds_read_b64_tr_b16 v[140:141], v76 offset:40960
    ds_read_b64_tr_b16 v[142:143], v76 offset:41472
    v_xor_b32 v76, 32768, v8
    v_add_u32 v76, 0x10000, v76
    ds_read_b64_tr_b16 v[144:145], v76 offset:32768
    ds_read_b64_tr_b16 v[146:147], v76 offset:33280
    ds_read_b64_tr_b16 v[148:149], v76 offset:40960
    ds_read_b64_tr_b16 v[150:151], v76 offset:41472
    v_xor_b32 v76, 32, v76
    ds_read_b64_tr_b16 v[152:153], v76 offset:32768
    ds_read_b64_tr_b16 v[154:155], v76 offset:33280
    ds_read_b64_tr_b16 v[156:157], v76 offset:40960
    ds_read_b64_tr_b16 v[158:159], v76 offset:41472
    v_xor_b32 v76, 49152, v8
    v_add_u32 v76, 0x10000, v76
    ds_read_b64_tr_b16 v[160:161], v76 offset:32768
    ds_read_b64_tr_b16 v[162:163], v76 offset:33280
    ds_read_b64_tr_b16 v[164:165], v76 offset:40960
    ds_read_b64_tr_b16 v[166:167], v76 offset:41472
    v_xor_b32 v76, 32, v76
    ds_read_b64_tr_b16 v[168:169], v76 offset:32768
    ds_read_b64_tr_b16 v[170:171], v76 offset:33280
    ds_read_b64_tr_b16 v[172:173], v76 offset:40960
    ds_read_b64_tr_b16 v[174:175], v76 offset:41472
    s_waitcnt lgkmcnt(0)
    s_barrier
    s_add_u32 m0, s74, 98304
    s_mov_b32 s73, 2097152
    buffer_load_dwordx4 v26, s[20:23], s73 offen lds
    s_add_u32 m0, s74, 99328
    s_mov_b32 s73, 2129920
    buffer_load_dwordx4 v34, s[20:23], s73 offen lds
    s_add_u32 m0, s74, 100352
    s_mov_b32 s73, 2162688
    buffer_load_dwordx4 v26, s[20:23], s73 offen lds
    s_add_u32 m0, s74, 101376
    s_mov_b32 s73, 2195456
    buffer_load_dwordx4 v34, s[20:23], s73 offen lds
    s_add_u32 m0, s74, 114688
    s_mov_b32 s73, 2359296
    buffer_load_dwordx4 v26, s[20:23], s73 offen lds
    s_add_u32 m0, s74, 115712
    s_mov_b32 s73, 2392064
    buffer_load_dwordx4 v34, s[20:23], s73 offen lds
    s_add_u32 m0, s74, 116736
    s_mov_b32 s73, 2424832
    buffer_load_dwordx4 v26, s[20:23], s73 offen lds
    s_add_u32 m0, s74, 117760
    s_mov_b32 s73, 2457600
    buffer_load_dwordx4 v34, s[20:23], s73 offen lds
    s_add_u32 m0, s74, 131072
    s_mov_b32 s73, 2621440
    buffer_load_dwordx4 v26, s[20:23], s73 offen lds
    s_add_u32 m0, s74, 132096
    s_mov_b32 s73, 2654208
    buffer_load_dwordx4 v34, s[20:23], s73 offen lds
    s_add_u32 m0, s74, 133120
    s_mov_b32 s73, 2686976
    buffer_load_dwordx4 v26, s[20:23], s73 offen lds
    s_add_u32 m0, s74, 134144
    s_mov_b32 s73, 2719744
    buffer_load_dwordx4 v34, s[20:23], s73 offen lds
    s_add_u32 m0, s74, 147456
    s_mov_b32 s73, 2883584
    buffer_load_dwordx4 v26, s[20:23], s73 offen lds
    s_add_u32 m0, s74, 148480
    s_mov_b32 s73, 2916352
    buffer_load_dwordx4 v34, s[20:23], s73 offen lds
    s_add_u32 m0, s74, 149504
    s_mov_b32 s73, 2949120
    buffer_load_dwordx4 v26, s[20:23], s73 offen lds
    s_add_u32 m0, s74, 150528
    s_mov_b32 s73, 2981888
    buffer_load_dwordx4 v34, s[20:23], s73 offen lds
    s_waitcnt vmcnt(16)
    s_barrier
    v_mov_b32 v76, v8
    ds_read_b64_tr_b16 a[0:1], v76 offset:32768
    ds_read_b64_tr_b16 a[2:3], v76 offset:33280
    ds_read_b64_tr_b16 a[4:5], v76 offset:40960
    ds_read_b64_tr_b16 a[6:7], v76 offset:41472
    v_xor_b32 v76, 32, v76
    ds_read_b64_tr_b16 a[8:9], v76 offset:32768
    ds_read_b64_tr_b16 a[10:11], v76 offset:33280
    ds_read_b64_tr_b16 a[12:13], v76 offset:40960
    ds_read_b64_tr_b16 a[14:15], v76 offset:41472
    v_xor_b32 v76, 16384, v8
    ds_read_b64_tr_b16 a[32:33], v76 offset:32768
    ds_read_b64_tr_b16 a[34:35], v76 offset:33280
    ds_read_b64_tr_b16 a[36:37], v76 offset:40960
    ds_read_b64_tr_b16 a[38:39], v76 offset:41472
    v_xor_b32 v76, 32, v76
    ds_read_b64_tr_b16 a[40:41], v76 offset:32768
    ds_read_b64_tr_b16 a[42:43], v76 offset:33280
    ds_read_b64_tr_b16 a[44:45], v76 offset:40960
    ds_read_b64_tr_b16 a[46:47], v76 offset:41472
    v_xor_b32 v76, 32768, v8
    ds_read_b64_tr_b16 a[64:65], v76 offset:32768
    ds_read_b64_tr_b16 a[66:67], v76 offset:33280
    ds_read_b64_tr_b16 a[68:69], v76 offset:40960
    ds_read_b64_tr_b16 a[70:71], v76 offset:41472
    v_xor_b32 v76, 32, v76
    ds_read_b64_tr_b16 a[72:73], v76 offset:32768
    ds_read_b64_tr_b16 a[74:75], v76 offset:33280
    ds_read_b64_tr_b16 a[76:77], v76 offset:40960
    ds_read_b64_tr_b16 a[78:79], v76 offset:41472
    v_xor_b32 v76, 49152, v8
    ds_read_b64_tr_b16 a[96:97], v76 offset:32768
    ds_read_b64_tr_b16 a[98:99], v76 offset:33280
    ds_read_b64_tr_b16 a[100:101], v76 offset:40960
    ds_read_b64_tr_b16 a[102:103], v76 offset:41472
    v_xor_b32 v76, 32, v76
    ds_read_b64_tr_b16 a[104:105], v76 offset:32768
    ds_read_b64_tr_b16 a[106:107], v76 offset:33280
    ds_read_b64_tr_b16 a[108:109], v76 offset:40960
    ds_read_b64_tr_b16 a[110:111], v76 offset:41472
    s_waitcnt lgkmcnt(0)
    s_barrier
    s_add_u32 m0, s74, 32768
    s_mov_b32 s73, 0
    buffer_load_dwordx4 v26, s[24:27], s73 offen lds
    s_add_u32 m0, s74, 33792
    s_mov_b32 s73, 32768
    buffer_load_dwordx4 v34, s[24:27], s73 offen lds
    s_add_u32 m0, s74, 34816
    s_mov_b32 s73, 65536
    buffer_load_dwordx4 v26, s[24:27], s73 offen lds
    s_add_u32 m0, s74, 35840
    s_mov_b32 s73, 98304
    buffer_load_dwordx4 v34, s[24:27], s73 offen lds
    s_add_u32 m0, s74, 49152
    s_mov_b32 s73, 262144
    buffer_load_dwordx4 v26, s[24:27], s73 offen lds
    s_add_u32 m0, s74, 50176
    s_mov_b32 s73, 294912
    buffer_load_dwordx4 v34, s[24:27], s73 offen lds
    s_add_u32 m0, s74, 51200
    s_mov_b32 s73, 327680
    buffer_load_dwordx4 v26, s[24:27], s73 offen lds
    s_add_u32 m0, s74, 52224
    s_mov_b32 s73, 360448
    buffer_load_dwordx4 v34, s[24:27], s73 offen lds
    s_add_u32 m0, s74, 65536
    s_mov_b32 s73, 524288
    buffer_load_dwordx4 v26, s[24:27], s73 offen lds
    s_add_u32 m0, s74, 66560
    s_mov_b32 s73, 557056
    buffer_load_dwordx4 v34, s[24:27], s73 offen lds
    s_add_u32 m0, s74, 67584
    s_mov_b32 s73, 589824
    buffer_load_dwordx4 v26, s[24:27], s73 offen lds
    s_add_u32 m0, s74, 68608
    s_mov_b32 s73, 622592
    buffer_load_dwordx4 v34, s[24:27], s73 offen lds
    s_add_u32 m0, s74, 81920
    s_mov_b32 s73, 786432
    buffer_load_dwordx4 v26, s[24:27], s73 offen lds
    s_add_u32 m0, s74, 82944
    s_mov_b32 s73, 819200
    buffer_load_dwordx4 v34, s[24:27], s73 offen lds
    s_add_u32 m0, s74, 83968
    s_mov_b32 s73, 851968
    buffer_load_dwordx4 v26, s[24:27], s73 offen lds
    s_add_u32 m0, s74, 84992
    s_mov_b32 s73, 884736
    buffer_load_dwordx4 v34, s[24:27], s73 offen lds
    s_waitcnt vmcnt(16)
    s_barrier
    v_mov_b32 v76, v8
    v_add_u32 v76, 0x10000, v76
    ds_read_b64_tr_b16 a[16:17], v76 offset:32768
    ds_read_b64_tr_b16 a[18:19], v76 offset:33280
    ds_read_b64_tr_b16 a[20:21], v76 offset:40960
    ds_read_b64_tr_b16 a[22:23], v76 offset:41472
    v_xor_b32 v76, 32, v76
    ds_read_b64_tr_b16 a[24:25], v76 offset:32768
    ds_read_b64_tr_b16 a[26:27], v76 offset:33280
    ds_read_b64_tr_b16 a[28:29], v76 offset:40960
    ds_read_b64_tr_b16 a[30:31], v76 offset:41472
    v_xor_b32 v76, 16384, v8
    v_add_u32 v76, 0x10000, v76
    ds_read_b64_tr_b16 a[48:49], v76 offset:32768
    ds_read_b64_tr_b16 a[50:51], v76 offset:33280
    ds_read_b64_tr_b16 a[52:53], v76 offset:40960
    ds_read_b64_tr_b16 a[54:55], v76 offset:41472
    v_xor_b32 v76, 32, v76
    ds_read_b64_tr_b16 a[56:57], v76 offset:32768
    ds_read_b64_tr_b16 a[58:59], v76 offset:33280
    ds_read_b64_tr_b16 a[60:61], v76 offset:40960
    ds_read_b64_tr_b16 a[62:63], v76 offset:41472
    v_xor_b32 v76, 32768, v8
    v_add_u32 v76, 0x10000, v76
    ds_read_b64_tr_b16 a[80:81], v76 offset:32768
    ds_read_b64_tr_b16 a[82:83], v76 offset:33280
    ds_read_b64_tr_b16 a[84:85], v76 offset:40960
    ds_read_b64_tr_b16 a[86:87], v76 offset:41472
    v_xor_b32 v76, 32, v76
    ds_read_b64_tr_b16 a[88:89], v76 offset:32768
    ds_read_b64_tr_b16 a[90:91], v76 offset:33280
    ds_read_b64_tr_b16 a[92:93], v76 offset:40960
    ds_read_b64_tr_b16 a[94:95], v76 offset:41472
    v_xor_b32 v76, 49152, v8
    v_add_u32 v76, 0x10000, v76
    ds_read_b64_tr_b16 a[112:113], v76 offset:32768
    ds_read_b64_tr_b16 a[114:115], v76 offset:33280
    ds_read_b64_tr_b16 a[116:117], v76 offset:40960
    ds_read_b64_tr_b16 a[118:119], v76 offset:41472
    v_xor_b32 v76, 32, v76
    ds_read_b64_tr_b16 a[120:121], v76 offset:32768
    ds_read_b64_tr_b16 a[122:123], v76 offset:33280
    ds_read_b64_tr_b16 a[124:125], v76 offset:40960
    ds_read_b64_tr_b16 a[126:127], v76 offset:41472
    s_waitcnt lgkmcnt(0)
    s_barrier
    buffer_load_dword v35, off, s[8:11], 0 offset:200 sc1
    s_add_u32 m0, s74, 98304
    s_mov_b32 s73, 2097152
    buffer_load_dwordx4 v26, s[24:27], s73 offen lds
    s_add_u32 m0, s74, 99328
    s_mov_b32 s73, 2129920
    buffer_load_dwordx4 v34, s[24:27], s73 offen lds
    s_add_u32 m0, s74, 100352
    s_mov_b32 s73, 2162688
    buffer_load_dwordx4 v26, s[24:27], s73 offen lds
    s_add_u32 m0, s74, 101376
    s_mov_b32 s73, 2195456
    buffer_load_dwordx4 v34, s[24:27], s73 offen lds
    s_add_u32 m0, s74, 114688
    s_mov_b32 s73, 2359296
    buffer_load_dwordx4 v26, s[24:27], s73 offen lds
    s_add_u32 m0, s74, 115712
    s_mov_b32 s73, 2392064
    buffer_load_dwordx4 v34, s[24:27], s73 offen lds
    s_add_u32 m0, s74, 116736
    s_mov_b32 s73, 2424832
    buffer_load_dwordx4 v26, s[24:27], s73 offen lds
    s_add_u32 m0, s74, 117760
    s_mov_b32 s73, 2457600
    buffer_load_dwordx4 v34, s[24:27], s73 offen lds
    s_add_u32 m0, s74, 131072
    s_mov_b32 s73, 2621440
    buffer_load_dwordx4 v26, s[24:27], s73 offen lds
    s_add_u32 m0, s74, 132096
    s_mov_b32 s73, 2654208
    buffer_load_dwordx4 v34, s[24:27], s73 offen lds
    s_add_u32 m0, s74, 133120
    s_mov_b32 s73, 2686976
    buffer_load_dwordx4 v26, s[24:27], s73 offen lds
    s_add_u32 m0, s74, 134144
    s_mov_b32 s73, 2719744
    buffer_load_dwordx4 v34, s[24:27], s73 offen lds
    s_add_u32 m0, s74, 147456
    s_mov_b32 s73, 2883584
    buffer_load_dwordx4 v26, s[24:27], s73 offen lds
    s_add_u32 m0, s74, 148480
    s_mov_b32 s73, 2916352
    buffer_load_dwordx4 v34, s[24:27], s73 offen lds
    s_add_u32 m0, s74, 149504
    s_mov_b32 s73, 2949120
    buffer_load_dwordx4 v26, s[24:27], s73 offen lds
    s_add_u32 m0, s74, 150528
    s_mov_b32 s73, 2981888
    buffer_load_dwordx4 v34, s[24:27], s73 offen lds
    s_waitcnt vmcnt(17)
    s_barrier
    v_mov_b32 v76, v8
    ds_read_b64_tr_b16 a[128:129], v76 offset:32768
    ds_read_b64_tr_b16 a[130:131], v76 offset:33280
    ds_read_b64_tr_b16 a[132:133], v76 offset:40960
    ds_read_b64_tr_b16 a[134:135], v76 offset:41472
    v_xor_b32 v76, 32, v76
    ds_read_b64_tr_b16 a[136:137], v76 offset:32768
    ds_read_b64_tr_b16 a[138:139], v76 offset:33280
    ds_read_b64_tr_b16 a[140:141], v76 offset:40960
    ds_read_b64_tr_b16 a[142:143], v76 offset:41472
    v_xor_b32 v76, 16384, v8
    ds_read_b64_tr_b16 a[160:161], v76 offset:32768
    ds_read_b64_tr_b16 a[162:163], v76 offset:33280
    ds_read_b64_tr_b16 a[164:165], v76 offset:40960
    ds_read_b64_tr_b16 a[166:167], v76 offset:41472
    v_xor_b32 v76, 32, v76
    ds_read_b64_tr_b16 a[168:169], v76 offset:32768
    ds_read_b64_tr_b16 a[170:171], v76 offset:33280
    ds_read_b64_tr_b16 a[172:173], v76 offset:40960
    ds_read_b64_tr_b16 a[174:175], v76 offset:41472
    v_xor_b32 v76, 32768, v8
    ds_read_b64_tr_b16 a[192:193], v76 offset:32768
    ds_read_b64_tr_b16 a[194:195], v76 offset:33280
    ds_read_b64_tr_b16 a[196:197], v76 offset:40960
    ds_read_b64_tr_b16 a[198:199], v76 offset:41472
    v_xor_b32 v76, 32, v76
    ds_read_b64_tr_b16 a[200:201], v76 offset:32768
    ds_read_b64_tr_b16 a[202:203], v76 offset:33280
    ds_read_b64_tr_b16 a[204:205], v76 offset:40960
    ds_read_b64_tr_b16 a[206:207], v76 offset:41472
    v_xor_b32 v76, 49152, v8
    ds_read_b64_tr_b16 a[224:225], v76 offset:32768
    ds_read_b64_tr_b16 a[226:227], v76 offset:33280
    ds_read_b64_tr_b16 a[228:229], v76 offset:40960
    ds_read_b64_tr_b16 a[230:231], v76 offset:41472
    v_xor_b32 v76, 32, v76
    ds_read_b64_tr_b16 a[232:233], v76 offset:32768
    ds_read_b64_tr_b16 a[234:235], v76 offset:33280
    ds_read_b64_tr_b16 a[236:237], v76 offset:40960
    ds_read_b64_tr_b16 a[238:239], v76 offset:41472
    s_waitcnt lgkmcnt(0)
    s_barrier
    s_add_u32 m0, s74, 32768
    s_mov_b32 s73, 128
    buffer_load_dwordx4 v27, s[28:31], s73 offen lds
    s_add_u32 m0, s74, 33792
    s_mov_b32 s73, 4224
    buffer_load_dwordx4 v27, s[28:31], s73 offen lds
    s_add_u32 m0, s74, 34816
    s_mov_b32 s73, 8320
    buffer_load_dwordx4 v27, s[28:31], s73 offen lds
    s_add_u32 m0, s74, 35840
    s_mov_b32 s73, 12416
    buffer_load_dwordx4 v27, s[28:31], s73 offen lds
    s_add_u32 m0, s74, 49152
    s_mov_b32 s73, 640
    buffer_load_dwordx4 v27, s[28:31], s73 offen lds
    s_add_u32 m0, s74, 50176
    s_mov_b32 s73, 4736
    buffer_load_dwordx4 v27, s[28:31], s73 offen lds
    s_add_u32 m0, s74, 51200
    s_mov_b32 s73, 8832
    buffer_load_dwordx4 v27, s[28:31], s73 offen lds
    s_add_u32 m0, s74, 52224
    s_mov_b32 s73, 12928
    buffer_load_dwordx4 v27, s[28:31], s73 offen lds
    s_add_u32 m0, s74, 65536
    s_mov_b32 s73, 65664
    buffer_load_dwordx4 v27, s[28:31], s73 offen lds
    s_add_u32 m0, s74, 66560
    s_mov_b32 s73, 69760
    buffer_load_dwordx4 v27, s[28:31], s73 offen lds
    s_add_u32 m0, s74, 67584
    s_mov_b32 s73, 73856
    buffer_load_dwordx4 v27, s[28:31], s73 offen lds
    s_add_u32 m0, s74, 68608
    s_mov_b32 s73, 77952
    buffer_load_dwordx4 v27, s[28:31], s73 offen lds
    s_add_u32 m0, s74, 81920
    s_mov_b32 s73, 66176
    buffer_load_dwordx4 v27, s[28:31], s73 offen lds
    s_add_u32 m0, s74, 82944
    s_mov_b32 s73, 70272
    buffer_load_dwordx4 v27, s[28:31], s73 offen lds
    s_add_u32 m0, s74, 83968
    s_mov_b32 s73, 74368
    buffer_load_dwordx4 v27, s[28:31], s73 offen lds
    s_add_u32 m0, s74, 84992
    s_mov_b32 s73, 78464
    buffer_load_dwordx4 v27, s[28:31], s73 offen lds
    s_waitcnt vmcnt(16)
    s_barrier
    v_mov_b32 v76, v8
    v_add_u32 v76, 0x10000, v76
    ds_read_b64_tr_b16 a[144:145], v76 offset:32768
    ds_read_b64_tr_b16 a[146:147], v76 offset:33280
    ds_read_b64_tr_b16 a[148:149], v76 offset:40960
    ds_read_b64_tr_b16 a[150:151], v76 offset:41472
    v_xor_b32 v76, 32, v76
    ds_read_b64_tr_b16 a[152:153], v76 offset:32768
    ds_read_b64_tr_b16 a[154:155], v76 offset:33280
    ds_read_b64_tr_b16 a[156:157], v76 offset:40960
    ds_read_b64_tr_b16 a[158:159], v76 offset:41472
    v_xor_b32 v76, 16384, v8
    v_add_u32 v76, 0x10000, v76
    ds_read_b64_tr_b16 a[176:177], v76 offset:32768
    ds_read_b64_tr_b16 a[178:179], v76 offset:33280
    ds_read_b64_tr_b16 a[180:181], v76 offset:40960
    ds_read_b64_tr_b16 a[182:183], v76 offset:41472
    v_xor_b32 v76, 32, v76
    ds_read_b64_tr_b16 a[184:185], v76 offset:32768
    ds_read_b64_tr_b16 a[186:187], v76 offset:33280
    ds_read_b64_tr_b16 a[188:189], v76 offset:40960
    ds_read_b64_tr_b16 a[190:191], v76 offset:41472
    v_xor_b32 v76, 32768, v8
    v_add_u32 v76, 0x10000, v76
    ds_read_b64_tr_b16 a[208:209], v76 offset:32768
    ds_read_b64_tr_b16 a[210:211], v76 offset:33280
    ds_read_b64_tr_b16 a[212:213], v76 offset:40960
    ds_read_b64_tr_b16 a[214:215], v76 offset:41472
    v_xor_b32 v76, 32, v76
    ds_read_b64_tr_b16 a[216:217], v76 offset:32768
    ds_read_b64_tr_b16 a[218:219], v76 offset:33280
    ds_read_b64_tr_b16 a[220:221], v76 offset:40960
    ds_read_b64_tr_b16 a[222:223], v76 offset:41472
    v_xor_b32 v76, 49152, v8
    v_add_u32 v76, 0x10000, v76
    ds_read_b64_tr_b16 a[240:241], v76 offset:32768
    ds_read_b64_tr_b16 a[242:243], v76 offset:33280
    ds_read_b64_tr_b16 a[244:245], v76 offset:40960
    ds_read_b64_tr_b16 a[246:247], v76 offset:41472
    v_xor_b32 v76, 32, v76
    ds_read_b64_tr_b16 a[248:249], v76 offset:32768
    ds_read_b64_tr_b16 a[250:251], v76 offset:33280
    ds_read_b64_tr_b16 a[252:253], v76 offset:40960
    ds_read_b64_tr_b16 a[254:255], v76 offset:41472
    s_waitcnt lgkmcnt(0)
    s_barrier
    v_readfirstlane_b32 s85, v35
    s_nop 0
    s_cmp_lg_u32 s85, 0
    s_cbranch_scc1 L_c_iok
    s_mov_b32 s59, 1000000
L_wi_c:
    buffer_load_dword v35, off, s[8:11], 0 offset:200 sc1
    s_sub_u32 s59, s59, 1
    s_cbranch_scc1 L_fail
    s_waitcnt vmcnt(0)
    v_readfirstlane_b32 s84, v35
    s_nop 0
    s_cmp_eq_u32 s84, 0
    s_cbranch_scc1 L_wi_c
L_c_iok:
    s_lshl_b32 s71, s60, 7
    s_add_u32 s71, s71, 262144
    v_lshrrev_b32 v33, 2, v0
    buffer_load_dword v35, v33, s[8:11], 0 offen sc1
    buffer_load_dwordx4 v[20:23], off, s[4:7], s71 sc1
    s_add_u32 m0, s74, 98304
    s_mov_b32 s73, 2097152
    buffer_load_dwordx4 v26, s[16:19], s73 offen lds
    s_add_u32 m0, s74, 99328
    s_mov_b32 s73, 2129920
    buffer_load_dwordx4 v34, s[16:19], s73 offen lds
    s_add_u32 m0, s74, 100352
    s_mov_b32 s73, 2162688
    buffer_load_dwordx4 v26, s[16:19], s73 offen lds
    s_add_u32 m0, s74, 101376
    s_mov_b32 s73, 2195456
    buffer_load_dwordx4 v34, s[16:19], s73 offen lds
    s_add_u32 m0, s74, 114688
    s_mov_b32 s73, 2359296
    buffer_load_dwordx4 v26, s[16:19], s73 offen lds
    s_add_u32 m0, s74, 115712
    s_mov_b32 s73, 2392064
    buffer_load_dwordx4 v34, s[16:19], s73 offen lds
    s_add_u32 m0, s74, 116736
    s_mov_b32 s73, 2424832
    buffer_load_dwordx4 v26, s[16:19], s73 offen lds
    s_add_u32 m0, s74, 117760
    s_mov_b32 s73, 2457600
    buffer_load_dwordx4 v34, s[16:19], s73 offen lds
    s_add_u32 m0, s74, 131072
    s_mov_b32 s73, 2621440
    buffer_load_dwordx4 v26, s[16:19], s73 offen lds
    s_add_u32 m0, s74, 132096
    s_mov_b32 s73, 2654208
    buffer_load_dwordx4 v34, s[16:19], s73 offen lds
    s_add_u32 m0, s74, 133120
    s_mov_b32 s73, 2686976
    buffer_load_dwordx4 v26, s[16:19], s73 offen lds
    s_add_u32 m0, s74, 134144
    s_mov_b32 s73, 2719744
    buffer_load_dwordx4 v34, s[16:19], s73 offen lds
    s_add_u32 m0, s74, 147456
    s_mov_b32 s73, 2883584
    buffer_load_dwordx4 v26, s[16:19], s73 offen lds
    s_add_u32 m0, s74, 148480
    s_mov_b32 s73, 2916352
    buffer_load_dwordx4 v34, s[16:19], s73 offen lds
    s_add_u32 m0, s74, 149504
    s_mov_b32 s73, 2949120
    buffer_load_dwordx4 v26, s[16:19], s73 offen lds
    s_add_u32 m0, s74, 150528
    s_mov_b32 s73, 2981888
    buffer_load_dwordx4 v34, s[16:19], s73 offen lds
    s_mov_b32 s70, 0xbe0293ee
    s_mov_b32 s90, 0x3e0293ee
    s_mov_b32 s91, 0x3e0293ee
    s_mov_b32 s61, 0
    s_mov_b32 s89, 0
    s_mov_b32 s86, 0x00ff00ff
    s_mov_b32 s87, 0x00ff00ff
    s_lshl_b32 s77, s3, 12
    s_add_u32 s77, s77, 524288
    s_lshl_b32 s67, s60, 14
    s_add_u32 s67, s67, 2097152
    s_mov_b32 s68, 524288
    s_add_u32 s82, s76, 0
    s_add_u32 s83, s76, 8192
    s_waitcnt vmcnt(16)
    s_barrier
    v_xor_b32 v76, 0, v9
    ds_read_b64_tr_b16 v[240:241], v76 offset:0
    ds_read_b64_tr_b16 v[242:243], v76 offset:256
    ds_read_b64_tr_b16 v[244:245], v76 offset:2048
    ds_read_b64_tr_b16 v[246:247], v76 offset:2304
    ds_read_b64_tr_b16 v[248:249], v76 offset:32768
    ds_read_b64_tr_b16 v[250:251], v76 offset:33024
    ds_read_b64_tr_b16 v[252:253], v76 offset:34816
    ds_read_b64_tr_b16 v[254:255], v76 offset:35072
    v_xor_b32 v76, 32, v9
    ds_read_b64_tr_b16 v[48:49], v76 offset:0
    ds_read_b64_tr_b16 v[50:51], v76 offset:256
    ds_read_b64_tr_b16 v[52:53], v76 offset:2048
    ds_read_b64_tr_b16 v[54:55], v76 offset:2304
    ds_read_b64_tr_b16 v[56:57], v76 offset:32768
    ds_read_b64_tr_b16 v[58:59], v76 offset:33024
    ds_read_b64_tr_b16 v[60:61], v76 offset:34816
    ds_read_b64_tr_b16 v[62:63], v76 offset:35072
    v_xor_b32 v76, 64, v9
    ds_read_b64_tr_b16 v[64:65], v76 offset:0
    ds_read_b64_tr_b16 v[66:67], v76 offset:256
    ds_read_b64_tr_b16 v[68:69], v76 offset:2048
    ds_read_b64_tr_b16 v[70:71], v76 offset:2304
    ds_read_b64_tr_b16 v[80:81], v76 offset:32768
    ds_read_b64_tr_b16 v[82:83], v76 offset:33024
    ds_read_b64_tr_b16 v[84:85], v76 offset:34816
    ds_read_b64_tr_b16 v[86:87], v76 offset:35072
    v_xor_b32 v76, 96, v9
    ds_read_b64_tr_b16 v[88:89], v76 offset:0
    ds_read_b64_tr_b16 v[90:91], v76 offset:256
    ds_read_b64_tr_b16 v[92:93], v76 offset:2048
    ds_read_b64_tr_b16 v[94:95], v76 offset:2304
    ds_read_b64_tr_b16 v[96:97], v76 offset:32768
    ds_read_b64_tr_b16 v[98:99], v76 offset:33024
    ds_read_b64_tr_b16 v[100:101], v76 offset:34816
    ds_read_b64_tr_b16 v[102:103], v76 offset:35072
    s_mul_i32 s73, s3, 12288
    s_add_u32 s73, s73, 49152
    s_waitcnt lgkmcnt(0)
    s_barrier
    v_add_u32 v9, s73, v0
    ds_write_b128 v9, v[48:51] offset:0
    ds_write_b128 v9, v[52:55] offset:1024
    ds_write_b128 v9, v[56:59] offset:2048
    ds_write_b128 v9, v[60:63] offset:3072
    ds_write_b128 v9, v[64:67] offset:4096
    ds_write_b128 v9, v[68:71] offset:5120
    ds_write_b128 v9, v[80:83] offset:6144
    ds_write_b128 v9, v[84:87] offset:7168
    ds_write_b128 v9, v[88:91] offset:8192
    ds_write_b128 v9, v[92:95] offset:9216
    ds_write_b128 v9, v[96:99] offset:10240
    ds_write_b128 v9, v[100:103] offset:11264
    ds_write_b128 v0, v[36:39] offset:47616
    s_waitcnt lgkmcnt(0)
    s_mov_b32 s59, 1000000
    s_branch L_c_chk
L_c_wait:
    buffer_load_dword v35, v33, s[8:11], 0 offen sc1
    buffer_load_dwordx4 v[20:23], off, s[4:7], s71 sc1
    s_sub_u32 s59, s59, 1
    s_cbranch_scc1 L_fail
    s_waitcnt vmcnt(0)
L_c_chk:
    v_readlane_b32 s73, v35, 49
    v_readlane_b32 s74, v35, 48
    s_cmp_lt_u32 s73, 40
    s_cbranch_scc1 L_c_wait
    v_min_u32 v20, v20, v21
    v_min_u32 v20, v20, v22
    s_nop 0
    v_readfirstlane_b32 s73, v20
    s_nop 0
    s_cmp_eq_u32 s73, 0
    s_cbranch_scc1 L_c_wait
    s_add_u32 s81, s67, 8192
    s_mov_b32 m0, s82
    s_nop 0
    buffer_load_dwordx4 v10, s[4:7], s67 offen sc1 lds
    buffer_load_dwordx4 v10, s[4:7], s67 offen offset:1024 sc1 lds
    s_mov_b32 m0, s83
    s_nop 0
    buffer_load_dwordx4 v10, s[4:7], s81 offen sc1 lds
    buffer_load_dwordx4 v10, s[4:7], s81 offen offset:1024 sc1 lds
    s_mov_b32 s62, 0
    buffer_load_dwordx4 v[16:19], v10, s[4:7], s62 offen sc1
    buffer_load_dwordx4 v[20:23], v10, s[4:7], s62 offen offset:1024 sc1
    s_waitcnt vmcnt(6)
    s_barrier
    v_mov_b32 v76, v8
    v_add_u32 v76, 0x10000, v76
    ds_read_b64_tr_b16 v[80:81], v76 offset:32768
    ds_read_b64_tr_b16 v[82:83], v76 offset:33280
    ds_read_b64_tr_b16 v[84:85], v76 offset:40960
    ds_read_b64_tr_b16 v[86:87], v76 offset:41472
    v_xor_b32 v76, 32, v76
    ds_read_b64_tr_b16 v[88:89], v76 offset:32768
    ds_read_b64_tr_b16 v[90:91], v76 offset:33280
    ds_read_b64_tr_b16 v[92:93], v76 offset:40960
    ds_read_b64_tr_b16 v[94:95], v76 offset:41472
    v_xor_b32 v76, 16384, v8
    v_add_u32 v76, 0x10000, v76
    ds_read_b64_tr_b16 v[96:97], v76 offset:32768
    ds_read_b64_tr_b16 v[98:99], v76 offset:33280
    ds_read_b64_tr_b16 v[100:101], v76 offset:40960
    ds_read_b64_tr_b16 v[102:103], v76 offset:41472
    v_xor_b32 v76, 32, v76
    ds_read_b64_tr_b16 v[104:105], v76 offset:32768
    ds_read_b64_tr_b16 v[106:107], v76 offset:33280
    ds_read_b64_tr_b16 v[108:109], v76 offset:40960
    ds_read_b64_tr_b16 v[110:111], v76 offset:41472
    v_xor_b32 v76, 32768, v8
    v_add_u32 v76, 0x10000, v76
    ds_read_b64_tr_b16 v[48:49], v76 offset:32768
    ds_read_b64_tr_b16 v[50:51], v76 offset:33280
    ds_read_b64_tr_b16 v[52:53], v76 offset:40960
    ds_read_b64_tr_b16 v[54:55], v76 offset:41472
    v_xor_b32 v76, 32, v76
    ds_read_b64_tr_b16 v[56:57], v76 offset:32768
    ds_read_b64_tr_b16 v[58:59], v76 offset:33280
    ds_read_b64_tr_b16 v[60:61], v76 offset:40960
    ds_read_b64_tr_b16 v[62:63], v76 offset:41472
    v_xor_b32 v76, 49152, v8
    v_add_u32 v76, 0x10000, v76
    ds_read_b64_tr_b16 v[64:65], v76 offset:32768
    ds_read_b64_tr_b16 v[66:67], v76 offset:33280
    ds_read_b64_tr_b16 v[68:69], v76 offset:40960
    ds_read_b64_tr_b16 v[70:71], v76 offset:41472
    v_xor_b32 v76, 32, v76
    ds_read_b64_tr_b16 v[40:41], v76 offset:32768
    ds_read_b64_tr_b16 v[42:43], v76 offset:33280
    ds_read_b64_tr_b16 v[44:45], v76 offset:40960
    ds_read_b64_tr_b16 v[46:47], v76 offset:41472
    s_lshl_b32 s73, s3, 14
    s_add_u32 s73, s73, 98304
    s_waitcnt lgkmcnt(0)
    s_barrier
    v_add_u32 v8, s73, v0
    ds_write_b128 v8, v[48:51] offset:8192
    ds_write_b128 v8, v[52:55] offset:9216
    ds_write_b128 v8, v[56:59] offset:10240
    ds_write_b128 v8, v[60:63] offset:11264
    ds_write_b128 v8, v[64:67] offset:12288
    ds_write_b128 v8, v[68:71] offset:13312
    ds_write_b128 v8, v[40:43] offset:14336
    ds_write_b128 v8, v[44:47] offset:15360
    ds_write_b128 v8, v[80:83] offset:0
    ds_write_b128 v8, v[84:87] offset:1024
    ds_write_b128 v8, v[88:91] offset:2048
    ds_write_b128 v8, v[92:95] offset:3072
    ds_write_b128 v8, v[96:99] offset:4096
    ds_write_b128 v8, v[100:103] offset:5120
    ds_write_b128 v8, v[104:107] offset:6144
    ds_write_b128 v8, v[108:111] offset:7168
    v_mov_b32 v79, v0
    v_mov_b32 v15, 0
    s_mov_b32 s62, 0
    s_mov_b32 s63, 8192
    s_mov_b32 s64, 24576
    s_mov_b32 s65, 1048576
    s_mov_b32 s80, 1052672
    s_add_u32 s66, s75, 1310720
    s_add_u32 s67, s67, 524288
    s_add_u32 s81, s67, 8192
    s_xor_b32 s82, s82, 0x4000
    s_xor_b32 s83, s83, 0x4000
    s_add_u32 s84, s71, 12
    s_cmp_lt_u32 s74, 32
    s_cbranch_scc1 L_step_slow
L_step_fast:
    v_mov_b64 v[48:49], 0
    v_mov_b64 v[50:51], 0
    v_mov_b64 v[52:53], 0
    v_mov_b64 v[54:55], 0
    v_mov_b64 v[56:57], 0
    v_mov_b64 v[58:59], 0
    v_mov_b64 v[60:61], 0
    v_mov_b64 v[62:63], 0
    v_mov_b64 v[64:65], 0
    v_mov_b64 v[66:67], 0
    v_mov_b64 v[68:69], 0
    v_mov_b64 v[70:71], 0
    v_mov_b64 v[72:73], -1
    v_mov_b64 v[74:75], -1
    s_mov_b32 s59, 1000000
    s_waitcnt vmcnt(0)
    .p2align 6
    s_nop 0
    s_nop 0
    s_nop 0
    s_nop 0
    s_nop 0
    s_nop 0
L_gwf:
    s_waitcnt vmcnt(3) lgkmcnt(0)
    v_max3_u32 v76, v16, v17, v18
    v_max_u32 v76, v76, v19
    s_waitcnt vmcnt(2)
    v_max3_u32 v76, v76, v20, v21
    v_max3_u32 v76, v76, v22, v23
    v_cmp_eq_u32 vcc, -1, v76
    v_smfmac_f32_16x16x64_bf16 v[48:51], v[16:19], v[112:119], v1
    ds_write_b128 v10, v[16:19] offset:32768
    v_smfmac_f32_16x16x64_bf16 v[52:55], v[16:19], v[120:127], v1
    ds_write_b128 v10, v[20:23] offset:33792
    s_cbranch_vccnz L_grf
    v_smfmac_f32_16x16x64_bf16 v[48:51], v[20:23], v[80:87], v1
    v_xor_b32 v77, 6144, v10
    v_smfmac_f32_16x16x64_bf16 v[52:55], v[20:23], v[88:95], v1
    ds_read_b128 v[80:83], v8 offset:8192
    v_smfmac_f32_16x16x64_bf16 v[56:59], v[16:19], a[0:7], v1
    ds_read_b128 v[84:87], v8 offset:9216
    v_smfmac_f32_16x16x64_bf16 v[60:63], v[16:19], a[8:15], v1
    s_waitcnt lgkmcnt(2)
    s_barrier
    ds_read_b128 v[24:27], v11 offset:32768
    v_smfmac_f32_16x16x64_bf16 v[56:59], v[20:23], a[16:23], v1
    s_mov_b32 m0, s82
    ds_read_b128 v[28:31], v11 offset:33792
    buffer_load_dwordx4 v10, s[4:7], s67 offen sc1 lds
    v_smfmac_f32_16x16x64_bf16 v[60:63], v[20:23], a[24:31], v1
    ds_read_b128 v[32:35], v12 offset:32768
    v_smfmac_f32_16x16x64_bf16 v[64:67], v[16:19], a[128:135], v1
    ds_read_b128 v[36:39], v12 offset:33792
    buffer_load_dwordx4 v10, s[4:7], s67 offen offset:1024 sc1 lds
    v_smfmac_f32_16x16x64_bf16 v[68:71], v[16:19], a[136:143], v1
    s_mov_b32 m0, s83
    ds_read_b128 v[40:43], v77 offset:32768
    v_smfmac_f32_16x16x64_bf16 v[64:67], v[20:23], a[144:151], v1
    ds_read_b128 v[44:47], v77 offset:33792
    buffer_load_dwordx4 v10, s[4:7], s81 offen sc1 lds
    v_smfmac_f32_16x16x64_bf16 v[68:71], v[20:23], a[152:159], v1
    s_waitcnt lgkmcnt(5)
    ds_read_b128 v[88:91], v8 offset:10240
    v_smfmac_f32_16x16x64_bf16 v[48:51], v[24:27], v[128:135], v1
    ds_read_b128 v[92:95], v8 offset:11264
    buffer_load_dwordx4 v10, s[4:7], s81 offen offset:1024 sc1 lds
    v_lshlrev_b32 v76, 2, v0
    v_smfmac_f32_16x16x64_bf16 v[52:55], v[24:27], v[136:143], v1
    s_waitcnt lgkmcnt(6)
    s_add_u32 s73, s67, s77
    v_smfmac_f32_16x16x64_bf16 v[48:51], v[28:31], v[96:103], v1
    buffer_load_dword v78, v76, s[4:7], s73 offen sc1
    v_smfmac_f32_16x16x64_bf16 v[52:55], v[28:31], v[104:111], v1
    s_waitcnt lgkmcnt(5)
    ds_read_b128 v[96:99], v8 offset:12288
    v_smfmac_f32_16x16x64_bf16 v[48:51], v[32:35], v[144:151], v1
    ds_read_b128 v[100:103], v8 offset:13312
    v_smfmac_f32_16x16x64_bf16 v[52:55], v[32:35], v[152:159], v1
    s_waitcnt lgkmcnt(6)
    ds_read_b128 v[104:107], v8 offset:14336
    v_smfmac_f32_16x16x64_bf16 v[48:51], v[36:39], v[80:87], v1
    s_waitcnt lgkmcnt(3)
    ds_read_b128 v[108:111], v8 offset:15360
    v_smfmac_f32_16x16x64_bf16 v[52:55], v[36:39], v[88:95], v1
    buffer_store_dword v14, v3, s[4:7], s68 offen sc1
    v_smfmac_f32_16x16x64_bf16 v[48:51], v[40:43], v[160:167], v1
    v_smfmac_f32_16x16x64_bf16 v[52:55], v[40:43], v[168:175], v1
    s_waitcnt lgkmcnt(2)
    buffer_load_dword v78, off, s[4:7], s84 sc1
    v_smfmac_f32_16x16x64_bf16 v[48:51], v[44:47], v[96:103], v1
    s_waitcnt lgkmcnt(0)
    ds_read_b128 v[80:83], v79 offset:0
    v_smfmac_f32_16x16x64_bf16 v[52:55], v[44:47], v[104:111], v1
    ds_read_b128 v[84:87], v79 offset:4096
    v_smfmac_f32_16x16x64_bf16 v[56:59], v[24:27], a[32:39], v1
    s_nop 0
    ds_read_b128 v[88:91], v79 offset:1024
    v_smfmac_f32_16x16x64_bf16 v[56:59], v[28:31], a[48:55], v1
    s_nop 0
    ds_read_b128 v[92:95], v79 offset:5120
    v_smfmac_f32_16x16x64_bf16 v[56:59], v[32:35], a[64:71], v1
    ds_read_b128 v[96:99], v79 offset:2048
    v_add_f32 v48, v48, v49
    v_smfmac_f32_16x16x64_bf16 v[56:59], v[36:39], a[80:87], v1
    ds_read_b128 v[100:103], v79 offset:6144
    v_add_f32 v50, v50, v51
    v_smfmac_f32_16x16x64_bf16 v[56:59], v[40:43], a[96:103], v1
    ds_read_b128 v[104:107], v79 offset:3072
    v_add_f32 v52, v52, v53
    v_smfmac_f32_16x16x64_bf16 v[56:59], v[44:47], a[112:119], v1
    ds_read_b128 v[108:111], v79 offset:7168
    v_add_f32 v54, v54, v55
    v_smfmac_f32_16x16x64_bf16 v[60:63], v[24:27], a[40:47], v1
    buffer_store_dword v72, v3, s[4:7], s64 offen
    v_cvt_pk_bf16_f32 v49, v48, v52
    v_smfmac_f32_16x16x64_bf16 v[60:63], v[28:31], a[56:63], v1
    v_cvt_pk_bf16_f32 v51, v50, v54
    v_smfmac_f32_16x16x64_bf16 v[60:63], v[32:35], a[72:79], v1
    ds_write2_b32 v4, v49, v51 offset0:0 offset1:4
    v_smfmac_f32_16x16x64_bf16 v[60:63], v[36:39], a[88:95], v1
    v_add_f32 v56, v56, v57
    v_smfmac_f32_16x16x64_bf16 v[60:63], v[40:43], a[104:111], v1
    v_add_f32 v58, v58, v59
    v_smfmac_f32_16x16x64_bf16 v[60:63], v[44:47], a[120:127], v1
    s_nop 1
    v_mov_b64 v[72:73], 0
    v_smfmac_f32_16x16x64_bf16 v[64:67], v[24:27], a[160:167], v1
    s_nop 1
    v_mov_b64 v[74:75], 0
    v_smfmac_f32_16x16x64_bf16 v[68:71], v[24:27], a[168:175], v1
    s_nop 0
    v_add_f32 v60, v60, v61
    v_add_f32 v62, v62, v63
    v_cvt_pk_bf16_f32 v57, v56, v60
    v_cvt_pk_bf16_f32 v59, v58, v62
    v_smfmac_f32_16x16x64_bf16 v[64:67], v[28:31], a[176:183], v1
    ds_write2_b32 v6, v57, v59 offset0:0 offset1:8
    v_smfmac_f32_16x16x64_bf16 v[68:71], v[28:31], a[184:191], v1
    v_add_u32 v76, s76, v79
    v_smfmac_f32_16x16x64_bf16 v[64:67], v[32:35], a[192:199], v1
    v_xor_b32 v79, 0x4000, v79
    v_smfmac_f32_16x16x64_bf16 v[68:71], v[32:35], a[200:207], v1
    s_waitcnt vmcnt(8)
    v_smfmac_f32_16x16x64_bf16 v[64:67], v[36:39], a[208:215], v1
    s_waitcnt lgkmcnt(0)
    s_barrier
    ds_read_b128 v[24:27], v5 offset:0
    v_smfmac_f32_16x16x64_bf16 v[68:71], v[36:39], a[216:223], v1
    ds_read_b128 v[28:31], v5 offset:512
    v_mov_b32 v20, 0x3f803f80
    v_smfmac_f32_16x16x64_bf16 v[64:67], v[40:43], a[224:231], v1
    ds_read_b128 v[56:59], v0 offset:43008
    v_mov_b32 v21, 0x3f803f80
    v_smfmac_f32_16x16x64_bf16 v[68:71], v[40:43], a[232:239], v1
    ds_read_b128 v[32:35], v5 offset:1024
    v_mov_b64 v[22:23], v[20:21]
    v_smfmac_f32_16x16x64_bf16 v[64:67], v[44:47], a[240:247], v1
    ds_read_b128 v[36:39], v5 offset:1536
    v_mov_b32 v17, 0
    v_smfmac_f32_16x16x64_bf16 v[68:71], v[44:47], a[248:255], v1
    s_waitcnt lgkmcnt(4)
    ds_read_b128 v[60:63], v0 offset:44032
    v_mov_b32 v19, 0
    v_mfma_f32_16x16x32_bf16 v[48:51], v[80:83], v[24:27], 0
    ds_read_b128 v[40:43], v76 offset:8192
    v_mfma_f32_16x16x32_bf16 v[52:55], v[84:87], v[24:27], 0
    s_waitcnt lgkmcnt(5)
    ds_read_b128 v[44:47], v76 offset:9216
    v_mfma_f32_16x16x32_bf16 v[48:51], v[88:91], v[28:31], v[48:51]
    ds_read_b128 v[80:83], v9 offset:0
    v_add_f32 v64, v64, v65
    v_mfma_f32_16x16x32_bf16 v[52:55], v[92:95], v[28:31], v[52:55]
    s_waitcnt lgkmcnt(6)
    v_add_f32 v66, v66, v67
    v_add_f32 v68, v68, v69
    v_smfmac_f32_16x16x64_bf16 v[72:75], v[56:59], v[24:31], v1
    s_waitcnt lgkmcnt(5)
    ds_read_b128 v[84:87], v9 offset:1024
    v_add_f32 v70, v70, v71
    v_mfma_f32_16x16x32_bf16 v[48:51], v[96:99], v[32:35], v[48:51]
    s_waitcnt lgkmcnt(4)
    ds_read_b128 v[88:91], v9 offset:2048
    v_cvt_pk_bf16_f32 v14, v64, v66
    v_smfmac_f32_16x16x64_bf16 v[72:75], v[60:63], v[32:39], v1
    ds_read_b128 v[92:95], v9 offset:3072
    v_cvt_pk_bf16_f32 v18, v68, v70
    v_mfma_f32_16x16x32_bf16 v[48:51], v[104:107], v[36:39], v[48:51]
    s_nop 2
    v_mfma_f32_16x16x32_bf16 v[52:55], v[100:103], v[32:35], v[52:55]
    s_nop 0
    v_add_f32 v72, v72, v73
    v_add_f32 v73, v74, v75
    v_mfma_f32_16x16x32_bf16 v[52:55], v[108:111], v[36:39], v[52:55]
    ds_read_b128 v[96:99], v9 offset:4096
    ds_read_b128 v[100:103], v9 offset:5120
    v_max_f32 v76, v72, v73
    v_max3_f32 v76, v76, v48, v49
    v_max3_f32 v76, v76, v50, v51
    s_nop 2
    v_max3_f32 v76, v76, v52, v53
    v_max3_f32 v76, v76, v54, v55
    v_mov_b32 v77, v76
    s_nop 1
    v_permlane16_swap_b32 v76, v77
    v_max_f32 v76, v76, v77
    v_mov_b32 v77, v76
    s_nop 1
    v_permlane32_swap_b32 v76, v77
    v_max_f32 v76, v76, v77
    v_mul_f32 v76, s70, v76
    v_pk_fma_f32 v[72:73], v[72:73], s[90:91], v[76:77] op_sel_hi:[1,1,0]
    v_pk_fma_f32 v[48:49], v[48:49], s[90:91], v[76:77] op_sel_hi:[1,1,0]
    v_pk_fma_f32 v[50:51], v[50:51], s[90:91], v[76:77] op_sel_hi:[1,1,0]
    v_pk_fma_f32 v[52:53], v[52:53], s[90:91], v[76:77] op_sel_hi:[1,1,0]
    v_pk_fma_f32 v[54:55], v[54:55], s[90:91], v[76:77] op_sel_hi:[1,1,0]
    v_exp_f32 v72, v72
    v_exp_f32 v73, v73
    v_exp_f32 v48, v48
    v_exp_f32 v49, v49
    v_cvt_pk_bf16_f32 v16, v72, v73
    v_exp_f32 v50, v50
    v_exp_f32 v51, v51
    v_mfma_f32_16x16x16_bf16 v[64:67], v[20:21], v[16:17], 0
    v_exp_f32 v52, v52
    v_cvt_pk_bf16_f32 v24, v48, v49
    v_mfma_f32_16x16x16_bf16 v[56:59], v[14:15], v[16:17], 0
    v_exp_f32 v53, v53
    v_cvt_pk_bf16_f32 v25, v50, v51
    v_mfma_f32_16x16x16_bf16 v[60:63], v[18:19], v[16:17], 0
    v_exp_f32 v54, v54
    v_exp_f32 v55, v55
    v_cvt_pk_bf16_f32 v26, v52, v53
    v_cvt_pk_bf16_f32 v27, v54, v55
    s_nop 0
    s_waitcnt lgkmcnt(6)
    v_mfma_f32_16x16x32_bf16 v[64:67], v[20:23], v[24:27], v[64:67]
    s_nop 0
    ds_read_b128 v[104:107], v9 offset:6144
    v_mov_b64 v[48:49], 0
    v_mfma_f32_16x16x32_bf16 v[56:59], v[40:43], v[24:27], v[56:59]
    s_nop 0
    ds_read_b128 v[108:111], v9 offset:7168
    s_nop 0
    v_mfma_f32_16x16x32_bf16 v[60:63], v[44:47], v[24:27], v[60:63]
    s_mov_b64 exec, s[86:87]
    v_rcp_f32 v76, v64
    s_nop 1
    v_pk_mul_f32 v[56:57], v[56:57], v[76:77] op_sel_hi:[1,0]
    v_pk_mul_f32 v[58:59], v[58:59], v[76:77] op_sel_hi:[1,0]
    s_nop 1
    v_pk_mul_f32 v[60:61], v[60:61], v[76:77] op_sel_hi:[1,0]
    v_pk_mul_f32 v[62:63], v[62:63], v[76:77] op_sel_hi:[1,0]
    v_cvt_pk_bf16_f32 v72, v56, v60
    v_cvt_pk_bf16_f32 v73, v57, v61
    v_cvt_pk_bf16_f32 v74, v58, v62
    v_cvt_pk_bf16_f32 v75, v59, v63
    ds_write_b128 v7, v[72:75]
    s_mov_b64 exec, -1
    v_mfma_f32_32x32x8_bf16 v[16:31], v[48:49], v[48:49], 0
    v_mfma_f32_32x32x8_bf16 v[32:47], v[48:49], v[48:49], 0
    s_waitcnt lgkmcnt(0)
    s_barrier
    ds_read_b128 v[64:67], v13 offset:45568
    ds_read_b128 v[68:71], v13 offset:46592
    v_mfma_f32_32x32x8_bf16 v[32:47], v[48:49], v[48:49], 0
    s_add_u32 s66, s65, s75
    s_nop 1
    s_waitcnt lgkmcnt(1)
    v_smfmac_f32_16x16x64_bf16 v[16:19], v[64:67], v[176:183], v1
    s_waitcnt lgkmcnt(0)
    v_smfmac_f32_16x16x64_bf16 v[16:19], v[68:71], v[184:191], v1
    s_nop 0
    ds_read_b128 v[48:51], v9 offset:8192
    s_nop 0
    v_smfmac_f32_16x16x64_bf16 v[20:23], v[64:67], v[192:199], v1
    s_nop 0
    ds_read_b128 v[52:55], v9 offset:9216
    s_nop 0
    v_smfmac_f32_16x16x64_bf16 v[20:23], v[68:71], v[200:207], v1
    s_nop 0
    ds_read_b128 v[56:59], v9 offset:10240
    v_add_f32 v16, v16, v17
    v_smfmac_f32_16x16x64_bf16 v[24:27], v[64:67], v[208:215], v1
    s_nop 1
    v_add_f32 v18, v18, v19
    v_cvt_pk_bf16_f32 v16, v16, v18
    v_and_or_b32 v16, v16, -2, s89
    v_smfmac_f32_16x16x64_bf16 v[24:27], v[68:71], v[216:223], v1
    s_nop 0
    ds_read_b128 v[60:63], v9 offset:11264
    v_add_f32 v20, v20, v21
    v_smfmac_f32_16x16x64_bf16 v[28:31], v[64:67], v[224:231], v1
    s_nop 1
    v_add_f32 v22, v22, v23
    v_cvt_pk_bf16_f32 v17, v20, v22
    v_smfmac_f32_16x16x64_bf16 v[28:31], v[68:71], v[232:239], v1
    s_nop 0
    buffer_store_dwordx2 v[16:17], v2, s[4:7], s65 offen offset:0
    v_add_f32 v24, v24, v25
    v_smfmac_f32_16x16x64_bf16 v[32:35], v[64:67], v[240:247], v1
    s_nop 1
    v_add_f32 v26, v26, v27
    v_cvt_pk_bf16_f32 v24, v24, v26
    v_and_or_b32 v24, v24, -2, s89
    v_smfmac_f32_16x16x64_bf16 v[32:35], v[68:71], v[248:255], v1
    s_nop 1
    v_add_f32 v28, v28, v29
    v_smfmac_f32_16x16x64_bf16 v[36:39], v[64:67], v[80:87], v1
    s_nop 1
    v_add_f32 v30, v30, v31
    v_cvt_pk_bf16_f32 v25, v28, v30
    v_smfmac_f32_16x16x64_bf16 v[36:39], v[68:71], v[88:95], v1
    s_nop 0
    buffer_store_dwordx2 v[24:25], v2, s[4:7], s65 offen offset:2048
    v_add_f32 v32, v32, v33
    v_smfmac_f32_16x16x64_bf16 v[40:43], v[64:67], v[96:103], v1
    s_nop 1
    v_add_f32 v34, v34, v35
    v_cvt_pk_bf16_f32 v32, v32, v34
    v_and_or_b32 v32, v32, -2, s89
    v_smfmac_f32_16x16x64_bf16 v[40:43], v[68:71], v[104:111], v1
    s_waitcnt lgkmcnt(0)
    s_nop 0
    v_add_f32 v36, v36, v37
    v_smfmac_f32_16x16x64_bf16 v[44:47], v[64:67], v[48:55], v1
    s_nop 1
    v_add_f32 v38, v38, v39
    v_cvt_pk_bf16_f32 v33, v36, v38
    v_smfmac_f32_16x16x64_bf16 v[44:47], v[68:71], v[56:63], v1
    s_nop 0
    buffer_store_dwordx2 v[32:33], v2, s[4:7], s80 offen offset:0
    v_add_f32 v40, v40, v41
    v_add_f32 v42, v42, v43
    v_cvt_pk_bf16_f32 v40, v40, v42
    v_and_or_b32 v40, v40, -2, s89
    s_nop 1
    v_add_f32 v44, v44, v45
    v_add_f32 v46, v46, v47
    v_cvt_pk_bf16_f32 v41, v44, v46
    buffer_store_dwordx2 v[40:41], v2, s[4:7], s80 offen offset:2048
    s_cmp_eq_u32 s3, 0
    s_cbranch_scc1 L_v0f
    s_cmp_eq_u32 s3, 1
    s_cbranch_scc1 L_v1f
    s_cmp_eq_u32 s3, 2
    s_cbranch_scc1 L_v2f
L_v3f:
    ds_read_b128 v[20:23], v0 offset:47616
    s_sub_u32 s88, 0, s89
    s_mov_b32 s64, s62
    s_mov_b32 s62, s63
    s_add_u32 s63, s63, 8192
    s_and_b32 s63, s63, 0x7fff
    s_xor_b32 s65, s65, 0x40000
    s_xor_b32 s80, s80, 0x40000
    s_add_u32 s67, s67, 524288
    s_add_u32 s81, s67, 8192
    s_xor_b32 s82, s82, 0x4000
    s_xor_b32 s83, s83, 0x4000
    s_add_u32 s68, s68, 8192
    s_add_u32 s73, s61, 3
    s_lshr_b32 s78, s73, 2
    s_min_u32 s78, s78, 15
    s_mov_b32 s72, s84
    s_add_u32 s61, s61, 1
    s_bfe_u32 s89, s61, 0x10001
    s_add_u32 s73, s61, 3
    s_and_b32 s73, s73, 3
    s_lshl_b32 s73, s73, 2
    s_add_u32 s84, s73, s71
    s_nop 15
    s_nop 6
    s_nop 0
    buffer_load_dwordx4 v[24:27], v10, s[4:7], s66 offen sc1
    buffer_load_dwordx4 v[28:31], v10, s[4:7], s66 offen offset:1024 sc1
    s_nop 15
    s_nop 15
    s_nop 0
    buffer_load_dwordx4 v[40:43], v10, s[4:7], s66 offen sc1
    buffer_load_dwordx4 v[44:47], v10, s[4:7], s66 offen offset:1024 sc1
    .p2align 5
    s_waitcnt vmcnt(3) lgkmcnt(0)
    v_mfma_f32_16x16x32_bf16 v[36:39], v[20:23], v[24:27], 0
    v_bitop3_b32 v76, v24, v26, s88 bitop3:0x7e
    s_waitcnt vmcnt(2)
    v_mfma_f32_16x16x32_bf16 v[36:39], v[20:23], v[28:31], v[36:39]
    v_bitop3_b32 v77, v28, v30, s88 bitop3:0x7e
    v_bitop3_b32 v76, v76, v77, 1 bitop3:0xa8
    v_cmp_ne_u32 vcc, 0, v76
    v_readfirstlane_b32 s74, v78
    v_mov_b64 v[48:49], 0
    v_mov_b64 v[50:51], 0
    s_cbranch_vccnz L_rr3f
    s_nop 0
    v_add_f32_dpp v36, v36, v36 row_shr:4 row_mask:0xf bank_mask:0xf
    v_add_f32_dpp v37, v37, v37 row_shr:4 row_mask:0xf bank_mask:0xf
    s_nop 0
    v_add_f32_dpp v36, v36, v36 row_shr:8 row_mask:0xf bank_mask:0xf
    v_add_f32_dpp v37, v37, v37 row_shr:8 row_mask:0xf bank_mask:0xf
    v_cvt_pk_bf16_f32 v14, v36, v37
    buffer_store_dword v14, v3, s[4:7], s62 offen
L_rok3f:
    s_cmp_gt_u32 s74, s78
    s_cbranch_scc0 L_kvw3f
L_kvok3f:
    s_cmp_ge_u32 s61, 63
    s_cbranch_scc1 L_last
    s_mov_b32 s59, 1000000
    v_mov_b64 v[52:53], 0
    v_mov_b64 v[54:55], 0
    v_mov_b64 v[56:57], 0
    v_mov_b64 v[58:59], 0
    v_mov_b64 v[60:61], 0
    v_mov_b64 v[62:63], 0
    v_mov_b64 v[64:65], 0
    v_mov_b64 v[66:67], 0
    v_mov_b64 v[68:69], 0
    v_mov_b64 v[70:71], 0
    v_mov_b64 v[72:73], -1
    v_mov_b64 v[74:75], -1
    ds_read_b128 v[80:83], v8 offset:0
    ds_read_b128 v[84:87], v8 offset:1024
    ds_read_b128 v[88:91], v8 offset:2048
    ds_read_b128 v[92:95], v8 offset:3072
    ds_read_b128 v[96:99], v8 offset:4096
    ds_read_b128 v[100:103], v8 offset:5120
    ds_read_b128 v[104:107], v8 offset:6144
    ds_read_b128 v[108:111], v8 offset:7168
    s_nop 5
    buffer_load_dwordx4 v[16:19], v10, s[4:7], s62 offen sc1
    buffer_load_dwordx4 v[20:23], v10, s[4:7], s62 offen offset:1024 sc1
    s_nop 15
    s_nop 15
    s_nop 2
    buffer_load_dwordx4 v[16:19], v10, s[4:7], s62 offen sc1
    buffer_load_dwordx4 v[20:23], v10, s[4:7], s62 offen offset:1024 sc1
    s_branch L_gwf
    .p2align 6
L_rr3f:
    buffer_load_dwordx4 v[24:27], v10, s[4:7], s66 offen sc1
    buffer_load_dwordx4 v[28:31], v10, s[4:7], s66 offen offset:1024 sc1
    s_sub_u32 s59, s59, 1
    s_cbranch_scc1 L_fail
    s_waitcnt vmcnt(3) lgkmcnt(0)
    v_mfma_f32_16x16x32_bf16 v[36:39], v[20:23], v[40:43], 0
    v_bitop3_b32 v76, v40, v42, s88 bitop3:0x7e
    s_waitcnt vmcnt(2)
    v_mfma_f32_16x16x32_bf16 v[36:39], v[20:23], v[44:47], v[36:39]
    v_bitop3_b32 v77, v44, v46, s88 bitop3:0x7e
    v_bitop3_b32 v76, v76, v77, 1 bitop3:0xa8
    v_cmp_ne_u32 vcc, 0, v76
    v_readfirstlane_b32 s74, v78
    v_mov_b64 v[48:49], 0
    v_mov_b64 v[50:51], 0
    s_cbranch_vccnz L_rs3f
    s_nop 0
    v_add_f32_dpp v36, v36, v36 row_shr:4 row_mask:0xf bank_mask:0xf
    v_add_f32_dpp v37, v37, v37 row_shr:4 row_mask:0xf bank_mask:0xf
    s_nop 0
    v_add_f32_dpp v36, v36, v36 row_shr:8 row_mask:0xf bank_mask:0xf
    v_add_f32_dpp v37, v37, v37 row_shr:8 row_mask:0xf bank_mask:0xf
    v_cvt_pk_bf16_f32 v14, v36, v37
    buffer_store_dword v14, v3, s[4:7], s62 offen
    s_branch L_rok3f
    .p2align 6
L_rs3f:
    buffer_load_dwordx4 v[40:43], v10, s[4:7], s66 offen sc1
    buffer_load_dwordx4 v[44:47], v10, s[4:7], s66 offen offset:1024 sc1
    s_sub_u32 s59, s59, 1
    s_cbranch_scc1 L_fail
    s_waitcnt vmcnt(3) lgkmcnt(0)
    v_mfma_f32_16x16x32_bf16 v[36:39], v[20:23], v[24:27], 0
    v_bitop3_b32 v76, v24, v26, s88 bitop3:0x7e
    s_waitcnt vmcnt(2)
    v_mfma_f32_16x16x32_bf16 v[36:39], v[20:23], v[28:31], v[36:39]
    v_bitop3_b32 v77, v28, v30, s88 bitop3:0x7e
    v_bitop3_b32 v76, v76, v77, 1 bitop3:0xa8
    v_cmp_ne_u32 vcc, 0, v76
    v_readfirstlane_b32 s74, v78
    v_mov_b64 v[48:49], 0
    v_mov_b64 v[50:51], 0
    s_cbranch_vccnz L_rr3f
    s_nop 0
    v_add_f32_dpp v36, v36, v36 row_shr:4 row_mask:0xf bank_mask:0xf
    v_add_f32_dpp v37, v37, v37 row_shr:4 row_mask:0xf bank_mask:0xf
    s_nop 0
    v_add_f32_dpp v36, v36, v36 row_shr:8 row_mask:0xf bank_mask:0xf
    v_add_f32_dpp v37, v37, v37 row_shr:8 row_mask:0xf bank_mask:0xf
    v_cvt_pk_bf16_f32 v14, v36, v37
    buffer_store_dword v14, v3, s[4:7], s62 offen
    s_branch L_rok3f
L_kvw3f:
    buffer_load_dword v78, off, s[4:7], s72 sc1
    s_sub_u32 s59, s59, 1
    s_cbranch_scc1 L_fail
    s_waitcnt vmcnt(0)
    v_readfirstlane_b32 s74, v78
    s_nop 0
    s_cmp_gt_u32 s74, s78
    s_cbranch_scc0 L_kvw3f
    s_branch L_kvok3f
L_v2f:
    ds_read_b128 v[20:23], v0 offset:47616
    s_sub_u32 s88, 0, s89
    s_mov_b32 s64, s62
    s_mov_b32 s62, s63
    s_add_u32 s63, s63, 8192
    s_and_b32 s63, s63, 0x7fff
    s_xor_b32 s65, s65, 0x40000
    s_xor_b32 s80, s80, 0x40000
    s_add_u32 s67, s67, 524288
    s_add_u32 s81, s67, 8192
    s_xor_b32 s82, s82, 0x4000
    s_xor_b32 s83, s83, 0x4000
    s_add_u32 s68, s68, 8192
    s_add_u32 s73, s61, 3
    s_lshr_b32 s78, s73, 2
    s_min_u32 s78, s78, 15
    s_mov_b32 s72, s84
    s_add_u32 s61, s61, 1
    s_bfe_u32 s89, s61, 0x10001
    s_add_u32 s73, s61, 3
    s_and_b32 s73, s73, 3
    s_lshl_b32 s73, s73, 2
    s_add_u32 s84, s73, s71
    s_nop 13
    s_nop 0
    buffer_load_dwordx4 v[24:27], v10, s[4:7], s66 offen sc1
    buffer_load_dwordx4 v[28:31], v10, s[4:7], s66 offen offset:1024 sc1
    s_nop 15
    s_nop 15
    s_nop 0
    buffer_load_dwordx4 v[40:43], v10, s[4:7], s66 offen sc1
    buffer_load_dwordx4 v[44:47], v10, s[4:7], s66 offen offset:1024 sc1
    .p2align 5
    s_waitcnt vmcnt(3) lgkmcnt(0)
    v_mfma_f32_16x16x32_bf16 v[36:39], v[20:23], v[24:27], 0
    v_bitop3_b32 v76, v24, v26, s88 bitop3:0x7e
    s_waitcnt vmcnt(2)
    v_mfma_f32_16x16x32_bf16 v[36:39], v[20:23], v[28:31], v[36:39]
    v_bitop3_b32 v77, v28, v30, s88 bitop3:0x7e
    v_bitop3_b32 v76, v76, v77, 1 bitop3:0xa8
    v_cmp_ne_u32 vcc, 0, v76
    v_readfirstlane_b32 s74, v78
    v_mov_b64 v[48:49], 0
    v_mov_b64 v[50:51], 0
    s_cbranch_vccnz L_rr2f
    s_nop 0
    v_add_f32_dpp v36, v36, v36 row_shr:4 row_mask:0xf bank_mask:0xf
    v_add_f32_dpp v37, v37, v37 row_shr:4 row_mask:0xf bank_mask:0xf
    s_nop 0
    v_add_f32_dpp v36, v36, v36 row_shr:8 row_mask:0xf bank_mask:0xf
    v_add_f32_dpp v37, v37, v37 row_shr:8 row_mask:0xf bank_mask:0xf
    v_cvt_pk_bf16_f32 v14, v36, v37
    buffer_store_dword v14, v3, s[4:7], s62 offen
L_rok2f:
    s_cmp_gt_u32 s74, s78
    s_cbranch_scc0 L_kvw2f
L_kvok2f:
    s_cmp_ge_u32 s61, 63
    s_cbranch_scc1 L_last
    s_mov_b32 s59, 1000000
    v_mov_b64 v[52:53], 0
    v_mov_b64 v[54:55], 0
    v_mov_b64 v[56:57], 0
    v_mov_b64 v[58:59], 0
    v_mov_b64 v[60:61], 0
    v_mov_b64 v[62:63], 0
    v_mov_b64 v[64:65], 0
    v_mov_b64 v[66:67], 0
    v_mov_b64 v[68:69], 0
    v_mov_b64 v[70:71], 0
    v_mov_b64 v[72:73], -1
    v_mov_b64 v[74:75], -1
    ds_read_b128 v[80:83], v8 offset:0
    ds_read_b128 v[84:87], v8 offset:1024
    ds_read_b128 v[88:91], v8 offset:2048
    ds_read_b128 v[92:95], v8 offset:3072
    ds_read_b128 v[96:99], v8 offset:4096
    ds_read_b128 v[100:103], v8 offset:5120
    ds_read_b128 v[104:107], v8 offset:6144
    ds_read_b128 v[108:111], v8 offset:7168
    s_nop 5
    s_nop 0
    buffer_load_dwordx4 v[16:19], v10, s[4:7], s62 offen sc1
    buffer_load_dwordx4 v[20:23], v10, s[4:7], s62 offen offset:1024 sc1
    s_nop 15
    s_nop 15
    s_nop 3
    buffer_load_dwordx4 v[16:19], v10, s[4:7], s62 offen sc1
    buffer_load_dwordx4 v[20:23], v10, s[4:7], s62 offen offset:1024 sc1
    s_branch L_gwf
    .p2align 6
L_rr2f:
    buffer_load_dwordx4 v[24:27], v10, s[4:7], s66 offen sc1
    buffer_load_dwordx4 v[28:31], v10, s[4:7], s66 offen offset:1024 sc1
    s_sub_u32 s59, s59, 1
    s_cbranch_scc1 L_fail
    s_waitcnt vmcnt(3) lgkmcnt(0)
    v_mfma_f32_16x16x32_bf16 v[36:39], v[20:23], v[40:43], 0
    v_bitop3_b32 v76, v40, v42, s88 bitop3:0x7e
    s_waitcnt vmcnt(2)
    v_mfma_f32_16x16x32_bf16 v[36:39], v[20:23], v[44:47], v[36:39]
    v_bitop3_b32 v77, v44, v46, s88 bitop3:0x7e
    v_bitop3_b32 v76, v76, v77, 1 bitop3:0xa8
    v_cmp_ne_u32 vcc, 0, v76
    v_readfirstlane_b32 s74, v78
    v_mov_b64 v[48:49], 0
    v_mov_b64 v[50:51], 0
    s_cbranch_vccnz L_rs2f
    s_nop 0
    v_add_f32_dpp v36, v36, v36 row_shr:4 row_mask:0xf bank_mask:0xf
    v_add_f32_dpp v37, v37, v37 row_shr:4 row_mask:0xf bank_mask:0xf
    s_nop 0
    v_add_f32_dpp v36, v36, v36 row_shr:8 row_mask:0xf bank_mask:0xf
    v_add_f32_dpp v37, v37, v37 row_shr:8 row_mask:0xf bank_mask:0xf
    v_cvt_pk_bf16_f32 v14, v36, v37
    buffer_store_dword v14, v3, s[4:7], s62 offen
    s_branch L_rok2f
    .p2align 6
L_rs2f:
    buffer_load_dwordx4 v[40:43], v10, s[4:7], s66 offen sc1
    buffer_load_dwordx4 v[44:47], v10, s[4:7], s66 offen offset:1024 sc1
    s_sub_u32 s59, s59, 1
    s_cbranch_scc1 L_fail
    s_waitcnt vmcnt(3) lgkmcnt(0)
    v_mfma_f32_16x16x32_bf16 v[36:39], v[20:23], v[24:27], 0
    v_bitop3_b32 v76, v24, v26, s88 bitop3:0x7e
    s_waitcnt vmcnt(2)
    v_mfma_f32_16x16x32_bf16 v[36:39], v[20:23], v[28:31], v[36:39]
    v_bitop3_b32 v77, v28, v30, s88 bitop3:0x7e
    v_bitop3_b32 v76, v76, v77, 1 bitop3:0xa8
    v_cmp_ne_u32 vcc, 0, v76
    v_readfirstlane_b32 s74, v78
    v_mov_b64 v[48:49], 0
    v_mov_b64 v[50:51], 0
    s_cbranch_vccnz L_rr2f
    s_nop 0
    v_add_f32_dpp v36, v36, v36 row_shr:4 row_mask:0xf bank_mask:0xf
    v_add_f32_dpp v37, v37, v37 row_shr:4 row_mask:0xf bank_mask:0xf
    s_nop 0
    v_add_f32_dpp v36, v36, v36 row_shr:8 row_mask:0xf bank_mask:0xf
    v_add_f32_dpp v37, v37, v37 row_shr:8 row_mask:0xf bank_mask:0xf
    v_cvt_pk_bf16_f32 v14, v36, v37
    buffer_store_dword v14, v3, s[4:7], s62 offen
    s_branch L_rok2f
L_kvw2f:
    buffer_load_dword v78, off, s[4:7], s72 sc1
    s_sub_u32 s59, s59, 1
    s_cbranch_scc1 L_fail
    s_waitcnt vmcnt(0)
    v_readfirstlane_b32 s74, v78
    s_nop 0
    s_cmp_gt_u32 s74, s78
    s_cbranch_scc0 L_kvw2f
    s_branch L_kvok2f
L_v1f:
    ds_read_b128 v[20:23], v0 offset:47616
    s_sub_u32 s88, 0, s89
    s_mov_b32 s64, s62
    s_mov_b32 s62, s63
    s_add_u32 s63, s63, 8192
    s_and_b32 s63, s63, 0x7fff
    s_xor_b32 s65, s65, 0x40000
    s_xor_b32 s80, s80, 0x40000
    s_add_u32 s67, s67, 524288
    s_add_u32 s81, s67, 8192
    s_xor_b32 s82, s82, 0x4000
    s_xor_b32 s83, s83, 0x4000
    s_add_u32 s68, s68, 8192
    s_add_u32 s73, s61, 3
    s_lshr_b32 s78, s73, 2
    s_min_u32 s78, s78, 15
    s_mov_b32 s72, s84
    s_add_u32 s61, s61, 1
    s_bfe_u32 s89, s61, 0x10001
    s_add_u32 s73, s61, 3
    s_and_b32 s73, s73, 3
    s_lshl_b32 s73, s73, 2
    s_add_u32 s84, s73, s71
    s_nop 6
    s_nop 0
    buffer_load_dwordx4 v[24:27], v10, s[4:7], s66 offen sc1
    buffer_load_dwordx4 v[28:31], v10, s[4:7], s66 offen offset:1024 sc1
    s_nop 15
    s_nop 11
    buffer_load_dwordx4 v[40:43], v10, s[4:7], s66 offen sc1
    buffer_load_dwordx4 v[44:47], v10, s[4:7], s66 offen offset:1024 sc1
    .p2align 5
    s_waitcnt vmcnt(3) lgkmcnt(0)
    v_mfma_f32_16x16x32_bf16 v[36:39], v[20:23], v[24:27], 0
    v_bitop3_b32 v76, v24, v26, s88 bitop3:0x7e
    s_waitcnt vmcnt(2)
    v_mfma_f32_16x16x32_bf16 v[36:39], v[20:23], v[28:31], v[36:39]
    v_bitop3_b32 v77, v28, v30, s88 bitop3:0x7e
    v_bitop3_b32 v76, v76, v77, 1 bitop3:0xa8
    v_cmp_ne_u32 vcc, 0, v76
    v_readfirstlane_b32 s74, v78
    v_mov_b64 v[48:49], 0
    v_mov_b64 v[50:51], 0
    s_cbranch_vccnz L_rr1f
    s_nop 0
    v_add_f32_dpp v36, v36, v36 row_shr:4 row_mask:0xf bank_mask:0xf
    v_add_f32_dpp v37, v37, v37 row_shr:4 row_mask:0xf bank_mask:0xf
    s_nop 0
    v_add_f32_dpp v36, v36, v36 row_shr:8 row_mask:0xf bank_mask:0xf
    v_add_f32_dpp v37, v37, v37 row_shr:8 row_mask:0xf bank_mask:0xf
    v_cvt_pk_bf16_f32 v14, v36, v37
    buffer_store_dword v14, v3, s[4:7], s62 offen
L_rok1f:
    s_cmp_gt_u32 s74, s78
    s_cbranch_scc0 L_kvw1f
L_kvok1f:
    s_cmp_ge_u32 s61, 63
    s_cbranch_scc1 L_last
    s_mov_b32 s59, 1000000
    v_mov_b64 v[52:53], 0
    v_mov_b64 v[54:55], 0
    v_mov_b64 v[56:57], 0
    v_mov_b64 v[58:59], 0
    v_mov_b64 v[60:61], 0
    v_mov_b64 v[62:63], 0
    v_mov_b64 v[64:65], 0
    v_mov_b64 v[66:67], 0
    v_mov_b64 v[68:69], 0
    v_mov_b64 v[70:71], 0
    v_mov_b64 v[72:73], -1
    v_mov_b64 v[74:75], -1
    ds_read_b128 v[80:83], v8 offset:0
    ds_read_b128 v[84:87], v8 offset:1024
    ds_read_b128 v[88:91], v8 offset:2048
    ds_read_b128 v[92:95], v8 offset:3072
    ds_read_b128 v[96:99], v8 offset:4096
    ds_read_b128 v[100:103], v8 offset:5120
    ds_read_b128 v[104:107], v8 offset:6144
    ds_read_b128 v[108:111], v8 offset:7168
    s_nop 6
    buffer_load_dwordx4 v[16:19], v10, s[4:7], s62 offen sc1
    buffer_load_dwordx4 v[20:23], v10, s[4:7], s62 offen offset:1024 sc1
    s_nop 15
    s_nop 15
    s_nop 1
    buffer_load_dwordx4 v[16:19], v10, s[4:7], s62 offen sc1
    buffer_load_dwordx4 v[20:23], v10, s[4:7], s62 offen offset:1024 sc1
    s_branch L_gwf
    .p2align 6
L_rr1f:
    buffer_load_dwordx4 v[24:27], v10, s[4:7], s66 offen sc1
    buffer_load_dwordx4 v[28:31], v10, s[4:7], s66 offen offset:1024 sc1
    s_sub_u32 s59, s59, 1
    s_cbranch_scc1 L_fail
    s_waitcnt vmcnt(3) lgkmcnt(0)
    v_mfma_f32_16x16x32_bf16 v[36:39], v[20:23], v[40:43], 0
    v_bitop3_b32 v76, v40, v42, s88 bitop3:0x7e
    s_waitcnt vmcnt(2)
    v_mfma_f32_16x16x32_bf16 v[36:39], v[20:23], v[44:47], v[36:39]
    v_bitop3_b32 v77, v44, v46, s88 bitop3:0x7e
    v_bitop3_b32 v76, v76, v77, 1 bitop3:0xa8
    v_cmp_ne_u32 vcc, 0, v76
    v_readfirstlane_b32 s74, v78
    v_mov_b64 v[48:49], 0
    v_mov_b64 v[50:51], 0
    s_cbranch_vccnz L_rs1f
    s_nop 0
    v_add_f32_dpp v36, v36, v36 row_shr:4 row_mask:0xf bank_mask:0xf
    v_add_f32_dpp v37, v37, v37 row_shr:4 row_mask:0xf bank_mask:0xf
    s_nop 0
    v_add_f32_dpp v36, v36, v36 row_shr:8 row_mask:0xf bank_mask:0xf
    v_add_f32_dpp v37, v37, v37 row_shr:8 row_mask:0xf bank_mask:0xf
    v_cvt_pk_bf16_f32 v14, v36, v37
    buffer_store_dword v14, v3, s[4:7], s62 offen
    s_branch L_rok1f
    .p2align 6
L_rs1f:
    buffer_load_dwordx4 v[40:43], v10, s[4:7], s66 offen sc1
    buffer_load_dwordx4 v[44:47], v10, s[4:7], s66 offen offset:1024 sc1
    s_sub_u32 s59, s59, 1
    s_cbranch_scc1 L_fail
    s_waitcnt vmcnt(3) lgkmcnt(0)
    v_mfma_f32_16x16x32_bf16 v[36:39], v[20:23], v[24:27], 0
    v_bitop3_b32 v76, v24, v26, s88 bitop3:0x7e
    s_waitcnt vmcnt(2)
    v_mfma_f32_16x16x32_bf16 v[36:39], v[20:23], v[28:31], v[36:39]
    v_bitop3_b32 v77, v28, v30, s88 bitop3:0x7e
    v_bitop3_b32 v76, v76, v77, 1 bitop3:0xa8
    v_cmp_ne_u32 vcc, 0, v76
    v_readfirstlane_b32 s74, v78
    v_mov_b64 v[48:49], 0
    v_mov_b64 v[50:51], 0
    s_cbranch_vccnz L_rr1f
    s_nop 0
    v_add_f32_dpp v36, v36, v36 row_shr:4 row_mask:0xf bank_mask:0xf
    v_add_f32_dpp v37, v37, v37 row_shr:4 row_mask:0xf bank_mask:0xf
    s_nop 0
    v_add_f32_dpp v36, v36, v36 row_shr:8 row_mask:0xf bank_mask:0xf
    v_add_f32_dpp v37, v37, v37 row_shr:8 row_mask:0xf bank_mask:0xf
    v_cvt_pk_bf16_f32 v14, v36, v37
    buffer_store_dword v14, v3, s[4:7], s62 offen
    s_branch L_rok1f
L_kvw1f:
    buffer_load_dword v78, off, s[4:7], s72 sc1
    s_sub_u32 s59, s59, 1
    s_cbranch_scc1 L_fail
    s_waitcnt vmcnt(0)
    v_readfirstlane_b32 s74, v78
    s_nop 0
    s_cmp_gt_u32 s74, s78
    s_cbranch_scc0 L_kvw1f
    s_branch L_kvok1f
L_v0f:
    ds_read_b128 v[20:23], v0 offset:47616
    s_sub_u32 s88, 0, s89
    s_mov_b32 s64, s62
    s_mov_b32 s62, s63
    s_add_u32 s63, s63, 8192
    s_and_b32 s63, s63, 0x7fff
    s_xor_b32 s65, s65, 0x40000
    s_xor_b32 s80, s80, 0x40000
    s_add_u32 s67, s67, 524288
    s_add_u32 s81, s67, 8192
    s_xor_b32 s82, s82, 0x4000
    s_xor_b32 s83, s83, 0x4000
    s_add_u32 s68, s68, 8192
    s_add_u32 s73, s61, 3
    s_lshr_b32 s78, s73, 2
    s_min_u32 s78, s78, 15
    s_mov_b32 s72, s84
    s_add_u32 s61, s61, 1
    s_bfe_u32 s89, s61, 0x10001
    s_add_u32 s73, s61, 3
    s_and_b32 s73, s73, 3
    s_lshl_b32 s73, s73, 2
    s_add_u32 s84, s73, s71
    buffer_load_dwordx4 v[24:27], v10, s[4:7], s66 offen sc1
    buffer_load_dwordx4 v[28:31], v10, s[4:7], s66 offen offset:1024 sc1
    s_nop 15
    s_nop 15
    s_nop 1
    buffer_load_dwordx4 v[40:43], v10, s[4:7], s66 offen sc1
    buffer_load_dwordx4 v[44:47], v10, s[4:7], s66 offen offset:1024 sc1
    .p2align 5
    s_waitcnt vmcnt(3) lgkmcnt(0)
    v_mfma_f32_16x16x32_bf16 v[36:39], v[20:23], v[24:27], 0
    v_bitop3_b32 v76, v24, v26, s88 bitop3:0x7e
    s_waitcnt vmcnt(2)
    v_mfma_f32_16x16x32_bf16 v[36:39], v[20:23], v[28:31], v[36:39]
    v_bitop3_b32 v77, v28, v30, s88 bitop3:0x7e
    v_bitop3_b32 v76, v76, v77, 1 bitop3:0xa8
    v_cmp_ne_u32 vcc, 0, v76
    v_readfirstlane_b32 s74, v78
    v_mov_b64 v[48:49], 0
    v_mov_b64 v[50:51], 0
    s_cbranch_vccnz L_rr0f
    s_nop 0
    v_add_f32_dpp v36, v36, v36 row_shr:4 row_mask:0xf bank_mask:0xf
    v_add_f32_dpp v37, v37, v37 row_shr:4 row_mask:0xf bank_mask:0xf
    s_nop 0
    v_add_f32_dpp v36, v36, v36 row_shr:8 row_mask:0xf bank_mask:0xf
    v_add_f32_dpp v37, v37, v37 row_shr:8 row_mask:0xf bank_mask:0xf
    v_cvt_pk_bf16_f32 v14, v36, v37
    buffer_store_dword v14, v3, s[4:7], s62 offen
L_rok0f:
    s_cmp_gt_u32 s74, s78
    s_cbranch_scc0 L_kvw0f
L_kvok0f:
    s_cmp_ge_u32 s61, 63
    s_cbranch_scc1 L_last
    s_mov_b32 s59, 1000000
    v_mov_b64 v[52:53], 0
    v_mov_b64 v[54:55], 0
    v_mov_b64 v[56:57], 0
    v_mov_b64 v[58:59], 0
    v_mov_b64 v[60:61], 0
    v_mov_b64 v[62:63], 0
    v_mov_b64 v[64:65], 0
    v_mov_b64 v[66:67], 0
    v_mov_b64 v[68:69], 0
    v_mov_b64 v[70:71], 0
    v_mov_b64 v[72:73], -1
    v_mov_b64 v[74:75], -1
    ds_read_b128 v[80:83], v8 offset:0
    ds_read_b128 v[84:87], v8 offset:1024
    ds_read_b128 v[88:91], v8 offset:2048
    ds_read_b128 v[92:95], v8 offset:3072
    ds_read_b128 v[96:99], v8 offset:4096
    ds_read_b128 v[100:103], v8 offset:5120
    ds_read_b128 v[104:107], v8 offset:6144
    ds_read_b128 v[108:111], v8 offset:7168
    s_nop 4
    buffer_load_dwordx4 v[16:19], v10, s[4:7], s62 offen sc1
    buffer_load_dwordx4 v[20:23], v10, s[4:7], s62 offen offset:1024 sc1
    s_nop 15
    s_nop 15
    s_nop 1
    buffer_load_dwordx4 v[16:19], v10, s[4:7], s62 offen sc1
    buffer_load_dwordx4 v[20:23], v10, s[4:7], s62 offen offset:1024 sc1
    s_branch L_gwf
    .p2align 6
L_rr0f:
    buffer_load_dwordx4 v[24:27], v10, s[4:7], s66 offen sc1
    buffer_load_dwordx4 v[28:31], v10, s[4:7], s66 offen offset:1024 sc1
    s_sub_u32 s59, s59, 1
    s_cbranch_scc1 L_fail
    s_waitcnt vmcnt(3) lgkmcnt(0)
    v_mfma_f32_16x16x32_bf16 v[36:39], v[20:23], v[40:43], 0
    v_bitop3_b32 v76, v40, v42, s88 bitop3:0x7e
    s_waitcnt vmcnt(2)
    v_mfma_f32_16x16x32_bf16 v[36:39], v[20:23], v[44:47], v[36:39]
    v_bitop3_b32 v77, v44, v46, s88 bitop3:0x7e
    v_bitop3_b32 v76, v76, v77, 1 bitop3:0xa8
    v_cmp_ne_u32 vcc, 0, v76
    v_readfirstlane_b32 s74, v78
    v_mov_b64 v[48:49], 0
    v_mov_b64 v[50:51], 0
    s_cbranch_vccnz L_rs0f
    s_nop 0
    v_add_f32_dpp v36, v36, v36 row_shr:4 row_mask:0xf bank_mask:0xf
    v_add_f32_dpp v37, v37, v37 row_shr:4 row_mask:0xf bank_mask:0xf
    s_nop 0
    v_add_f32_dpp v36, v36, v36 row_shr:8 row_mask:0xf bank_mask:0xf
    v_add_f32_dpp v37, v37, v37 row_shr:8 row_mask:0xf bank_mask:0xf
    v_cvt_pk_bf16_f32 v14, v36, v37
    buffer_store_dword v14, v3, s[4:7], s62 offen
    s_branch L_rok0f
    .p2align 6
L_rs0f:
    buffer_load_dwordx4 v[40:43], v10, s[4:7], s66 offen sc1
    buffer_load_dwordx4 v[44:47], v10, s[4:7], s66 offen offset:1024 sc1
    s_sub_u32 s59, s59, 1
    s_cbranch_scc1 L_fail
    s_waitcnt vmcnt(3) lgkmcnt(0)
    v_mfma_f32_16x16x32_bf16 v[36:39], v[20:23], v[24:27], 0
    v_bitop3_b32 v76, v24, v26, s88 bitop3:0x7e
    s_waitcnt vmcnt(2)
    v_mfma_f32_16x16x32_bf16 v[36:39], v[20:23], v[28:31], v[36:39]
    v_bitop3_b32 v77, v28, v30, s88 bitop3:0x7e
    v_bitop3_b32 v76, v76, v77, 1 bitop3:0xa8
    v_cmp_ne_u32 vcc, 0, v76
    v_readfirstlane_b32 s74, v78
    v_mov_b64 v[48:49], 0
    v_mov_b64 v[50:51], 0
    s_cbranch_vccnz L_rr0f
    s_nop 0
    v_add_f32_dpp v36, v36, v36 row_shr:4 row_mask:0xf bank_mask:0xf
    v_add_f32_dpp v37, v37, v37 row_shr:4 row_mask:0xf bank_mask:0xf
    s_nop 0
    v_add_f32_dpp v36, v36, v36 row_shr:8 row_mask:0xf bank_mask:0xf
    v_add_f32_dpp v37, v37, v37 row_shr:8 row_mask:0xf bank_mask:0xf
    v_cvt_pk_bf16_f32 v14, v36, v37
    buffer_store_dword v14, v3, s[4:7], s62 offen
    s_branch L_rok0f
L_kvw0f:
    buffer_load_dword v78, off, s[4:7], s72 sc1
    s_sub_u32 s59, s59, 1
    s_cbranch_scc1 L_fail
    s_waitcnt vmcnt(0)
    v_readfirstlane_b32 s74, v78
    s_nop 0
    s_cmp_gt_u32 s74, s78
    s_cbranch_scc0 L_kvw0f
    s_branch L_kvok0f
    .p2align 6
L_grf:
    buffer_load_dwordx4 v[16:19], v10, s[4:7], s62 offen sc1
    buffer_load_dwordx4 v[20:23], v10, s[4:7], s62 offen offset:1024 sc1
    s_nop 1
    v_mov_b64 v[48:49], 0
    v_mov_b64 v[50:51], 0
    v_mov_b64 v[52:53], 0
    v_mov_b64 v[54:55], 0
    s_sub_u32 s59, s59, 1
    s_cbranch_scc0 L_gwf
    s_branch L_fail
L_step_slow:
    v_mov_b64 v[48:49], 0
    v_mov_b64 v[50:51], 0
    v_mov_b64 v[52:53], 0
    v_mov_b64 v[54:55], 0
    v_mov_b64 v[56:57], 0
    v_mov_b64 v[58:59], 0
    v_mov_b64 v[60:61], 0
    v_mov_b64 v[62:63], 0
    v_mov_b64 v[64:65], 0
    v_mov_b64 v[66:67], 0
    v_mov_b64 v[68:69], 0
    v_mov_b64 v[70:71], 0
    v_mov_b64 v[72:73], -1
    v_mov_b64 v[74:75], -1
    s_mov_b32 s59, 1000000
    s_waitcnt vmcnt(0)
    .p2align 6
    s_nop 0
    s_nop 0
    s_nop 0
    s_nop 0
    s_nop 0
    s_nop 0
L_gws:
    s_waitcnt vmcnt(3) lgkmcnt(0)
    v_max3_u32 v76, v16, v17, v18
    v_max_u32 v76, v76, v19
    s_waitcnt vmcnt(2)
    v_max3_u32 v76, v76, v20, v21
    v_max3_u32 v76, v76, v22, v23
    v_cmp_eq_u32 vcc, -1, v76
    v_smfmac_f32_16x16x64_bf16 v[48:51], v[16:19], v[112:119], v1
    ds_write_b128 v10, v[16:19] offset:32768
    v_smfmac_f32_16x16x64_bf16 v[52:55], v[16:19], v[120:127], v1
    ds_write_b128 v10, v[20:23] offset:33792
    s_cbranch_vccnz L_grs
    v_smfmac_f32_16x16x64_bf16 v[48:51], v[20:23], v[80:87], v1
    v_xor_b32 v77, 6144, v10
    v_smfmac_f32_16x16x64_bf16 v[52:55], v[20:23], v[88:95], v1
    ds_read_b128 v[80:83], v8 offset:8192
    v_smfmac_f32_16x16x64_bf16 v[56:59], v[16:19], a[0:7], v1
    ds_read_b128 v[84:87], v8 offset:9216
    v_smfmac_f32_16x16x64_bf16 v[60:63], v[16:19], a[8:15], v1
    s_waitcnt lgkmcnt(2)
    s_barrier
    ds_read_b128 v[24:27], v11 offset:32768
    v_smfmac_f32_16x16x64_bf16 v[56:59], v[20:23], a[16:23], v1
    s_mov_b32 m0, s82
    ds_read_b128 v[28:31], v11 offset:33792
    buffer_load_dwordx4 v10, s[4:7], s67 offen sc1 lds
    v_smfmac_f32_16x16x64_bf16 v[60:63], v[20:23], a[24:31], v1
    ds_read_b128 v[32:35], v12 offset:32768
    v_smfmac_f32_16x16x64_bf16 v[64:67], v[16:19], a[128:135], v1
    ds_read_b128 v[36:39], v12 offset:33792
    buffer_load_dwordx4 v10, s[4:7], s67 offen offset:1024 sc1 lds
    v_smfmac_f32_16x16x64_bf16 v[68:71], v[16:19], a[136:143], v1
    s_mov_b32 m0, s83
    ds_read_b128 v[40:43], v77 offset:32768
    v_smfmac_f32_16x16x64_bf16 v[64:67], v[20:23], a[144:151], v1
    ds_read_b128 v[44:47], v77 offset:33792
    buffer_load_dwordx4 v10, s[4:7], s81 offen sc1 lds
    v_smfmac_f32_16x16x64_bf16 v[68:71], v[20:23], a[152:159], v1
    s_waitcnt lgkmcnt(5)
    ds_read_b128 v[88:91], v8 offset:10240
    v_smfmac_f32_16x16x64_bf16 v[48:51], v[24:27], v[128:135], v1
    ds_read_b128 v[92:95], v8 offset:11264
    buffer_load_dwordx4 v10, s[4:7], s81 offen offset:1024 sc1 lds
    v_lshlrev_b32 v76, 2, v0
    v_smfmac_f32_16x16x64_bf16 v[52:55], v[24:27], v[136:143], v1
    s_waitcnt lgkmcnt(6)
    s_add_u32 s73, s67, s77
    v_smfmac_f32_16x16x64_bf16 v[48:51], v[28:31], v[96:103], v1
    buffer_load_dword v78, v76, s[4:7], s73 offen sc1
    v_smfmac_f32_16x16x64_bf16 v[52:55], v[28:31], v[104:111], v1
    s_waitcnt lgkmcnt(5)
    ds_read_b128 v[96:99], v8 offset:12288
    v_smfmac_f32_16x16x64_bf16 v[48:51], v[32:35], v[144:151], v1
    ds_read_b128 v[100:103], v8 offset:13312
    v_smfmac_f32_16x16x64_bf16 v[52:55], v[32:35], v[152:159], v1
    s_waitcnt lgkmcnt(6)
    ds_read_b128 v[104:107], v8 offset:14336
    v_smfmac_f32_16x16x64_bf16 v[48:51], v[36:39], v[80:87], v1
    s_waitcnt lgkmcnt(3)
    ds_read_b128 v[108:111], v8 offset:15360
    v_smfmac_f32_16x16x64_bf16 v[52:55], v[36:39], v[88:95], v1
    buffer_store_dword v14, v3, s[4:7], s68 offen sc1
    v_smfmac_f32_16x16x64_bf16 v[48:51], v[40:43], v[160:167], v1
    v_smfmac_f32_16x16x64_bf16 v[52:55], v[40:43], v[168:175], v1
    s_waitcnt lgkmcnt(2)
    buffer_load_dword v78, off, s[4:7], s84 sc1
    v_smfmac_f32_16x16x64_bf16 v[48:51], v[44:47], v[96:103], v1
    s_waitcnt lgkmcnt(0)
    ds_read_b128 v[80:83], v79 offset:0
    v_smfmac_f32_16x16x64_bf16 v[52:55], v[44:47], v[104:111], v1
    ds_read_b128 v[84:87], v79 offset:4096
    v_smfmac_f32_16x16x64_bf16 v[56:59], v[24:27], a[32:39], v1
    s_nop 0
    ds_read_b128 v[88:91], v79 offset:1024
    v_smfmac_f32_16x16x64_bf16 v[56:59], v[28:31], a[48:55], v1
    s_nop 0
    ds_read_b128 v[92:95], v79 offset:5120
    v_smfmac_f32_16x16x64_bf16 v[56:59], v[32:35], a[64:71], v1
    ds_read_b128 v[96:99], v79 offset:2048
    v_add_f32 v48, v48, v49
    v_smfmac_f32_16x16x64_bf16 v[56:59], v[36:39], a[80:87], v1
    ds_read_b128 v[100:103], v79 offset:6144
    v_add_f32 v50, v50, v51
    v_smfmac_f32_16x16x64_bf16 v[56:59], v[40:43], a[96:103], v1
    ds_read_b128 v[104:107], v79 offset:3072
    v_add_f32 v52, v52, v53
    v_smfmac_f32_16x16x64_bf16 v[56:59], v[44:47], a[112:119], v1
    ds_read_b128 v[108:111], v79 offset:7168
    v_add_f32 v54, v54, v55
    v_smfmac_f32_16x16x64_bf16 v[60:63], v[24:27], a[40:47], v1
    buffer_store_dword v72, v3, s[4:7], s64 offen sc1
    v_cvt_pk_bf16_f32 v49, v48, v52
    v_smfmac_f32_16x16x64_bf16 v[60:63], v[28:31], a[56:63], v1
    v_cvt_pk_bf16_f32 v51, v50, v54
    v_smfmac_f32_16x16x64_bf16 v[60:63], v[32:35], a[72:79], v1
    ds_write2_b32 v4, v49, v51 offset0:0 offset1:4
    v_smfmac_f32_16x16x64_bf16 v[60:63], v[36:39], a[88:95], v1
    v_add_f32 v56, v56, v57
    v_smfmac_f32_16x16x64_bf16 v[60:63], v[40:43], a[104:111], v1
    v_add_f32 v58, v58, v59
    v_smfmac_f32_16x16x64_bf16 v[60:63], v[44:47], a[120:127], v1
    s_nop 1
    v_mov_b64 v[72:73], 0
    v_smfmac_f32_16x16x64_bf16 v[64:67], v[24:27], a[160:167], v1
    s_nop 1
    v_mov_b64 v[74:75], 0
    v_smfmac_f32_16x16x64_bf16 v[68:71], v[24:27], a[168:175], v1
    s_nop 0
    v_add_f32 v60, v60, v61
    v_add_f32 v62, v62, v63
    v_cvt_pk_bf16_f32 v57, v56, v60
    v_cvt_pk_bf16_f32 v59, v58, v62
    v_smfmac_f32_16x16x64_bf16 v[64:67], v[28:31], a[176:183], v1
    ds_write2_b32 v6, v57, v59 offset0:0 offset1:8
    v_smfmac_f32_16x16x64_bf16 v[68:71], v[28:31], a[184:191], v1
    v_add_u32 v76, s76, v79
    v_smfmac_f32_16x16x64_bf16 v[64:67], v[32:35], a[192:199], v1
    v_xor_b32 v79, 0x4000, v79
    v_smfmac_f32_16x16x64_bf16 v[68:71], v[32:35], a[200:207], v1
    s_waitcnt vmcnt(8)
    v_smfmac_f32_16x16x64_bf16 v[64:67], v[36:39], a[208:215], v1
    s_waitcnt lgkmcnt(0)
    s_barrier
    ds_read_b128 v[24:27], v5 offset:0
    v_smfmac_f32_16x16x64_bf16 v[68:71], v[36:39], a[216:223], v1
    ds_read_b128 v[28:31], v5 offset:512
    v_mov_b32 v20, 0x3f803f80
    v_smfmac_f32_16x16x64_bf16 v[64:67], v[40:43], a[224:231], v1
    ds_read_b128 v[56:59], v0 offset:43008
    v_mov_b32 v21, 0x3f803f80
    v_smfmac_f32_16x16x64_bf16 v[68:71], v[40:43], a[232:239], v1
    ds_read_b128 v[32:35], v5 offset:1024
    v_mov_b64 v[22:23], v[20:21]
    v_smfmac_f32_16x16x64_bf16 v[64:67], v[44:47], a[240:247], v1
    ds_read_b128 v[36:39], v5 offset:1536
    v_mov_b32 v17, 0
    v_smfmac_f32_16x16x64_bf16 v[68:71], v[44:47], a[248:255], v1
    s_waitcnt lgkmcnt(4)
    ds_read_b128 v[60:63], v0 offset:44032
    v_mov_b32 v19, 0
    v_mfma_f32_16x16x32_bf16 v[48:51], v[80:83], v[24:27], 0
    ds_read_b128 v[40:43], v76 offset:8192
    v_mfma_f32_16x16x32_bf16 v[52:55], v[84:87], v[24:27], 0
    s_waitcnt lgkmcnt(5)
    ds_read_b128 v[44:47], v76 offset:9216
    v_mfma_f32_16x16x32_bf16 v[48:51], v[88:91], v[28:31], v[48:51]
    ds_read_b128 v[80:83], v9 offset:0
    v_add_f32 v64, v64, v65
    v_mfma_f32_16x16x32_bf16 v[52:55], v[92:95], v[28:31], v[52:55]
    s_waitcnt lgkmcnt(6)
    v_add_f32 v66, v66, v67
    v_add_f32 v68, v68, v69
    v_smfmac_f32_16x16x64_bf16 v[72:75], v[56:59], v[24:31], v1
    s_waitcnt lgkmcnt(5)
    ds_read_b128 v[84:87], v9 offset:1024
    v_add_f32 v70, v70, v71
    v_mfma_f32_16x16x32_bf16 v[48:51], v[96:99], v[32:35], v[48:51]
    s_waitcnt lgkmcnt(4)
    ds_read_b128 v[88:91], v9 offset:2048
    v_cvt_pk_bf16_f32 v14, v64, v66
    v_smfmac_f32_16x16x64_bf16 v[72:75], v[60:63], v[32:39], v1
    ds_read_b128 v[92:95], v9 offset:3072
    v_cvt_pk_bf16_f32 v18, v68, v70
    v_mfma_f32_16x16x32_bf16 v[48:51], v[104:107], v[36:39], v[48:51]
    s_nop 2
    v_mfma_f32_16x16x32_bf16 v[52:55], v[100:103], v[32:35], v[52:55]
    s_nop 0
    v_add_f32 v72, v72, v73
    v_add_f32 v73, v74, v75
    v_mfma_f32_16x16x32_bf16 v[52:55], v[108:111], v[36:39], v[52:55]
    ds_read_b128 v[96:99], v9 offset:4096
    ds_read_b128 v[100:103], v9 offset:5120
    v_max_f32 v76, v72, v73
    v_max3_f32 v76, v76, v48, v49
    v_max3_f32 v76, v76, v50, v51
    s_nop 2
    v_max3_f32 v76, v76, v52, v53
    v_max3_f32 v76, v76, v54, v55
    v_mov_b32 v77, v76
    s_nop 1
    v_permlane16_swap_b32 v76, v77
    v_max_f32 v76, v76, v77
    v_mov_b32 v77, v76
    s_nop 1
    v_permlane32_swap_b32 v76, v77
    v_max_f32 v76, v76, v77
    v_mul_f32 v76, s70, v76
    v_pk_fma_f32 v[72:73], v[72:73], s[90:91], v[76:77] op_sel_hi:[1,1,0]
    v_pk_fma_f32 v[48:49], v[48:49], s[90:91], v[76:77] op_sel_hi:[1,1,0]
    v_pk_fma_f32 v[50:51], v[50:51], s[90:91], v[76:77] op_sel_hi:[1,1,0]
    v_pk_fma_f32 v[52:53], v[52:53], s[90:91], v[76:77] op_sel_hi:[1,1,0]
    v_pk_fma_f32 v[54:55], v[54:55], s[90:91], v[76:77] op_sel_hi:[1,1,0]
    v_exp_f32 v72, v72
    v_exp_f32 v73, v73
    v_exp_f32 v48, v48
    v_exp_f32 v49, v49
    v_cvt_pk_bf16_f32 v16, v72, v73
    v_exp_f32 v50, v50
    v_exp_f32 v51, v51
    v_mfma_f32_16x16x16_bf16 v[64:67], v[20:21], v[16:17], 0
    v_exp_f32 v52, v52
    v_cvt_pk_bf16_f32 v24, v48, v49
    v_mfma_f32_16x16x16_bf16 v[56:59], v[14:15], v[16:17], 0
    v_exp_f32 v53, v53
    v_cvt_pk_bf16_f32 v25, v50, v51
    v_mfma_f32_16x16x16_bf16 v[60:63], v[18:19], v[16:17], 0
    v_exp_f32 v54, v54
    v_exp_f32 v55, v55
    v_cvt_pk_bf16_f32 v26, v52, v53
    v_cvt_pk_bf16_f32 v27, v54, v55
    s_nop 0
    s_waitcnt lgkmcnt(6)
    v_mfma_f32_16x16x32_bf16 v[64:67], v[20:23], v[24:27], v[64:67]
    s_nop 0
    ds_read_b128 v[104:107], v9 offset:6144
    v_mov_b64 v[48:49], 0
    v_mfma_f32_16x16x32_bf16 v[56:59], v[40:43], v[24:27], v[56:59]
    s_nop 0
    ds_read_b128 v[108:111], v9 offset:7168
    s_nop 0
    v_mfma_f32_16x16x32_bf16 v[60:63], v[44:47], v[24:27], v[60:63]
    s_mov_b64 exec, s[86:87]
    v_rcp_f32 v76, v64
    s_nop 1
    v_pk_mul_f32 v[56:57], v[56:57], v[76:77] op_sel_hi:[1,0]
    v_pk_mul_f32 v[58:59], v[58:59], v[76:77] op_sel_hi:[1,0]
    s_nop 1
    v_pk_mul_f32 v[60:61], v[60:61], v[76:77] op_sel_hi:[1,0]
    v_pk_mul_f32 v[62:63], v[62:63], v[76:77] op_sel_hi:[1,0]
    v_cvt_pk_bf16_f32 v72, v56, v60
    v_cvt_pk_bf16_f32 v73, v57, v61
    v_cvt_pk_bf16_f32 v74, v58, v62
    v_cvt_pk_bf16_f32 v75, v59, v63
    ds_write_b128 v7, v[72:75]
    s_mov_b64 exec, -1
    v_mfma_f32_32x32x8_bf16 v[16:31], v[48:49], v[48:49], 0
    v_mfma_f32_32x32x8_bf16 v[32:47], v[48:49], v[48:49], 0
    s_waitcnt lgkmcnt(0)
    s_barrier
    ds_read_b128 v[64:67], v13 offset:45568
    ds_read_b128 v[68:71], v13 offset:46592
    v_mfma_f32_32x32x8_bf16 v[32:47], v[48:49], v[48:49], 0
    s_add_u32 s66, s65, s75
    s_nop 1
    s_waitcnt lgkmcnt(1)
    v_smfmac_f32_16x16x64_bf16 v[16:19], v[64:67], v[176:183], v1
    s_waitcnt lgkmcnt(0)
    v_smfmac_f32_16x16x64_bf16 v[16:19], v[68:71], v[184:191], v1
    s_nop 0
    ds_read_b128 v[48:51], v9 offset:8192
    s_nop 0
    v_smfmac_f32_16x16x64_bf16 v[20:23], v[64:67], v[192:199], v1
    s_nop 0
    ds_read_b128 v[52:55], v9 offset:9216
    s_nop 0
    v_smfmac_f32_16x16x64_bf16 v[20:23], v[68:71], v[200:207], v1
    s_nop 0
    ds_read_b128 v[56:59], v9 offset:10240
    v_add_f32 v16, v16, v17
    v_smfmac_f32_16x16x64_bf16 v[24:27], v[64:67], v[208:215], v1
    s_nop 1
    v_add_f32 v18, v18, v19
    v_cvt_pk_bf16_f32 v16, v16, v18
    v_and_or_b32 v16, v16, -2, s89
    v_smfmac_f32_16x16x64_bf16 v[24:27], v[68:71], v[216:223], v1
    s_nop 0
    ds_read_b128 v[60:63], v9 offset:11264
    v_add_f32 v20, v20, v21
    v_smfmac_f32_16x16x64_bf16 v[28:31], v[64:67], v[224:231], v1
    s_nop 1
    v_add_f32 v22, v22, v23
    v_cvt_pk_bf16_f32 v17, v20, v22
    v_smfmac_f32_16x16x64_bf16 v[28:31], v[68:71], v[232:239], v1
    s_nop 0
    buffer_store_dwordx2 v[16:17], v2, s[4:7], s65 offen offset:0 sc1
    v_add_f32 v24, v24, v25
    v_smfmac_f32_16x16x64_bf16 v[32:35], v[64:67], v[240:247], v1
    s_nop 1
    v_add_f32 v26, v26, v27
    v_cvt_pk_bf16_f32 v24, v24, v26
    v_and_or_b32 v24, v24, -2, s89
    v_smfmac_f32_16x16x64_bf16 v[32:35], v[68:71], v[248:255], v1
    s_nop 1
    v_add_f32 v28, v28, v29
    v_smfmac_f32_16x16x64_bf16 v[36:39], v[64:67], v[80:87], v1
    s_nop 1
    v_add_f32 v30, v30, v31
    v_cvt_pk_bf16_f32 v25, v28, v30
    v_smfmac_f32_16x16x64_bf16 v[36:39], v[68:71], v[88:95], v1
    s_nop 0
    buffer_store_dwordx2 v[24:25], v2, s[4:7], s65 offen offset:2048 sc1
    v_add_f32 v32, v32, v33
    v_smfmac_f32_16x16x64_bf16 v[40:43], v[64:67], v[96:103], v1
    s_nop 1
    v_add_f32 v34, v34, v35
    v_cvt_pk_bf16_f32 v32, v32, v34
    v_and_or_b32 v32, v32, -2, s89
    v_smfmac_f32_16x16x64_bf16 v[40:43], v[68:71], v[104:111], v1
    s_waitcnt lgkmcnt(0)
    s_nop 0
    v_add_f32 v36, v36, v37
    v_smfmac_f32_16x16x64_bf16 v[44:47], v[64:67], v[48:55], v1
    s_nop 1
    v_add_f32 v38, v38, v39
    v_cvt_pk_bf16_f32 v33, v36, v38
    v_smfmac_f32_16x16x64_bf16 v[44:47], v[68:71], v[56:63], v1
    s_nop 0
    buffer_store_dwordx2 v[32:33], v2, s[4:7], s80 offen offset:0 sc1
    v_add_f32 v40, v40, v41
    v_add_f32 v42, v42, v43
    v_cvt_pk_bf16_f32 v40, v40, v42
    v_and_or_b32 v40, v40, -2, s89
    s_nop 1
    v_add_f32 v44, v44, v45
    v_add_f32 v46, v46, v47
    v_cvt_pk_bf16_f32 v41, v44, v46
    buffer_store_dwordx2 v[40:41], v2, s[4:7], s80 offen offset:2048 sc1
    s_cmp_eq_u32 s3, 0
    s_cbranch_scc1 L_v0s
    s_cmp_eq_u32 s3, 1
    s_cbranch_scc1 L_v1s
    s_cmp_eq_u32 s3, 2
    s_cbranch_scc1 L_v2s
L_v3s:
    ds_read_b128 v[20:23], v0 offset:47616
    s_sub_u32 s88, 0, s89
    s_mov_b32 s64, s62
    s_mov_b32 s62, s63
    s_add_u32 s63, s63, 8192
    s_and_b32 s63, s63, 0x7fff
    s_xor_b32 s65, s65, 0x40000
    s_xor_b32 s80, s80, 0x40000
    s_add_u32 s67, s67, 524288
    s_add_u32 s81, s67, 8192
    s_xor_b32 s82, s82, 0x4000
    s_xor_b32 s83, s83, 0x4000
    s_add_u32 s68, s68, 8192
    s_add_u32 s73, s61, 3
    s_lshr_b32 s78, s73, 2
    s_min_u32 s78, s78, 15
    s_mov_b32 s72, s84
    s_add_u32 s61, s61, 1
    s_bfe_u32 s89, s61, 0x10001
    s_add_u32 s73, s61, 3
    s_and_b32 s73, s73, 3
    s_lshl_b32 s73, s73, 2
    s_add_u32 s84, s73, s71
    s_nop 15
    s_nop 6
    s_nop 0
    buffer_load_dwordx4 v[24:27], v10, s[4:7], s66 offen sc1
    buffer_load_dwordx4 v[28:31], v10, s[4:7], s66 offen offset:1024 sc1
    s_nop 15
    s_nop 15
    s_nop 0
    buffer_load_dwordx4 v[40:43], v10, s[4:7], s66 offen sc1
    buffer_load_dwordx4 v[44:47], v10, s[4:7], s66 offen offset:1024 sc1
    .p2align 5
    s_waitcnt vmcnt(3) lgkmcnt(0)
    v_mfma_f32_16x16x32_bf16 v[36:39], v[20:23], v[24:27], 0
    v_bitop3_b32 v76, v24, v26, s88 bitop3:0x7e
    s_waitcnt vmcnt(2)
    v_mfma_f32_16x16x32_bf16 v[36:39], v[20:23], v[28:31], v[36:39]
    v_bitop3_b32 v77, v28, v30, s88 bitop3:0x7e
    v_bitop3_b32 v76, v76, v77, 1 bitop3:0xa8
    v_cmp_ne_u32 vcc, 0, v76
    v_readfirstlane_b32 s74, v78
    v_mov_b64 v[48:49], 0
    v_mov_b64 v[50:51], 0
    s_cbranch_vccnz L_rr3s
    s_nop 0
    v_add_f32_dpp v36, v36, v36 row_shr:4 row_mask:0xf bank_mask:0xf
    v_add_f32_dpp v37, v37, v37 row_shr:4 row_mask:0xf bank_mask:0xf
    s_nop 0
    v_add_f32_dpp v36, v36, v36 row_shr:8 row_mask:0xf bank_mask:0xf
    v_add_f32_dpp v37, v37, v37 row_shr:8 row_mask:0xf bank_mask:0xf
    v_cvt_pk_bf16_f32 v14, v36, v37
    buffer_store_dword v14, v3, s[4:7], s62 offen sc1
L_rok3s:
    s_cmp_gt_u32 s74, s78
    s_cbranch_scc0 L_kvw3s
L_kvok3s:
    s_cmp_ge_u32 s61, 63
    s_cbranch_scc1 L_last
    s_mov_b32 s59, 1000000
    v_mov_b64 v[52:53], 0
    v_mov_b64 v[54:55], 0
    v_mov_b64 v[56:57], 0
    v_mov_b64 v[58:59], 0
    v_mov_b64 v[60:61], 0
    v_mov_b64 v[62:63], 0
    v_mov_b64 v[64:65], 0
    v_mov_b64 v[66:67], 0
    v_mov_b64 v[68:69], 0
    v_mov_b64 v[70:71], 0
    v_mov_b64 v[72:73], -1
    v_mov_b64 v[74:75], -1
    ds_read_b128 v[80:83], v8 offset:0
    ds_read_b128 v[84:87], v8 offset:1024
    ds_read_b128 v[88:91], v8 offset:2048
    ds_read_b128 v[92:95], v8 offset:3072
    ds_read_b128 v[96:99], v8 offset:4096
    ds_read_b128 v[100:103], v8 offset:5120
    ds_read_b128 v[104:107], v8 offset:6144
    ds_read_b128 v[108:111], v8 offset:7168
    s_nop 5
    buffer_load_dwordx4 v[16:19], v10, s[4:7], s62 offen sc1
    buffer_load_dwordx4 v[20:23], v10, s[4:7], s62 offen offset:1024 sc1
    s_nop 15
    s_nop 15
    s_nop 2
    buffer_load_dwordx4 v[16:19], v10, s[4:7], s62 offen sc1
    buffer_load_dwordx4 v[20:23], v10, s[4:7], s62 offen offset:1024 sc1
    s_branch L_gws
    .p2align 6
L_rr3s:
    buffer_load_dwordx4 v[24:27], v10, s[4:7], s66 offen sc1
    buffer_load_dwordx4 v[28:31], v10, s[4:7], s66 offen offset:1024 sc1
    s_sub_u32 s59, s59, 1
    s_cbranch_scc1 L_fail
    s_waitcnt vmcnt(3) lgkmcnt(0)
    v_mfma_f32_16x16x32_bf16 v[36:39], v[20:23], v[40:43], 0
    v_bitop3_b32 v76, v40, v42, s88 bitop3:0x7e
    s_waitcnt vmcnt(2)
    v_mfma_f32_16x16x32_bf16 v[36:39], v[20:23], v[44:47], v[36:39]
    v_bitop3_b32 v77, v44, v46, s88 bitop3:0x7e
    v_bitop3_b32 v76, v76, v77, 1 bitop3:0xa8
    v_cmp_ne_u32 vcc, 0, v76
    v_readfirstlane_b32 s74, v78
    v_mov_b64 v[48:49], 0
    v_mov_b64 v[50:51], 0
    s_cbranch_vccnz L_rs3s
    s_nop 0
    v_add_f32_dpp v36, v36, v36 row_shr:4 row_mask:0xf bank_mask:0xf
    v_add_f32_dpp v37, v37, v37 row_shr:4 row_mask:0xf bank_mask:0xf
    s_nop 0
    v_add_f32_dpp v36, v36, v36 row_shr:8 row_mask:0xf bank_mask:0xf
    v_add_f32_dpp v37, v37, v37 row_shr:8 row_mask:0xf bank_mask:0xf
    v_cvt_pk_bf16_f32 v14, v36, v37
    buffer_store_dword v14, v3, s[4:7], s62 offen sc1
    s_branch L_rok3s
    .p2align 6
L_rs3s:
    buffer_load_dwordx4 v[40:43], v10, s[4:7], s66 offen sc1
    buffer_load_dwordx4 v[44:47], v10, s[4:7], s66 offen offset:1024 sc1
    s_sub_u32 s59, s59, 1
    s_cbranch_scc1 L_fail
    s_waitcnt vmcnt(3) lgkmcnt(0)
    v_mfma_f32_16x16x32_bf16 v[36:39], v[20:23], v[24:27], 0
    v_bitop3_b32 v76, v24, v26, s88 bitop3:0x7e
    s_waitcnt vmcnt(2)
    v_mfma_f32_16x16x32_bf16 v[36:39], v[20:23], v[28:31], v[36:39]
    v_bitop3_b32 v77, v28, v30, s88 bitop3:0x7e
    v_bitop3_b32 v76, v76, v77, 1 bitop3:0xa8
    v_cmp_ne_u32 vcc, 0, v76
    v_readfirstlane_b32 s74, v78
    v_mov_b64 v[48:49], 0
    v_mov_b64 v[50:51], 0
    s_cbranch_vccnz L_rr3s
    s_nop 0
    v_add_f32_dpp v36, v36, v36 row_shr:4 row_mask:0xf bank_mask:0xf
    v_add_f32_dpp v37, v37, v37 row_shr:4 row_mask:0xf bank_mask:0xf
    s_nop 0
    v_add_f32_dpp v36, v36, v36 row_shr:8 row_mask:0xf bank_mask:0xf
    v_add_f32_dpp v37, v37, v37 row_shr:8 row_mask:0xf bank_mask:0xf
    v_cvt_pk_bf16_f32 v14, v36, v37
    buffer_store_dword v14, v3, s[4:7], s62 offen sc1
    s_branch L_rok3s
L_kvw3s:
    buffer_load_dword v78, off, s[4:7], s72 sc1
    s_sub_u32 s59, s59, 1
    s_cbranch_scc1 L_fail
    s_waitcnt vmcnt(0)
    v_readfirstlane_b32 s74, v78
    s_nop 0
    s_cmp_gt_u32 s74, s78
    s_cbranch_scc0 L_kvw3s
    s_branch L_kvok3s
L_v2s:
    ds_read_b128 v[20:23], v0 offset:47616
    s_sub_u32 s88, 0, s89
    s_mov_b32 s64, s62
    s_mov_b32 s62, s63
    s_add_u32 s63, s63, 8192
    s_and_b32 s63, s63, 0x7fff
    s_xor_b32 s65, s65, 0x40000
    s_xor_b32 s80, s80, 0x40000
    s_add_u32 s67, s67, 524288
    s_add_u32 s81, s67, 8192
    s_xor_b32 s82, s82, 0x4000
    s_xor_b32 s83, s83, 0x4000
    s_add_u32 s68, s68, 8192
    s_add_u32 s73, s61, 3
    s_lshr_b32 s78, s73, 2
    s_min_u32 s78, s78, 15
    s_mov_b32 s72, s84
    s_add_u32 s61, s61, 1
    s_bfe_u32 s89, s61, 0x10001
    s_add_u32 s73, s61, 3
    s_and_b32 s73, s73, 3
    s_lshl_b32 s73, s73, 2
    s_add_u32 s84, s73, s71
    s_nop 13
    s_nop 0
    buffer_load_dwordx4 v[24:27], v10, s[4:7], s66 offen sc1
    buffer_load_dwordx4 v[28:31], v10, s[4:7], s66 offen offset:1024 sc1
    s_nop 15
    s_nop 15
    s_nop 0
    buffer_load_dwordx4 v[40:43], v10, s[4:7], s66 offen sc1
    buffer_load_dwordx4 v[44:47], v10, s[4:7], s66 offen offset:1024 sc1
    .p2align 5
    s_waitcnt vmcnt(3) lgkmcnt(0)
    v_mfma_f32_16x16x32_bf16 v[36:39], v[20:23], v[24:27], 0
    v_bitop3_b32 v76, v24, v26, s88 bitop3:0x7e
    s_waitcnt vmcnt(2)
    v_mfma_f32_16x16x32_bf16 v[36:39], v[20:23], v[28:31], v[36:39]
    v_bitop3_b32 v77, v28, v30, s88 bitop3:0x7e
    v_bitop3_b32 v76, v76, v77, 1 bitop3:0xa8
    v_cmp_ne_u32 vcc, 0, v76
    v_readfirstlane_b32 s74, v78
    v_mov_b64 v[48:49], 0
    v_mov_b64 v[50:51], 0
    s_cbranch_vccnz L_rr2s
    s_nop 0
    v_add_f32_dpp v36, v36, v36 row_shr:4 row_mask:0xf bank_mask:0xf
    v_add_f32_dpp v37, v37, v37 row_shr:4 row_mask:0xf bank_mask:0xf
    s_nop 0
    v_add_f32_dpp v36, v36, v36 row_shr:8 row_mask:0xf bank_mask:0xf
    v_add_f32_dpp v37, v37, v37 row_shr:8 row_mask:0xf bank_mask:0xf
    v_cvt_pk_bf16_f32 v14, v36, v37
    buffer_store_dword v14, v3, s[4:7], s62 offen sc1
L_rok2s:
    s_cmp_gt_u32 s74, s78
    s_cbranch_scc0 L_kvw2s
L_kvok2s:
    s_cmp_ge_u32 s61, 63
    s_cbranch_scc1 L_last
    s_mov_b32 s59, 1000000
    v_mov_b64 v[52:53], 0
    v_mov_b64 v[54:55], 0
    v_mov_b64 v[56:57], 0
    v_mov_b64 v[58:59], 0
    v_mov_b64 v[60:61], 0
    v_mov_b64 v[62:63], 0
    v_mov_b64 v[64:65], 0
    v_mov_b64 v[66:67], 0
    v_mov_b64 v[68:69], 0
    v_mov_b64 v[70:71], 0
    v_mov_b64 v[72:73], -1
    v_mov_b64 v[74:75], -1
    ds_read_b128 v[80:83], v8 offset:0
    ds_read_b128 v[84:87], v8 offset:1024
    ds_read_b128 v[88:91], v8 offset:2048
    ds_read_b128 v[92:95], v8 offset:3072
    ds_read_b128 v[96:99], v8 offset:4096
    ds_read_b128 v[100:103], v8 offset:5120
    ds_read_b128 v[104:107], v8 offset:6144
    ds_read_b128 v[108:111], v8 offset:7168
    s_nop 5
    s_nop 0
    buffer_load_dwordx4 v[16:19], v10, s[4:7], s62 offen sc1
    buffer_load_dwordx4 v[20:23], v10, s[4:7], s62 offen offset:1024 sc1
    s_nop 15
    s_nop 15
    s_nop 3
    buffer_load_dwordx4 v[16:19], v10, s[4:7], s62 offen sc1
    buffer_load_dwordx4 v[20:23], v10, s[4:7], s62 offen offset:1024 sc1
    s_branch L_gws
    .p2align 6
L_rr2s:
    buffer_load_dwordx4 v[24:27], v10, s[4:7], s66 offen sc1
    buffer_load_dwordx4 v[28:31], v10, s[4:7], s66 offen offset:1024 sc1
    s_sub_u32 s59, s59, 1
    s_cbranch_scc1 L_fail
    s_waitcnt vmcnt(3) lgkmcnt(0)
    v_mfma_f32_16x16x32_bf16 v[36:39], v[20:23], v[40:43], 0
    v_bitop3_b32 v76, v40, v42, s88 bitop3:0x7e
    s_waitcnt vmcnt(2)
    v_mfma_f32_16x16x32_bf16 v[36:39], v[20:23], v[44:47], v[36:39]
    v_bitop3_b32 v77, v44, v46, s88 bitop3:0x7e
    v_bitop3_b32 v76, v76, v77, 1 bitop3:0xa8
    v_cmp_ne_u32 vcc, 0, v76
    v_readfirstlane_b32 s74, v78
    v_mov_b64 v[48:49], 0
    v_mov_b64 v[50:51], 0
    s_cbranch_vccnz L_rs2s
    s_nop 0
    v_add_f32_dpp v36, v36, v36 row_shr:4 row_mask:0xf bank_mask:0xf
    v_add_f32_dpp v37, v37, v37 row_shr:4 row_mask:0xf bank_mask:0xf
    s_nop 0
    v_add_f32_dpp v36, v36, v36 row_shr:8 row_mask:0xf bank_mask:0xf
    v_add_f32_dpp v37, v37, v37 row_shr:8 row_mask:0xf bank_mask:0xf
    v_cvt_pk_bf16_f32 v14, v36, v37
    buffer_store_dword v14, v3, s[4:7], s62 offen sc1
    s_branch L_rok2s
    .p2align 6
L_rs2s:
    buffer_load_dwordx4 v[40:43], v10, s[4:7], s66 offen sc1
    buffer_load_dwordx4 v[44:47], v10, s[4:7], s66 offen offset:1024 sc1
    s_sub_u32 s59, s59, 1
    s_cbranch_scc1 L_fail
    s_waitcnt vmcnt(3) lgkmcnt(0)
    v_mfma_f32_16x16x32_bf16 v[36:39], v[20:23], v[24:27], 0
    v_bitop3_b32 v76, v24, v26, s88 bitop3:0x7e
    s_waitcnt vmcnt(2)
    v_mfma_f32_16x16x32_bf16 v[36:39], v[20:23], v[28:31], v[36:39]
    v_bitop3_b32 v77, v28, v30, s88 bitop3:0x7e
    v_bitop3_b32 v76, v76, v77, 1 bitop3:0xa8
    v_cmp_ne_u32 vcc, 0, v76
    v_readfirstlane_b32 s74, v78
    v_mov_b64 v[48:49], 0
    v_mov_b64 v[50:51], 0
    s_cbranch_vccnz L_rr2s
    s_nop 0
    v_add_f32_dpp v36, v36, v36 row_shr:4 row_mask:0xf bank_mask:0xf
    v_add_f32_dpp v37, v37, v37 row_shr:4 row_mask:0xf bank_mask:0xf
    s_nop 0
    v_add_f32_dpp v36, v36, v36 row_shr:8 row_mask:0xf bank_mask:0xf
    v_add_f32_dpp v37, v37, v37 row_shr:8 row_mask:0xf bank_mask:0xf
    v_cvt_pk_bf16_f32 v14, v36, v37
    buffer_store_dword v14, v3, s[4:7], s62 offen sc1
    s_branch L_rok2s
L_kvw2s:
    buffer_load_dword v78, off, s[4:7], s72 sc1
    s_sub_u32 s59, s59, 1
    s_cbranch_scc1 L_fail
    s_waitcnt vmcnt(0)
    v_readfirstlane_b32 s74, v78
    s_nop 0
    s_cmp_gt_u32 s74, s78
    s_cbranch_scc0 L_kvw2s
    s_branch L_kvok2s
L_v1s:
    ds_read_b128 v[20:23], v0 offset:47616
    s_sub_u32 s88, 0, s89
    s_mov_b32 s64, s62
    s_mov_b32 s62, s63
    s_add_u32 s63, s63, 8192
    s_and_b32 s63, s63, 0x7fff
    s_xor_b32 s65, s65, 0x40000
    s_xor_b32 s80, s80, 0x40000
    s_add_u32 s67, s67, 524288
    s_add_u32 s81, s67, 8192
    s_xor_b32 s82, s82, 0x4000
    s_xor_b32 s83, s83, 0x4000
    s_add_u32 s68, s68, 8192
    s_add_u32 s73, s61, 3
    s_lshr_b32 s78, s73, 2
    s_min_u32 s78, s78, 15
    s_mov_b32 s72, s84
    s_add_u32 s61, s61, 1
    s_bfe_u32 s89, s61, 0x10001
    s_add_u32 s73, s61, 3
    s_and_b32 s73, s73, 3
    s_lshl_b32 s73, s73, 2
    s_add_u32 s84, s73, s71
    s_nop 6
    s_nop 0
    buffer_load_dwordx4 v[24:27], v10, s[4:7], s66 offen sc1
    buffer_load_dwordx4 v[28:31], v10, s[4:7], s66 offen offset:1024 sc1
    s_nop 15
    s_nop 11
    buffer_load_dwordx4 v[40:43], v10, s[4:7], s66 offen sc1
    buffer_load_dwordx4 v[44:47], v10, s[4:7], s66 offen offset:1024 sc1
    .p2align 5
    s_waitcnt vmcnt(3) lgkmcnt(0)
    v_mfma_f32_16x16x32_bf16 v[36:39], v[20:23], v[24:27], 0
    v_bitop3_b32 v76, v24, v26, s88 bitop3:0x7e
    s_waitcnt vmcnt(2)
    v_mfma_f32_16x16x32_bf16 v[36:39], v[20:23], v[28:31], v[36:39]
    v_bitop3_b32 v77, v28, v30, s88 bitop3:0x7e
    v_bitop3_b32 v76, v76, v77, 1 bitop3:0xa8
    v_cmp_ne_u32 vcc, 0, v76
    v_readfirstlane_b32 s74, v78
    v_mov_b64 v[48:49], 0
    v_mov_b64 v[50:51], 0
    s_cbranch_vccnz L_rr1s
    s_nop 0
    v_add_f32_dpp v36, v36, v36 row_shr:4 row_mask:0xf bank_mask:0xf
    v_add_f32_dpp v37, v37, v37 row_shr:4 row_mask:0xf bank_mask:0xf
    s_nop 0
    v_add_f32_dpp v36, v36, v36 row_shr:8 row_mask:0xf bank_mask:0xf
    v_add_f32_dpp v37, v37, v37 row_shr:8 row_mask:0xf bank_mask:0xf
    v_cvt_pk_bf16_f32 v14, v36, v37
    buffer_store_dword v14, v3, s[4:7], s62 offen sc1
L_rok1s:
    s_cmp_gt_u32 s74, s78
    s_cbranch_scc0 L_kvw1s
L_kvok1s:
    s_cmp_ge_u32 s61, 63
    s_cbranch_scc1 L_last
    s_mov_b32 s59, 1000000
    v_mov_b64 v[52:53], 0
    v_mov_b64 v[54:55], 0
    v_mov_b64 v[56:57], 0
    v_mov_b64 v[58:59], 0
    v_mov_b64 v[60:61], 0
    v_mov_b64 v[62:63], 0
    v_mov_b64 v[64:65], 0
    v_mov_b64 v[66:67], 0
    v_mov_b64 v[68:69], 0
    v_mov_b64 v[70:71], 0
    v_mov_b64 v[72:73], -1
    v_mov_b64 v[74:75], -1
    ds_read_b128 v[80:83], v8 offset:0
    ds_read_b128 v[84:87], v8 offset:1024
    ds_read_b128 v[88:91], v8 offset:2048
    ds_read_b128 v[92:95], v8 offset:3072
    ds_read_b128 v[96:99], v8 offset:4096
    ds_read_b128 v[100:103], v8 offset:5120
    ds_read_b128 v[104:107], v8 offset:6144
    ds_read_b128 v[108:111], v8 offset:7168
    s_nop 6
    buffer_load_dwordx4 v[16:19], v10, s[4:7], s62 offen sc1
    buffer_load_dwordx4 v[20:23], v10, s[4:7], s62 offen offset:1024 sc1
    s_nop 15
    s_nop 15
    s_nop 1
    buffer_load_dwordx4 v[16:19], v10, s[4:7], s62 offen sc1
    buffer_load_dwordx4 v[20:23], v10, s[4:7], s62 offen offset:1024 sc1
    s_branch L_gws
    .p2align 6
L_rr1s:
    buffer_load_dwordx4 v[24:27], v10, s[4:7], s66 offen sc1
    buffer_load_dwordx4 v[28:31], v10, s[4:7], s66 offen offset:1024 sc1
    s_sub_u32 s59, s59, 1
    s_cbranch_scc1 L_fail
    s_waitcnt vmcnt(3) lgkmcnt(0)
    v_mfma_f32_16x16x32_bf16 v[36:39], v[20:23], v[40:43], 0
    v_bitop3_b32 v76, v40, v42, s88 bitop3:0x7e
    s_waitcnt vmcnt(2)
    v_mfma_f32_16x16x32_bf16 v[36:39], v[20:23], v[44:47], v[36:39]
    v_bitop3_b32 v77, v44, v46, s88 bitop3:0x7e
    v_bitop3_b32 v76, v76, v77, 1 bitop3:0xa8
    v_cmp_ne_u32 vcc, 0, v76
    v_readfirstlane_b32 s74, v78
    v_mov_b64 v[48:49], 0
    v_mov_b64 v[50:51], 0
    s_cbranch_vccnz L_rs1s
    s_nop 0
    v_add_f32_dpp v36, v36, v36 row_shr:4 row_mask:0xf bank_mask:0xf
    v_add_f32_dpp v37, v37, v37 row_shr:4 row_mask:0xf bank_mask:0xf
    s_nop 0
    v_add_f32_dpp v36, v36, v36 row_shr:8 row_mask:0xf bank_mask:0xf
    v_add_f32_dpp v37, v37, v37 row_shr:8 row_mask:0xf bank_mask:0xf
    v_cvt_pk_bf16_f32 v14, v36, v37
    buffer_store_dword v14, v3, s[4:7], s62 offen sc1
    s_branch L_rok1s
    .p2align 6
L_rs1s:
    buffer_load_dwordx4 v[40:43], v10, s[4:7], s66 offen sc1
    buffer_load_dwordx4 v[44:47], v10, s[4:7], s66 offen offset:1024 sc1
    s_sub_u32 s59, s59, 1
    s_cbranch_scc1 L_fail
    s_waitcnt vmcnt(3) lgkmcnt(0)
    v_mfma_f32_16x16x32_bf16 v[36:39], v[20:23], v[24:27], 0
    v_bitop3_b32 v76, v24, v26, s88 bitop3:0x7e
    s_waitcnt vmcnt(2)
    v_mfma_f32_16x16x32_bf16 v[36:39], v[20:23], v[28:31], v[36:39]
    v_bitop3_b32 v77, v28, v30, s88 bitop3:0x7e
    v_bitop3_b32 v76, v76, v77, 1 bitop3:0xa8
    v_cmp_ne_u32 vcc, 0, v76
    v_readfirstlane_b32 s74, v78
    v_mov_b64 v[48:49], 0
    v_mov_b64 v[50:51], 0
    s_cbranch_vccnz L_rr1s
    s_nop 0
    v_add_f32_dpp v36, v36, v36 row_shr:4 row_mask:0xf bank_mask:0xf
    v_add_f32_dpp v37, v37, v37 row_shr:4 row_mask:0xf bank_mask:0xf
    s_nop 0
    v_add_f32_dpp v36, v36, v36 row_shr:8 row_mask:0xf bank_mask:0xf
    v_add_f32_dpp v37, v37, v37 row_shr:8 row_mask:0xf bank_mask:0xf
    v_cvt_pk_bf16_f32 v14, v36, v37
    buffer_store_dword v14, v3, s[4:7], s62 offen sc1
    s_branch L_rok1s
L_kvw1s:
    buffer_load_dword v78, off, s[4:7], s72 sc1
    s_sub_u32 s59, s59, 1
    s_cbranch_scc1 L_fail
    s_waitcnt vmcnt(0)
    v_readfirstlane_b32 s74, v78
    s_nop 0
    s_cmp_gt_u32 s74, s78
    s_cbranch_scc0 L_kvw1s
    s_branch L_kvok1s
L_v0s:
    ds_read_b128 v[20:23], v0 offset:47616
    s_sub_u32 s88, 0, s89
    s_mov_b32 s64, s62
    s_mov_b32 s62, s63
    s_add_u32 s63, s63, 8192
    s_and_b32 s63, s63, 0x7fff
    s_xor_b32 s65, s65, 0x40000
    s_xor_b32 s80, s80, 0x40000
    s_add_u32 s67, s67, 524288
    s_add_u32 s81, s67, 8192
    s_xor_b32 s82, s82, 0x4000
    s_xor_b32 s83, s83, 0x4000
    s_add_u32 s68, s68, 8192
    s_add_u32 s73, s61, 3
    s_lshr_b32 s78, s73, 2
    s_min_u32 s78, s78, 15
    s_mov_b32 s72, s84
    s_add_u32 s61, s61, 1
    s_bfe_u32 s89, s61, 0x10001
    s_add_u32 s73, s61, 3
    s_and_b32 s73, s73, 3
    s_lshl_b32 s73, s73, 2
    s_add_u32 s84, s73, s71
    buffer_load_dwordx4 v[24:27], v10, s[4:7], s66 offen sc1
    buffer_load_dwordx4 v[28:31], v10, s[4:7], s66 offen offset:1024 sc1
    s_nop 15
    s_nop 15
    s_nop 1
    buffer_load_dwordx4 v[40:43], v10, s[4:7], s66 offen sc1
    buffer_load_dwordx4 v[44:47], v10, s[4:7], s66 offen offset:1024 sc1
    .p2align 5
    s_waitcnt vmcnt(3) lgkmcnt(0)
    v_mfma_f32_16x16x32_bf16 v[36:39], v[20:23], v[24:27], 0
    v_bitop3_b32 v76, v24, v26, s88 bitop3:0x7e
    s_waitcnt vmcnt(2)
    v_mfma_f32_16x16x32_bf16 v[36:39], v[20:23], v[28:31], v[36:39]
    v_bitop3_b32 v77, v28, v30, s88 bitop3:0x7e
    v_bitop3_b32 v76, v76, v77, 1 bitop3:0xa8
    v_cmp_ne_u32 vcc, 0, v76
    v_readfirstlane_b32 s74, v78
    v_mov_b64 v[48:49], 0
    v_mov_b64 v[50:51], 0
    s_cbranch_vccnz L_rr0s
    s_nop 0
    v_add_f32_dpp v36, v36, v36 row_shr:4 row_mask:0xf bank_mask:0xf
    v_add_f32_dpp v37, v37, v37 row_shr:4 row_mask:0xf bank_mask:0xf
    s_nop 0
    v_add_f32_dpp v36, v36, v36 row_shr:8 row_mask:0xf bank_mask:0xf
    v_add_f32_dpp v37, v37, v37 row_shr:8 row_mask:0xf bank_mask:0xf
    v_cvt_pk_bf16_f32 v14, v36, v37
    buffer_store_dword v14, v3, s[4:7], s62 offen sc1
L_rok0s:
    s_cmp_gt_u32 s74, s78
    s_cbranch_scc0 L_kvw0s
L_kvok0s:
    s_cmp_ge_u32 s61, 63
    s_cbranch_scc1 L_last
    s_mov_b32 s59, 1000000
    v_mov_b64 v[52:53], 0
    v_mov_b64 v[54:55], 0
    v_mov_b64 v[56:57], 0
    v_mov_b64 v[58:59], 0
    v_mov_b64 v[60:61], 0
    v_mov_b64 v[62:63], 0
    v_mov_b64 v[64:65], 0
    v_mov_b64 v[66:67], 0
    v_mov_b64 v[68:69], 0
    v_mov_b64 v[70:71], 0
    v_mov_b64 v[72:73], -1
    v_mov_b64 v[74:75], -1
    ds_read_b128 v[80:83], v8 offset:0
    ds_read_b128 v[84:87], v8 offset:1024
    ds_read_b128 v[88:91], v8 offset:2048
    ds_read_b128 v[92:95], v8 offset:3072
    ds_read_b128 v[96:99], v8 offset:4096
    ds_read_b128 v[100:103], v8 offset:5120
    ds_read_b128 v[104:107], v8 offset:6144
    ds_read_b128 v[108:111], v8 offset:7168
    s_nop 4
    buffer_load_dwordx4 v[16:19], v10, s[4:7], s62 offen sc1
    buffer_load_dwordx4 v[20:23], v10, s[4:7], s62 offen offset:1024 sc1
    s_nop 15
    s_nop 15
    s_nop 1
    buffer_load_dwordx4 v[16:19], v10, s[4:7], s62 offen sc1
    buffer_load_dwordx4 v[20:23], v10, s[4:7], s62 offen offset:1024 sc1
    s_branch L_gws
    .p2align 6
L_rr0s:
    buffer_load_dwordx4 v[24:27], v10, s[4:7], s66 offen sc1
    buffer_load_dwordx4 v[28:31], v10, s[4:7], s66 offen offset:1024 sc1
    s_sub_u32 s59, s59, 1
    s_cbranch_scc1 L_fail
    s_waitcnt vmcnt(3) lgkmcnt(0)
    v_mfma_f32_16x16x32_bf16 v[36:39], v[20:23], v[40:43], 0
    v_bitop3_b32 v76, v40, v42, s88 bitop3:0x7e
    s_waitcnt vmcnt(2)
    v_mfma_f32_16x16x32_bf16 v[36:39], v[20:23], v[44:47], v[36:39]
    v_bitop3_b32 v77, v44, v46, s88 bitop3:0x7e
    v_bitop3_b32 v76, v76, v77, 1 bitop3:0xa8
    v_cmp_ne_u32 vcc, 0, v76
    v_readfirstlane_b32 s74, v78
    v_mov_b64 v[48:49], 0
    v_mov_b64 v[50:51], 0
    s_cbranch_vccnz L_rs0s
    s_nop 0
    v_add_f32_dpp v36, v36, v36 row_shr:4 row_mask:0xf bank_mask:0xf
    v_add_f32_dpp v37, v37, v37 row_shr:4 row_mask:0xf bank_mask:0xf
    s_nop 0
    v_add_f32_dpp v36, v36, v36 row_shr:8 row_mask:0xf bank_mask:0xf
    v_add_f32_dpp v37, v37, v37 row_shr:8 row_mask:0xf bank_mask:0xf
    v_cvt_pk_bf16_f32 v14, v36, v37
    buffer_store_dword v14, v3, s[4:7], s62 offen sc1
    s_branch L_rok0s
    .p2align 6
L_rs0s:
    buffer_load_dwordx4 v[40:43], v10, s[4:7], s66 offen sc1
    buffer_load_dwordx4 v[44:47], v10, s[4:7], s66 offen offset:1024 sc1
    s_sub_u32 s59, s59, 1
    s_cbranch_scc1 L_fail
    s_waitcnt vmcnt(3) lgkmcnt(0)
    v_mfma_f32_16x16x32_bf16 v[36:39], v[20:23], v[24:27], 0
    v_bitop3_b32 v76, v24, v26, s88 bitop3:0x7e
    s_waitcnt vmcnt(2)
    v_mfma_f32_16x16x32_bf16 v[36:39], v[20:23], v[28:31], v[36:39]
    v_bitop3_b32 v77, v28, v30, s88 bitop3:0x7e
    v_bitop3_b32 v76, v76, v77, 1 bitop3:0xa8
    v_cmp_ne_u32 vcc, 0, v76
    v_readfirstlane_b32 s74, v78
    v_mov_b64 v[48:49], 0
    v_mov_b64 v[50:51], 0
    s_cbranch_vccnz L_rr0s
    s_nop 0
    v_add_f32_dpp v36, v36, v36 row_shr:4 row_mask:0xf bank_mask:0xf
    v_add_f32_dpp v37, v37, v37 row_shr:4 row_mask:0xf bank_mask:0xf
    s_nop 0
    v_add_f32_dpp v36, v36, v36 row_shr:8 row_mask:0xf bank_mask:0xf
    v_add_f32_dpp v37, v37, v37 row_shr:8 row_mask:0xf bank_mask:0xf
    v_cvt_pk_bf16_f32 v14, v36, v37
    buffer_store_dword v14, v3, s[4:7], s62 offen sc1
    s_branch L_rok0s
L_kvw0s:
    buffer_load_dword v78, off, s[4:7], s72 sc1
    s_sub_u32 s59, s59, 1
    s_cbranch_scc1 L_fail
    s_waitcnt vmcnt(0)
    v_readfirstlane_b32 s74, v78
    s_nop 0
    s_cmp_gt_u32 s74, s78
    s_cbranch_scc0 L_kvw0s
    s_branch L_kvok0s
    .p2align 6
L_grs:
    buffer_load_dwordx4 v[16:19], v10, s[4:7], s62 offen sc1
    buffer_load_dwordx4 v[20:23], v10, s[4:7], s62 offen offset:1024 sc1
    s_nop 1
    v_mov_b64 v[48:49], 0
    v_mov_b64 v[50:51], 0
    v_mov_b64 v[52:53], 0
    v_mov_b64 v[54:55], 0
    s_sub_u32 s59, s59, 1
    s_cbranch_scc0 L_gws
    s_branch L_fail
L_last:
    buffer_store_dword v14, v3, s[4:7], s68 offen sc1
    s_branch L_end
L_arole:
    s_sub_u32 s60, s58, 1
    s_lshl_b32 s60, s60, 2
    s_cmp_eq_u32 s58, 6
    s_cselect_b32 s60, 24, s60
    s_lshr_b32 s73, s57, 2
    s_add_u32 s60, s60, s73
    s_and_b32 s61, s57, 3
    v_and_b32 v20, 15, v0
    v_lshrrev_b32 v21, 4, v0
    v_and_b32 v22, 3, v0
    v_bfe_u32 v23, v0, 2, 2
    v_lshlrev_b32 v1, 10, v20
    v_lshl_add_u32 v1, v21, 4, v1
    s_lshr_b32 s73, s3, 1
    s_lshl_b32 s73, s73, 14
    s_and_b32 s74, s3, 1
    s_lshl_b32 s74, s74, 9
    s_add_u32 s73, s73, s74
    v_add_u32 v1, s73, v1
    s_lshl_b32 s63, s61, 15
    s_lshl_b32 s64, s3, 13
    s_add_u32 m0, s64, 0
    s_nop 0
    buffer_load_dwordx4 v1, s[12:15], s63 offen offset:0 lds
    s_add_u32 m0, s64, 960
    s_nop 0
    buffer_load_dwordx4 v1, s[12:15], s63 offen offset:64 lds
    s_add_u32 m0, s64, 1920
    s_nop 0
    buffer_load_dwordx4 v1, s[12:15], s63 offen offset:128 lds
    s_add_u32 m0, s64, 2880
    s_nop 0
    buffer_load_dwordx4 v1, s[12:15], s63 offen offset:192 lds
    s_add_u32 m0, s64, 3840
    s_nop 0
    buffer_load_dwordx4 v1, s[12:15], s63 offen offset:256 lds
    s_add_u32 m0, s64, 4800
    s_nop 0
    buffer_load_dwordx4 v1, s[12:15], s63 offen offset:320 lds
    s_add_u32 m0, s64, 5760
    s_nop 0
    buffer_load_dwordx4 v1, s[12:15], s63 offen offset:384 lds
    s_add_u32 m0, s64, 6720
    s_nop 0
    buffer_load_dwordx4 v1, s[12:15], s63 offen offset:448 lds
    s_lshl_b32 s75, s60, 8
    s_lshl_b32 s73, s3, 4
    v_add_u32 v24, s73, v21
    s_mov_b32 s73, 8192
    v_mul_lo_u32 v24, v24, s73
    v_add_u32 v24, s75, v24
    v_lshlrev_b32 v25, 1, v21
    v_xor_b32 v25, v25, v20
    v_lshl_add_u32 v26, v25, 4, v24
    v_xor_b32 v25, 8, v25
    v_lshl_add_u32 v27, v25, 4, v24
    v_lshl_add_u32 v24, v21, 3, v23
    v_lshlrev_b32 v24, 8, v24
    v_and_b32 v25, 1, v22
    v_lshl_add_u32 v24, v25, 3, v24
    v_and_b32 v25, 1, v21
    v_lshlrev_b32 v25, 3, v25
    v_lshl_add_u32 v25, v23, 1, v25
    v_lshrrev_b32 v127, 1, v22
    s_lshl_b32 s73, s3, 2
    v_add_u32 v127, s73, v127
    v_xor_b32 v25, v25, v127
    v_lshl_add_u32 v126, v25, 4, v24
    s_lshl_b32 s74, s3, 12
    s_add_u32 m0, s74, 32768
    s_mov_b32 s73, 0
    buffer_load_dwordx4 v26, s[20:23], s73 offen lds
    s_add_u32 m0, s74, 33792
    s_mov_b32 s73, 32768
    buffer_load_dwordx4 v26, s[20:23], s73 offen lds
    s_add_u32 m0, s74, 34816
    s_mov_b32 s73, 65536
    buffer_load_dwordx4 v27, s[20:23], s73 offen lds
    s_add_u32 m0, s74, 35840
    s_mov_b32 s73, 98304
    buffer_load_dwordx4 v27, s[20:23], s73 offen lds
    s_add_u32 m0, s74, 49152
    s_mov_b32 s73, 524288
    buffer_load_dwordx4 v26, s[20:23], s73 offen lds
    s_add_u32 m0, s74, 50176
    s_mov_b32 s73, 557056
    buffer_load_dwordx4 v26, s[20:23], s73 offen lds
    s_add_u32 m0, s74, 51200
    s_mov_b32 s73, 589824
    buffer_load_dwordx4 v27, s[20:23], s73 offen lds
    s_add_u32 m0, s74, 52224
    s_mov_b32 s73, 622592
    buffer_load_dwordx4 v27, s[20:23], s73 offen lds
    s_add_u32 m0, s74, 65536
    s_mov_b32 s73, 1048576
    buffer_load_dwordx4 v26, s[20:23], s73 offen lds
    s_add_u32 m0, s74, 66560
    s_mov_b32 s73, 1081344
    buffer_load_dwordx4 v26, s[20:23], s73 offen lds
    s_add_u32 m0, s74, 67584
    s_mov_b32 s73, 1114112
    buffer_load_dwordx4 v27, s[20:23], s73 offen lds
    s_add_u32 m0, s74, 68608
    s_mov_b32 s73, 1146880
    buffer_load_dwordx4 v27, s[20:23], s73 offen lds
    s_add_u32 m0, s74, 81920
    s_mov_b32 s73, 1572864
    buffer_load_dwordx4 v26, s[20:23], s73 offen lds
    s_add_u32 m0, s74, 82944
    s_mov_b32 s73, 1605632
    buffer_load_dwordx4 v26, s[20:23], s73 offen lds
    s_add_u32 m0, s74, 83968
    s_mov_b32 s73, 1638400
    buffer_load_dwordx4 v27, s[20:23], s73 offen lds
    s_add_u32 m0, s74, 84992
    s_mov_b32 s73, 1671168
    buffer_load_dwordx4 v27, s[20:23], s73 offen lds
    s_add_u32 m0, s74, 98304
    s_mov_b32 s73, 2097152
    buffer_load_dwordx4 v26, s[20:23], s73 offen lds
    s_add_u32 m0, s74, 99328
    s_mov_b32 s73, 2129920
    buffer_load_dwordx4 v26, s[20:23], s73 offen lds
    s_add_u32 m0, s74, 100352
    s_mov_b32 s73, 2162688
    buffer_load_dwordx4 v27, s[20:23], s73 offen lds
    s_add_u32 m0, s74, 101376
    s_mov_b32 s73, 2195456
    buffer_load_dwordx4 v27, s[20:23], s73 offen lds
    s_add_u32 m0, s74, 114688
    s_mov_b32 s73, 2621440
    buffer_load_dwordx4 v26, s[20:23], s73 offen lds
    s_add_u32 m0, s74, 115712
    s_mov_b32 s73, 2654208
    buffer_load_dwordx4 v26, s[20:23], s73 offen lds
    s_add_u32 m0, s74, 116736
    s_mov_b32 s73, 2686976
    buffer_load_dwordx4 v27, s[20:23], s73 offen lds
    s_add_u32 m0, s74, 117760
    s_mov_b32 s73, 2719744
    buffer_load_dwordx4 v27, s[20:23], s73 offen lds
    s_add_u32 m0, s74, 131072
    s_mov_b32 s73, 3145728
    buffer_load_dwordx4 v26, s[20:23], s73 offen lds
    s_add_u32 m0, s74, 132096
    s_mov_b32 s73, 3178496
    buffer_load_dwordx4 v26, s[20:23], s73 offen lds
    s_add_u32 m0, s74, 133120
    s_mov_b32 s73, 3211264
    buffer_load_dwordx4 v27, s[20:23], s73 offen lds
    s_add_u32 m0, s74, 134144
    s_mov_b32 s73, 3244032
    buffer_load_dwordx4 v27, s[20:23], s73 offen lds
    s_add_u32 m0, s74, 147456
    s_mov_b32 s73, 3670016
    buffer_load_dwordx4 v26, s[20:23], s73 offen lds
    s_add_u32 m0, s74, 148480
    s_mov_b32 s73, 3702784
    buffer_load_dwordx4 v26, s[20:23], s73 offen lds
    s_add_u32 m0, s74, 149504
    s_mov_b32 s73, 3735552
    buffer_load_dwordx4 v27, s[20:23], s73 offen lds
    s_add_u32 m0, s74, 150528
    s_mov_b32 s73, 3768320
    buffer_load_dwordx4 v27, s[20:23], s73 offen lds
    s_waitcnt vmcnt(16)
    s_barrier
    v_xor_b32 v127, 0, v126
    v_add_u32 v127, 32768, v127
    ds_read_b64_tr_b16 v[128:129], v127 offset:0
    ds_read_b64_tr_b16 v[130:131], v127 offset:1024
    ds_read_b64_tr_b16 v[136:137], v127 offset:8192
    ds_read_b64_tr_b16 v[138:139], v127 offset:9216
    ds_read_b64_tr_b16 v[144:145], v127 offset:16384
    ds_read_b64_tr_b16 v[146:147], v127 offset:17408
    ds_read_b64_tr_b16 v[152:153], v127 offset:24576
    ds_read_b64_tr_b16 v[154:155], v127 offset:25600
    ds_read_b64_tr_b16 v[160:161], v127 offset:32768
    ds_read_b64_tr_b16 v[162:163], v127 offset:33792
    ds_read_b64_tr_b16 v[168:169], v127 offset:40960
    ds_read_b64_tr_b16 v[170:171], v127 offset:41984
    ds_read_b64_tr_b16 v[176:177], v127 offset:49152
    ds_read_b64_tr_b16 v[178:179], v127 offset:50176
    ds_read_b64_tr_b16 v[184:185], v127 offset:57344
    ds_read_b64_tr_b16 v[186:187], v127 offset:58368
    v_xor_b32 v127, 32, v126
    v_add_u32 v127, 32768, v127
    ds_read_b64_tr_b16 v[132:133], v127 offset:0
    ds_read_b64_tr_b16 v[134:135], v127 offset:1024
    ds_read_b64_tr_b16 v[140:141], v127 offset:8192
    ds_read_b64_tr_b16 v[142:143], v127 offset:9216
    ds_read_b64_tr_b16 v[148:149], v127 offset:16384
    ds_read_b64_tr_b16 v[150:151], v127 offset:17408
    ds_read_b64_tr_b16 v[156:157], v127 offset:24576
    ds_read_b64_tr_b16 v[158:159], v127 offset:25600
    ds_read_b64_tr_b16 v[164:165], v127 offset:32768
    ds_read_b64_tr_b16 v[166:167], v127 offset:33792
    ds_read_b64_tr_b16 v[172:173], v127 offset:40960
    ds_read_b64_tr_b16 v[174:175], v127 offset:41984
    ds_read_b64_tr_b16 v[180:181], v127 offset:49152
    ds_read_b64_tr_b16 v[182:183], v127 offset:50176
    ds_read_b64_tr_b16 v[188:189], v127 offset:57344
    ds_read_b64_tr_b16 v[190:191], v127 offset:58368
    s_waitcnt lgkmcnt(0)
    s_barrier
    s_add_u32 m0, s74, 32768
    s_mov_b32 s73, 0
    buffer_load_dwordx4 v26, s[24:27], s73 offen lds
    s_add_u32 m0, s74, 33792
    s_mov_b32 s73, 32768
    buffer_load_dwordx4 v26, s[24:27], s73 offen lds
    s_add_u32 m0, s74, 34816
    s_mov_b32 s73, 65536
    buffer_load_dwordx4 v27, s[24:27], s73 offen lds
    s_add_u32 m0, s74, 35840
    s_mov_b32 s73, 98304
    buffer_load_dwordx4 v27, s[24:27], s73 offen lds
    s_add_u32 m0, s74, 49152
    s_mov_b32 s73, 524288
    buffer_load_dwordx4 v26, s[24:27], s73 offen lds
    s_add_u32 m0, s74, 50176
    s_mov_b32 s73, 557056
    buffer_load_dwordx4 v26, s[24:27], s73 offen lds
    s_add_u32 m0, s74, 51200
    s_mov_b32 s73, 589824
    buffer_load_dwordx4 v27, s[24:27], s73 offen lds
    s_add_u32 m0, s74, 52224
    s_mov_b32 s73, 622592
    buffer_load_dwordx4 v27, s[24:27], s73 offen lds
    s_add_u32 m0, s74, 65536
    s_mov_b32 s73, 1048576
    buffer_load_dwordx4 v26, s[24:27], s73 offen lds
    s_add_u32 m0, s74, 66560
    s_mov_b32 s73, 1081344
    buffer_load_dwordx4 v26, s[24:27], s73 offen lds
    s_add_u32 m0, s74, 67584
    s_mov_b32 s73, 1114112
    buffer_load_dwordx4 v27, s[24:27], s73 offen lds
    s_add_u32 m0, s74, 68608
    s_mov_b32 s73, 1146880
    buffer_load_dwordx4 v27, s[24:27], s73 offen lds
    s_add_u32 m0, s74, 81920
    s_mov_b32 s73, 1572864
    buffer_load_dwordx4 v26, s[24:27], s73 offen lds
    s_add_u32 m0, s74, 82944
    s_mov_b32 s73, 1605632
    buffer_load_dwordx4 v26, s[24:27], s73 offen lds
    s_add_u32 m0, s74, 83968
    s_mov_b32 s73, 1638400
    buffer_load_dwordx4 v27, s[24:27], s73 offen lds
    s_add_u32 m0, s74, 84992
    s_mov_b32 s73, 1671168
    buffer_load_dwordx4 v27, s[24:27], s73 offen lds
    s_waitcnt vmcnt(16)
    s_barrier
    v_xor_b32 v127, 0, v126
    v_add_u32 v127, 98304, v127
    ds_read_b64_tr_b16 v[192:193], v127 offset:0
    ds_read_b64_tr_b16 v[194:195], v127 offset:1024
    ds_read_b64_tr_b16 v[200:201], v127 offset:8192
    ds_read_b64_tr_b16 v[202:203], v127 offset:9216
    ds_read_b64_tr_b16 v[208:209], v127 offset:16384
    ds_read_b64_tr_b16 v[210:211], v127 offset:17408
    ds_read_b64_tr_b16 v[216:217], v127 offset:24576
    ds_read_b64_tr_b16 v[218:219], v127 offset:25600
    ds_read_b64_tr_b16 v[224:225], v127 offset:32768
    ds_read_b64_tr_b16 v[226:227], v127 offset:33792
    ds_read_b64_tr_b16 v[232:233], v127 offset:40960
    ds_read_b64_tr_b16 v[234:235], v127 offset:41984
    ds_read_b64_tr_b16 v[240:241], v127 offset:49152
    ds_read_b64_tr_b16 v[242:243], v127 offset:50176
    ds_read_b64_tr_b16 v[248:249], v127 offset:57344
    ds_read_b64_tr_b16 v[250:251], v127 offset:58368
    v_xor_b32 v127, 32, v126
    v_add_u32 v127, 98304, v127
    ds_read_b64_tr_b16 v[196:197], v127 offset:0
    ds_read_b64_tr_b16 v[198:199], v127 offset:1024
    ds_read_b64_tr_b16 v[204:205], v127 offset:8192
    ds_read_b64_tr_b16 v[206:207], v127 offset:9216
    ds_read_b64_tr_b16 v[212:213], v127 offset:16384
    ds_read_b64_tr_b16 v[214:215], v127 offset:17408
    ds_read_b64_tr_b16 v[220:221], v127 offset:24576
    ds_read_b64_tr_b16 v[222:223], v127 offset:25600
    ds_read_b64_tr_b16 v[228:229], v127 offset:32768
    ds_read_b64_tr_b16 v[230:231], v127 offset:33792
    ds_read_b64_tr_b16 v[236:237], v127 offset:40960
    ds_read_b64_tr_b16 v[238:239], v127 offset:41984
    ds_read_b64_tr_b16 v[244:245], v127 offset:49152
    ds_read_b64_tr_b16 v[246:247], v127 offset:50176
    ds_read_b64_tr_b16 v[252:253], v127 offset:57344
    ds_read_b64_tr_b16 v[254:255], v127 offset:58368
    s_waitcnt lgkmcnt(0)
    s_barrier
    s_add_u32 m0, s74, 98304
    s_mov_b32 s73, 2097152
    buffer_load_dwordx4 v26, s[24:27], s73 offen lds
    s_add_u32 m0, s74, 99328
    s_mov_b32 s73, 2129920
    buffer_load_dwordx4 v26, s[24:27], s73 offen lds
    s_add_u32 m0, s74, 100352
    s_mov_b32 s73, 2162688
    buffer_load_dwordx4 v27, s[24:27], s73 offen lds
    s_add_u32 m0, s74, 101376
    s_mov_b32 s73, 2195456
    buffer_load_dwordx4 v27, s[24:27], s73 offen lds
    s_add_u32 m0, s74, 114688
    s_mov_b32 s73, 2621440
    buffer_load_dwordx4 v26, s[24:27], s73 offen lds
    s_add_u32 m0, s74, 115712
    s_mov_b32 s73, 2654208
    buffer_load_dwordx4 v26, s[24:27], s73 offen lds
    s_add_u32 m0, s74, 116736
    s_mov_b32 s73, 2686976
    buffer_load_dwordx4 v27, s[24:27], s73 offen lds
    s_add_u32 m0, s74, 117760
    s_mov_b32 s73, 2719744
    buffer_load_dwordx4 v27, s[24:27], s73 offen lds
    s_add_u32 m0, s74, 131072
    s_mov_b32 s73, 3145728
    buffer_load_dwordx4 v26, s[24:27], s73 offen lds
    s_add_u32 m0, s74, 132096
    s_mov_b32 s73, 3178496
    buffer_load_dwordx4 v26, s[24:27], s73 offen lds
    s_add_u32 m0, s74, 133120
    s_mov_b32 s73, 3211264
    buffer_load_dwordx4 v27, s[24:27], s73 offen lds
    s_add_u32 m0, s74, 134144
    s_mov_b32 s73, 3244032
    buffer_load_dwordx4 v27, s[24:27], s73 offen lds
    s_add_u32 m0, s74, 147456
    s_mov_b32 s73, 3670016
    buffer_load_dwordx4 v26, s[24:27], s73 offen lds
    s_add_u32 m0, s74, 148480
    s_mov_b32 s73, 3702784
    buffer_load_dwordx4 v26, s[24:27], s73 offen lds
    s_add_u32 m0, s74, 149504
    s_mov_b32 s73, 3735552
    buffer_load_dwordx4 v27, s[24:27], s73 offen lds
    s_add_u32 m0, s74, 150528
    s_mov_b32 s73, 3768320
    buffer_load_dwordx4 v27, s[24:27], s73 offen lds
    s_waitcnt vmcnt(16)
    s_barrier
    v_xor_b32 v127, 0, v126
    v_add_u32 v127, 32768, v127
    ds_read_b64_tr_b16 a[0:1], v127 offset:0
    ds_read_b64_tr_b16 a[2:3], v127 offset:1024
    ds_read_b64_tr_b16 a[8:9], v127 offset:8192
    ds_read_b64_tr_b16 a[10:11], v127 offset:9216
    ds_read_b64_tr_b16 a[16:17], v127 offset:16384
    ds_read_b64_tr_b16 a[18:19], v127 offset:17408
    ds_read_b64_tr_b16 a[24:25], v127 offset:24576
    ds_read_b64_tr_b16 a[26:27], v127 offset:25600
    ds_read_b64_tr_b16 a[32:33], v127 offset:32768
    ds_read_b64_tr_b16 a[34:35], v127 offset:33792
    ds_read_b64_tr_b16 a[40:41], v127 offset:40960
    ds_read_b64_tr_b16 a[42:43], v127 offset:41984
    ds_read_b64_tr_b16 a[48:49], v127 offset:49152
    ds_read_b64_tr_b16 a[50:51], v127 offset:50176
    ds_read_b64_tr_b16 a[56:57], v127 offset:57344
    ds_read_b64_tr_b16 a[58:59], v127 offset:58368
    v_xor_b32 v127, 32, v126
    v_add_u32 v127, 32768, v127
    ds_read_b64_tr_b16 a[4:5], v127 offset:0
    ds_read_b64_tr_b16 a[6:7], v127 offset:1024
    ds_read_b64_tr_b16 a[12:13], v127 offset:8192
    ds_read_b64_tr_b16 a[14:15], v127 offset:9216
    ds_read_b64_tr_b16 a[20:21], v127 offset:16384
    ds_read_b64_tr_b16 a[22:23], v127 offset:17408
    ds_read_b64_tr_b16 a[28:29], v127 offset:24576
    ds_read_b64_tr_b16 a[30:31], v127 offset:25600
    ds_read_b64_tr_b16 a[36:37], v127 offset:32768
    ds_read_b64_tr_b16 a[38:39], v127 offset:33792
    ds_read_b64_tr_b16 a[44:45], v127 offset:40960
    ds_read_b64_tr_b16 a[46:47], v127 offset:41984
    ds_read_b64_tr_b16 a[52:53], v127 offset:49152
    ds_read_b64_tr_b16 a[54:55], v127 offset:50176
    ds_read_b64_tr_b16 a[60:61], v127 offset:57344
    ds_read_b64_tr_b16 a[62:63], v127 offset:58368
    s_waitcnt lgkmcnt(0)
    s_barrier
    s_add_u32 m0, s74, 32768
    s_mov_b32 s73, 0
    buffer_load_dwordx4 v26, s[16:19], s73 offen lds
    s_add_u32 m0, s74, 33792
    s_mov_b32 s73, 32768
    buffer_load_dwordx4 v26, s[16:19], s73 offen lds
    s_add_u32 m0, s74, 34816
    s_mov_b32 s73, 65536
    buffer_load_dwordx4 v27, s[16:19], s73 offen lds
    s_add_u32 m0, s74, 35840
    s_mov_b32 s73, 98304
    buffer_load_dwordx4 v27, s[16:19], s73 offen lds
    s_add_u32 m0, s74, 49152
    s_mov_b32 s73, 524288
    buffer_load_dwordx4 v26, s[16:19], s73 offen lds
    s_add_u32 m0, s74, 50176
    s_mov_b32 s73, 557056
    buffer_load_dwordx4 v26, s[16:19], s73 offen lds
    s_add_u32 m0, s74, 51200
    s_mov_b32 s73, 589824
    buffer_load_dwordx4 v27, s[16:19], s73 offen lds
    s_add_u32 m0, s74, 52224
    s_mov_b32 s73, 622592
    buffer_load_dwordx4 v27, s[16:19], s73 offen lds
    s_add_u32 m0, s74, 65536
    s_mov_b32 s73, 1048576
    buffer_load_dwordx4 v26, s[16:19], s73 offen lds
    s_add_u32 m0, s74, 66560
    s_mov_b32 s73, 1081344
    buffer_load_dwordx4 v26, s[16:19], s73 offen lds
    s_add_u32 m0, s74, 67584
    s_mov_b32 s73, 1114112
    buffer_load_dwordx4 v27, s[16:19], s73 offen lds
    s_add_u32 m0, s74, 68608
    s_mov_b32 s73, 1146880
    buffer_load_dwordx4 v27, s[16:19], s73 offen lds
    s_add_u32 m0, s74, 81920
    s_mov_b32 s73, 1572864
    buffer_load_dwordx4 v26, s[16:19], s73 offen lds
    s_add_u32 m0, s74, 82944
    s_mov_b32 s73, 1605632
    buffer_load_dwordx4 v26, s[16:19], s73 offen lds
    s_add_u32 m0, s74, 83968
    s_mov_b32 s73, 1638400
    buffer_load_dwordx4 v27, s[16:19], s73 offen lds
    s_add_u32 m0, s74, 84992
    s_mov_b32 s73, 1671168
    buffer_load_dwordx4 v27, s[16:19], s73 offen lds
    s_waitcnt vmcnt(16)
    s_barrier
    v_xor_b32 v127, 0, v126
    v_add_u32 v127, 98304, v127
    ds_read_b64_tr_b16 a[64:65], v127 offset:0
    ds_read_b64_tr_b16 a[66:67], v127 offset:1024
    ds_read_b64_tr_b16 a[72:73], v127 offset:8192
    ds_read_b64_tr_b16 a[74:75], v127 offset:9216
    ds_read_b64_tr_b16 a[80:81], v127 offset:16384
    ds_read_b64_tr_b16 a[82:83], v127 offset:17408
    ds_read_b64_tr_b16 a[88:89], v127 offset:24576
    ds_read_b64_tr_b16 a[90:91], v127 offset:25600
    ds_read_b64_tr_b16 a[96:97], v127 offset:32768
    ds_read_b64_tr_b16 a[98:99], v127 offset:33792
    ds_read_b64_tr_b16 a[104:105], v127 offset:40960
    ds_read_b64_tr_b16 a[106:107], v127 offset:41984
    ds_read_b64_tr_b16 a[112:113], v127 offset:49152
    ds_read_b64_tr_b16 a[114:115], v127 offset:50176
    ds_read_b64_tr_b16 a[120:121], v127 offset:57344
    ds_read_b64_tr_b16 a[122:123], v127 offset:58368
    v_xor_b32 v127, 32, v126
    v_add_u32 v127, 98304, v127
    ds_read_b64_tr_b16 a[68:69], v127 offset:0
    ds_read_b64_tr_b16 a[70:71], v127 offset:1024
    ds_read_b64_tr_b16 a[76:77], v127 offset:8192
    ds_read_b64_tr_b16 a[78:79], v127 offset:9216
    ds_read_b64_tr_b16 a[84:85], v127 offset:16384
    ds_read_b64_tr_b16 a[86:87], v127 offset:17408
    ds_read_b64_tr_b16 a[92:93], v127 offset:24576
    ds_read_b64_tr_b16 a[94:95], v127 offset:25600
    ds_read_b64_tr_b16 a[100:101], v127 offset:32768
    ds_read_b64_tr_b16 a[102:103], v127 offset:33792
    ds_read_b64_tr_b16 a[108:109], v127 offset:40960
    ds_read_b64_tr_b16 a[110:111], v127 offset:41984
    ds_read_b64_tr_b16 a[116:117], v127 offset:49152
    ds_read_b64_tr_b16 a[118:119], v127 offset:50176
    ds_read_b64_tr_b16 a[124:125], v127 offset:57344
    ds_read_b64_tr_b16 a[126:127], v127 offset:58368
    s_waitcnt lgkmcnt(0)
    s_barrier
    s_add_u32 m0, s74, 98304
    s_mov_b32 s73, 2097152
    buffer_load_dwordx4 v26, s[16:19], s73 offen lds
    s_add_u32 m0, s74, 99328
    s_mov_b32 s73, 2129920
    buffer_load_dwordx4 v26, s[16:19], s73 offen lds
    s_add_u32 m0, s74, 100352
    s_mov_b32 s73, 2162688
    buffer_load_dwordx4 v27, s[16:19], s73 offen lds
    s_add_u32 m0, s74, 101376
    s_mov_b32 s73, 2195456
    buffer_load_dwordx4 v27, s[16:19], s73 offen lds
    s_add_u32 m0, s74, 114688
    s_mov_b32 s73, 2621440
    buffer_load_dwordx4 v26, s[16:19], s73 offen lds
    s_add_u32 m0, s74, 115712
    s_mov_b32 s73, 2654208
    buffer_load_dwordx4 v26, s[16:19], s73 offen lds
    s_add_u32 m0, s74, 116736
    s_mov_b32 s73, 2686976
    buffer_load_dwordx4 v27, s[16:19], s73 offen lds
    s_add_u32 m0, s74, 117760
    s_mov_b32 s73, 2719744
    buffer_load_dwordx4 v27, s[16:19], s73 offen lds
    s_add_u32 m0, s74, 131072
    s_mov_b32 s73, 3145728
    buffer_load_dwordx4 v26, s[16:19], s73 offen lds
    s_add_u32 m0, s74, 132096
    s_mov_b32 s73, 3178496
    buffer_load_dwordx4 v26, s[16:19], s73 offen lds
    s_add_u32 m0, s74, 133120
    s_mov_b32 s73, 3211264
    buffer_load_dwordx4 v27, s[16:19], s73 offen lds
    s_add_u32 m0, s74, 134144
    s_mov_b32 s73, 3244032
    buffer_load_dwordx4 v27, s[16:19], s73 offen lds
    s_add_u32 m0, s74, 147456
    s_mov_b32 s73, 3670016
    buffer_load_dwordx4 v26, s[16:19], s73 offen lds
    s_add_u32 m0, s74, 148480
    s_mov_b32 s73, 3702784
    buffer_load_dwordx4 v26, s[16:19], s73 offen lds
    s_add_u32 m0, s74, 149504
    s_mov_b32 s73, 3735552
    buffer_load_dwordx4 v27, s[16:19], s73 offen lds
    s_add_u32 m0, s74, 150528
    s_mov_b32 s73, 3768320
    buffer_load_dwordx4 v27, s[16:19], s73 offen lds
    s_add_u32 s63, s63, 131072
    s_xor_b32 s64, s64, 0x8000
    v_lshlrev_b32 v24, 2, v21
    v_add_u32 v25, 0, v24
    v_cmp_le_u32 s[86:87], v25, v20
    v_add_u32 v25, 1, v24
    v_cmp_le_u32 s[88:89], v25, v20
    v_add_u32 v25, 2, v24
    v_cmp_le_u32 s[90:91], v25, v20
    v_add_u32 v25, 3, v24
    v_cmp_le_u32 s[92:93], v25, v20
    s_mov_b32 s94, -1
    s_mov_b32 s95, 0
    s_mov_b32 s70, 0x3e0293ee
    s_mov_b32 s71, 0xbe0293ee
    v_and_b32 v24, 1, v20
    v_mov_b32 v124, 0x05040100
    v_mov_b32 v25, 0x03020706
    v_cmp_eq_u32 vcc, 1, v24
    s_nop 1
    v_cndmask_b32 v124, v124, v25, vcc
    v_lshlrev_b32 v6, 9, v24
    v_lshrrev_b32 v24, 1, v21
    v_lshl_add_u32 v6, v24, 12, v6
    v_lshrrev_b32 v24, 1, v20
    v_lshl_add_u32 v6, v24, 4, v6
    v_and_b32 v24, 1, v21
    v_lshl_add_u32 v6, v24, 8, v6
    s_lshl_b32 s73, s3, 10
    s_add_u32 s73, s73, 131072
    v_add_u32 v6, s73, v6
    s_lshl_b32 s73, s3, 12
    s_add_u32 s73, s73, 131072
    v_lshlrev_b32 v0, 4, v0
    v_add_u32 v7, 131072, v0
    v_mov_b32 v2, v0
    s_lshl_b32 s74, s3, 10
    s_add_u32 s75, s74, 65536
    v_add_u32 v3, s75, v0
    v_add_u32 v4, 65536, v0
    s_add_u32 s75, s74, 147456
    v_add_u32 v9, s75, v0
    s_lshl_b32 s74, s3, 11
    v_add_u32 v5, s74, v0
    v_mov_b32 v8, 0xff800000
    v_mov_b32 v12, 0x3f803f80
    v_mov_b32 v13, 0x3f803f80
    v_mov_b32 v14, 0x3f803f80
    v_mov_b32 v15, 0x3f803f80
    v_add_u32 v125, s73, v0
    s_lshl_b32 s73, s61, 5
    s_add_u32 s73, s73, s60
    s_lshl_b32 s65, s73, 14
    s_add_u32 s65, s65, 2097152
    s_lshl_b32 s67, s61, 6
    s_add_u32 s67, s67, 266240
    s_lshl_b32 s66, s60, 7
    s_lshl_b32 s73, s61, 2
    s_add_u32 s66, s66, s73
    s_add_u32 s66, s66, 262144
    s_lshl_b32 s68, s61, 13
    s_add_u32 s68, s68, 524288
    s_mul_i32 s69, s61, 360448
    s_lshl_b32 s73, s60, 12
    s_add_u32 s69, s69, s73
    s_lshl_b32 s73, s3, 10
    s_add_u32 s69, s69, s73
    s_add_u32 s69, s69, 52428800
    s_mov_b32 s62, 0
    s_mov_b32 s78, 0
    s_branch L_a_proj1
L_a_proj:
    s_waitcnt vmcnt(8)
    s_barrier
L_a_proj1:
    ds_read_b128 v[64:67], v2 offset:0
    ds_read_b128 v[68:71], v2 offset:16384
    ds_read_b128 v[72:75], v2 offset:1024
    ds_read_b128 v[76:79], v2 offset:17408
    s_waitcnt lgkmcnt(2)
    v_mfma_f32_16x16x32_bf16 v[16:19], v[128:131], v[64:67], 0
    v_mfma_f32_16x16x32_bf16 v[48:51], v[64:67], a[0:3], 0
    v_mfma_f32_16x16x32_bf16 v[20:23], v[132:135], v[64:67], 0
    v_mfma_f32_16x16x32_bf16 v[56:59], v[64:67], a[4:7], 0
    v_mfma_f32_16x16x32_bf16 v[24:27], v[128:131], v[68:71], 0
    v_mfma_f32_16x16x32_bf16 v[52:55], v[68:71], a[0:3], 0
    v_mfma_f32_16x16x32_bf16 v[28:31], v[132:135], v[68:71], 0
    v_mfma_f32_16x16x32_bf16 v[60:63], v[68:71], a[4:7], 0
    ds_read_b128 v[64:67], v2 offset:2048
    ds_read_b128 v[68:71], v2 offset:18432
    s_waitcnt lgkmcnt(2)
    v_mfma_f32_16x16x32_bf16 v[16:19], v[136:139], v[72:75], v[16:19]
    v_mfma_f32_16x16x32_bf16 v[48:51], v[72:75], a[8:11], v[48:51]
    v_mfma_f32_16x16x32_bf16 v[20:23], v[140:143], v[72:75], v[20:23]
    v_mfma_f32_16x16x32_bf16 v[56:59], v[72:75], a[12:15], v[56:59]
    v_mfma_f32_16x16x32_bf16 v[24:27], v[136:139], v[76:79], v[24:27]
    v_mfma_f32_16x16x32_bf16 v[52:55], v[76:79], a[8:11], v[52:55]
    v_mfma_f32_16x16x32_bf16 v[28:31], v[140:143], v[76:79], v[28:31]
    v_mfma_f32_16x16x32_bf16 v[60:63], v[76:79], a[12:15], v[60:63]
    ds_read_b128 v[72:75], v2 offset:3072
    ds_read_b128 v[76:79], v2 offset:19456
    s_waitcnt lgkmcnt(2)
    v_mfma_f32_16x16x32_bf16 v[16:19], v[144:147], v[64:67], v[16:19]
    v_mfma_f32_16x16x32_bf16 v[48:51], v[64:67], a[16:19], v[48:51]
    v_mfma_f32_16x16x32_bf16 v[20:23], v[148:151], v[64:67], v[20:23]
    v_mfma_f32_16x16x32_bf16 v[56:59], v[64:67], a[20:23], v[56:59]
    v_mfma_f32_16x16x32_bf16 v[24:27], v[144:147], v[68:71], v[24:27]
    v_mfma_f32_16x16x32_bf16 v[52:55], v[68:71], a[16:19], v[52:55]
    v_mfma_f32_16x16x32_bf16 v[28:31], v[148:151], v[68:71], v[28:31]
    v_mfma_f32_16x16x32_bf16 v[60:63], v[68:71], a[20:23], v[60:63]
    ds_read_b128 v[64:67], v2 offset:4096
    ds_read_b128 v[68:71], v2 offset:20480
    s_waitcnt lgkmcnt(2)
    v_mfma_f32_16x16x32_bf16 v[16:19], v[152:155], v[72:75], v[16:19]
    v_mfma_f32_16x16x32_bf16 v[48:51], v[72:75], a[24:27], v[48:51]
    v_mfma_f32_16x16x32_bf16 v[20:23], v[156:159], v[72:75], v[20:23]
    v_mfma_f32_16x16x32_bf16 v[56:59], v[72:75], a[28:31], v[56:59]
    v_mfma_f32_16x16x32_bf16 v[24:27], v[152:155], v[76:79], v[24:27]
    v_mfma_f32_16x16x32_bf16 v[52:55], v[76:79], a[24:27], v[52:55]
    v_mfma_f32_16x16x32_bf16 v[28:31], v[156:159], v[76:79], v[28:31]
    v_mfma_f32_16x16x32_bf16 v[60:63], v[76:79], a[28:31], v[60:63]
    ds_read_b128 v[72:75], v2 offset:5120
    ds_read_b128 v[76:79], v2 offset:21504
    s_waitcnt lgkmcnt(2)
    v_mfma_f32_16x16x32_bf16 v[16:19], v[160:163], v[64:67], v[16:19]
    v_mfma_f32_16x16x32_bf16 v[48:51], v[64:67], a[32:35], v[48:51]
    v_mfma_f32_16x16x32_bf16 v[20:23], v[164:167], v[64:67], v[20:23]
    v_mfma_f32_16x16x32_bf16 v[56:59], v[64:67], a[36:39], v[56:59]
    v_mfma_f32_16x16x32_bf16 v[24:27], v[160:163], v[68:71], v[24:27]
    v_mfma_f32_16x16x32_bf16 v[52:55], v[68:71], a[32:35], v[52:55]
    v_mfma_f32_16x16x32_bf16 v[28:31], v[164:167], v[68:71], v[28:31]
    v_mfma_f32_16x16x32_bf16 v[60:63], v[68:71], a[36:39], v[60:63]
    ds_read_b128 v[64:67], v2 offset:6144
    ds_read_b128 v[68:71], v2 offset:22528
    s_waitcnt lgkmcnt(2)
    v_mfma_f32_16x16x32_bf16 v[16:19], v[168:171], v[72:75], v[16:19]
    v_mfma_f32_16x16x32_bf16 v[48:51], v[72:75], a[40:43], v[48:51]
    v_mfma_f32_16x16x32_bf16 v[20:23], v[172:175], v[72:75], v[20:23]
    v_mfma_f32_16x16x32_bf16 v[56:59], v[72:75], a[44:47], v[56:59]
    v_mfma_f32_16x16x32_bf16 v[24:27], v[168:171], v[76:79], v[24:27]
    v_mfma_f32_16x16x32_bf16 v[52:55], v[76:79], a[40:43], v[52:55]
    v_mfma_f32_16x16x32_bf16 v[28:31], v[172:175], v[76:79], v[28:31]
    v_mfma_f32_16x16x32_bf16 v[60:63], v[76:79], a[44:47], v[60:63]
    ds_read_b128 v[72:75], v2 offset:7168
    ds_read_b128 v[76:79], v2 offset:23552
    s_waitcnt lgkmcnt(2)
    v_mfma_f32_16x16x32_bf16 v[16:19], v[176:179], v[64:67], v[16:19]
    v_mfma_f32_16x16x32_bf16 v[48:51], v[64:67], a[48:51], v[48:51]
    v_mfma_f32_16x16x32_bf16 v[20:23], v[180:183], v[64:67], v[20:23]
    v_mfma_f32_16x16x32_bf16 v[56:59], v[64:67], a[52:55], v[56:59]
    v_mfma_f32_16x16x32_bf16 v[24:27], v[176:179], v[68:71], v[24:27]
    v_mfma_f32_16x16x32_bf16 v[52:55], v[68:71], a[48:51], v[52:55]
    v_mfma_f32_16x16x32_bf16 v[28:31], v[180:183], v[68:71], v[28:31]
    v_mfma_f32_16x16x32_bf16 v[60:63], v[68:71], a[52:55], v[60:63]
    ds_read_b128 v[64:67], v2 offset:8192
    ds_read_b128 v[68:71], v2 offset:24576
    s_waitcnt lgkmcnt(2)
    v_mfma_f32_16x16x32_bf16 v[16:19], v[184:187], v[72:75], v[16:19]
    v_mfma_f32_16x16x32_bf16 v[48:51], v[72:75], a[56:59], v[48:51]
    v_mfma_f32_16x16x32_bf16 v[20:23], v[188:191], v[72:75], v[20:23]
    v_mfma_f32_16x16x32_bf16 v[56:59], v[72:75], a[60:63], v[56:59]
    v_mfma_f32_16x16x32_bf16 v[24:27], v[184:187], v[76:79], v[24:27]
    v_mfma_f32_16x16x32_bf16 v[52:55], v[76:79], a[56:59], v[52:55]
    v_mfma_f32_16x16x32_bf16 v[28:31], v[188:191], v[76:79], v[28:31]
    v_mfma_f32_16x16x32_bf16 v[60:63], v[76:79], a[60:63], v[60:63]
    ds_read_b128 v[72:75], v2 offset:9216
    ds_read_b128 v[76:79], v2 offset:25600
    s_waitcnt lgkmcnt(2)
    v_mfma_f32_16x16x32_bf16 v[16:19], v[192:195], v[64:67], v[16:19]
    v_mfma_f32_16x16x32_bf16 v[48:51], v[64:67], a[64:67], v[48:51]
    v_mfma_f32_16x16x32_bf16 v[20:23], v[196:199], v[64:67], v[20:23]
    v_mfma_f32_16x16x32_bf16 v[56:59], v[64:67], a[68:71], v[56:59]
    v_mfma_f32_16x16x32_bf16 v[24:27], v[192:195], v[68:71], v[24:27]
    v_mfma_f32_16x16x32_bf16 v[52:55], v[68:71], a[64:67], v[52:55]
    v_mfma_f32_16x16x32_bf16 v[28:31], v[196:199], v[68:71], v[28:31]
    v_mfma_f32_16x16x32_bf16 v[60:63], v[68:71], a[68:71], v[60:63]
    ds_read_b128 v[64:67], v2 offset:10240
    ds_read_b128 v[68:71], v2 offset:26624
    s_waitcnt lgkmcnt(2)
    v_mfma_f32_16x16x32_bf16 v[16:19], v[200:203], v[72:75], v[16:19]
    v_mfma_f32_16x16x32_bf16 v[48:51], v[72:75], a[72:75], v[48:51]
    v_mfma_f32_16x16x32_bf16 v[20:23], v[204:207], v[72:75], v[20:23]
    v_mfma_f32_16x16x32_bf16 v[56:59], v[72:75], a[76:79], v[56:59]
    v_mfma_f32_16x16x32_bf16 v[24:27], v[200:203], v[76:79], v[24:27]
    v_mfma_f32_16x16x32_bf16 v[52:55], v[76:79], a[72:75], v[52:55]
    v_mfma_f32_16x16x32_bf16 v[28:31], v[204:207], v[76:79], v[28:31]
    v_mfma_f32_16x16x32_bf16 v[60:63], v[76:79], a[76:79], v[60:63]
    ds_read_b128 v[72:75], v2 offset:11264
    ds_read_b128 v[76:79], v2 offset:27648
    s_waitcnt lgkmcnt(2)
    v_mfma_f32_16x16x32_bf16 v[16:19], v[208:211], v[64:67], v[16:19]
    v_mfma_f32_16x16x32_bf16 v[48:51], v[64:67], a[80:83], v[48:51]
    v_mfma_f32_16x16x32_bf16 v[20:23], v[212:215], v[64:67], v[20:23]
    v_mfma_f32_16x16x32_bf16 v[56:59], v[64:67], a[84:87], v[56:59]
    v_mfma_f32_16x16x32_bf16 v[24:27], v[208:211], v[68:71], v[24:27]
    v_mfma_f32_16x16x32_bf16 v[52:55], v[68:71], a[80:83], v[52:55]
    v_mfma_f32_16x16x32_bf16 v[28:31], v[212:215], v[68:71], v[28:31]
    v_mfma_f32_16x16x32_bf16 v[60:63], v[68:71], a[84:87], v[60:63]
    ds_read_b128 v[64:67], v2 offset:12288
    ds_read_b128 v[68:71], v2 offset:28672
    s_waitcnt lgkmcnt(2)
    v_mfma_f32_16x16x32_bf16 v[16:19], v[216:219], v[72:75], v[16:19]
    v_mfma_f32_16x16x32_bf16 v[48:51], v[72:75], a[88:91], v[48:51]
    v_mfma_f32_16x16x32_bf16 v[20:23], v[220:223], v[72:75], v[20:23]
    v_mfma_f32_16x16x32_bf16 v[56:59], v[72:75], a[92:95], v[56:59]
    v_mfma_f32_16x16x32_bf16 v[24:27], v[216:219], v[76:79], v[24:27]
    v_mfma_f32_16x16x32_bf16 v[52:55], v[76:79], a[88:91], v[52:55]
    v_mfma_f32_16x16x32_bf16 v[28:31], v[220:223], v[76:79], v[28:31]
    v_mfma_f32_16x16x32_bf16 v[60:63], v[76:79], a[92:95], v[60:63]
    ds_read_b128 v[72:75], v2 offset:13312
    ds_read_b128 v[76:79], v2 offset:29696
    s_waitcnt lgkmcnt(2)
    v_mfma_f32_16x16x32_bf16 v[16:19], v[224:227], v[64:67], v[16:19]
    v_mfma_f32_16x16x32_bf16 v[48:51], v[64:67], a[96:99], v[48:51]
    v_mfma_f32_16x16x32_bf16 v[20:23], v[228:231], v[64:67], v[20:23]
    v_mfma_f32_16x16x32_bf16 v[56:59], v[64:67], a[100:103], v[56:59]
    v_mfma_f32_16x16x32_bf16 v[24:27], v[224:227], v[68:71], v[24:27]
    v_mfma_f32_16x16x32_bf16 v[52:55], v[68:71], a[96:99], v[52:55]
    v_mfma_f32_16x16x32_bf16 v[28:31], v[228:231], v[68:71], v[28:31]
    v_mfma_f32_16x16x32_bf16 v[60:63], v[68:71], a[100:103], v[60:63]
    ds_read_b128 v[64:67], v2 offset:14336
    ds_read_b128 v[68:71], v2 offset:30720
    s_waitcnt lgkmcnt(2)
    v_mfma_f32_16x16x32_bf16 v[16:19], v[232:235], v[72:75], v[16:19]
    v_mfma_f32_16x16x32_bf16 v[48:51], v[72:75], a[104:107], v[48:51]
    v_mfma_f32_16x16x32_bf16 v[20:23], v[236:239], v[72:75], v[20:23]
    v_mfma_f32_16x16x32_bf16 v[56:59], v[72:75], a[108:111], v[56:59]
    v_mfma_f32_16x16x32_bf16 v[24:27], v[232:235], v[76:79], v[24:27]
    v_mfma_f32_16x16x32_bf16 v[52:55], v[76:79], a[104:107], v[52:55]
    v_mfma_f32_16x16x32_bf16 v[28:31], v[236:239], v[76:79], v[28:31]
    v_mfma_f32_16x16x32_bf16 v[60:63], v[76:79], a[108:111], v[60:63]
    ds_read_b128 v[72:75], v2 offset:15360
    ds_read_b128 v[76:79], v2 offset:31744
    s_waitcnt lgkmcnt(2)
    v_mfma_f32_16x16x32_bf16 v[16:19], v[240:243], v[64:67], v[16:19]
    v_mfma_f32_16x16x32_bf16 v[48:51], v[64:67], a[112:115], v[48:51]
    v_mfma_f32_16x16x32_bf16 v[20:23], v[244:247], v[64:67], v[20:23]
    v_mfma_f32_16x16x32_bf16 v[56:59], v[64:67], a[116:119], v[56:59]
    v_mfma_f32_16x16x32_bf16 v[24:27], v[240:243], v[68:71], v[24:27]
    v_mfma_f32_16x16x32_bf16 v[52:55], v[68:71], a[112:115], v[52:55]
    v_mfma_f32_16x16x32_bf16 v[28:31], v[244:247], v[68:71], v[28:31]
    v_mfma_f32_16x16x32_bf16 v[60:63], v[68:71], a[116:119], v[60:63]
    s_waitcnt lgkmcnt(0)
    v_mfma_f32_16x16x32_bf16 v[16:19], v[248:251], v[72:75], v[16:19]
    v_mfma_f32_16x16x32_bf16 v[48:51], v[72:75], a[120:123], v[48:51]
    v_mfma_f32_16x16x32_bf16 v[20:23], v[252:255], v[72:75], v[20:23]
    v_mfma_f32_16x16x32_bf16 v[56:59], v[72:75], a[124:127], v[56:59]
    v_mfma_f32_16x16x32_bf16 v[24:27], v[248:251], v[76:79], v[24:27]
    v_mfma_f32_16x16x32_bf16 v[52:55], v[76:79], a[120:123], v[52:55]
    v_mfma_f32_16x16x32_bf16 v[28:31], v[252:255], v[76:79], v[28:31]
    v_mfma_f32_16x16x32_bf16 v[60:63], v[76:79], a[124:127], v[60:63]
    s_nop 2
    v_cvt_pk_bf16_f32 v80, v16, v20
    v_cvt_pk_bf16_f32 v81, v17, v21
    v_cvt_pk_bf16_f32 v82, v18, v22
    v_cvt_pk_bf16_f32 v83, v19, v23
    v_cvt_pk_bf16_f32 v84, v24, v28
    v_cvt_pk_bf16_f32 v85, v25, v29
    v_cvt_pk_bf16_f32 v86, v26, v30
    v_cvt_pk_bf16_f32 v87, v27, v31
    v_cvt_pk_bf16_f32 v88, v48, v49
    v_cvt_pk_bf16_f32 v89, v50, v51
    v_cvt_pk_bf16_f32 v90, v52, v53
    v_cvt_pk_bf16_f32 v91, v54, v55
    v_cvt_pk_bf16_f32 v92, v56, v57
    v_cvt_pk_bf16_f32 v93, v58, v59
    v_cvt_pk_bf16_f32 v94, v60, v61
    v_cvt_pk_bf16_f32 v95, v62, v63
    s_lshl_b32 s73, s3, 10
    s_add_u32 s73, s73, s65
    s_add_u32 s74, s73, 4096
    s_add_u32 s75, s65, 8192
    buffer_store_dwordx4 v[80:83], v0, s[4:7], s73 offen sc1
    buffer_store_dwordx4 v[84:87], v0, s[4:7], s74 offen sc1
    buffer_store_dwordx4 v[88:91], v5, s[4:7], s75 offen sc1
    buffer_store_dwordx4 v[92:95], v5, s[4:7], s75 offen offset:1024 sc1
    s_add_u32 s78, s78, 1
    s_cmp_eq_u32 s78, 1
    s_cbranch_scc0 L_a_q
    s_mov_b32 s59, 1000000
L_wi_a:
    buffer_load_dword v10, off, s[8:11], 0 offset:200 sc1
    s_sub_u32 s59, s59, 1
    s_cbranch_scc1 L_fail
    s_waitcnt vmcnt(0)
    v_readfirstlane_b32 s84, v10
    s_nop 0
    s_cmp_eq_u32 s84, 0
    s_cbranch_scc1 L_wi_a
    s_barrier
    s_cmp_lg_u32 s3, 0
    s_cbranch_scc1 L_fl_1
    v_mov_b32 v10, s78
    s_mov_b64 exec, 1
    buffer_store_dword v10, off, s[4:7], s66 sc1
    s_mov_b64 exec, -1
L_fl_1:
    v_xor_b32 v127, 0, v126
    v_add_u32 v127, 32768, v127
    ds_read_b64_tr_b16 a[128:129], v127 offset:0
    ds_read_b64_tr_b16 a[130:131], v127 offset:1024
    ds_read_b64_tr_b16 a[136:137], v127 offset:8192
    ds_read_b64_tr_b16 a[138:139], v127 offset:9216
    ds_read_b64_tr_b16 a[144:145], v127 offset:16384
    ds_read_b64_tr_b16 a[146:147], v127 offset:17408
    ds_read_b64_tr_b16 a[152:153], v127 offset:24576
    ds_read_b64_tr_b16 a[154:155], v127 offset:25600
    ds_read_b64_tr_b16 a[160:161], v127 offset:32768
    ds_read_b64_tr_b16 a[162:163], v127 offset:33792
    ds_read_b64_tr_b16 a[168:169], v127 offset:40960
    ds_read_b64_tr_b16 a[170:171], v127 offset:41984
    ds_read_b64_tr_b16 a[176:177], v127 offset:49152
    ds_read_b64_tr_b16 a[178:179], v127 offset:50176
    ds_read_b64_tr_b16 a[184:185], v127 offset:57344
    ds_read_b64_tr_b16 a[186:187], v127 offset:58368
    v_xor_b32 v127, 32, v126
    v_add_u32 v127, 32768, v127
    ds_read_b64_tr_b16 a[132:133], v127 offset:0
    ds_read_b64_tr_b16 a[134:135], v127 offset:1024
    ds_read_b64_tr_b16 a[140:141], v127 offset:8192
    ds_read_b64_tr_b16 a[142:143], v127 offset:9216
    ds_read_b64_tr_b16 a[148:149], v127 offset:16384
    ds_read_b64_tr_b16 a[150:151], v127 offset:17408
    ds_read_b64_tr_b16 a[156:157], v127 offset:24576
    ds_read_b64_tr_b16 a[158:159], v127 offset:25600
    ds_read_b64_tr_b16 a[164:165], v127 offset:32768
    ds_read_b64_tr_b16 a[166:167], v127 offset:33792
    ds_read_b64_tr_b16 a[172:173], v127 offset:40960
    ds_read_b64_tr_b16 a[174:175], v127 offset:41984
    ds_read_b64_tr_b16 a[180:181], v127 offset:49152
    ds_read_b64_tr_b16 a[182:183], v127 offset:50176
    ds_read_b64_tr_b16 a[188:189], v127 offset:57344
    ds_read_b64_tr_b16 a[190:191], v127 offset:58368
    v_xor_b32 v127, 0, v126
    v_add_u32 v127, 98304, v127
    ds_read_b64_tr_b16 a[192:193], v127 offset:0
    ds_read_b64_tr_b16 a[194:195], v127 offset:1024
    ds_read_b64_tr_b16 a[200:201], v127 offset:8192
    ds_read_b64_tr_b16 a[202:203], v127 offset:9216
    ds_read_b64_tr_b16 a[208:209], v127 offset:16384
    ds_read_b64_tr_b16 a[210:211], v127 offset:17408
    ds_read_b64_tr_b16 a[216:217], v127 offset:24576
    ds_read_b64_tr_b16 a[218:219], v127 offset:25600
    ds_read_b64_tr_b16 a[224:225], v127 offset:32768
    ds_read_b64_tr_b16 a[226:227], v127 offset:33792
    ds_read_b64_tr_b16 a[232:233], v127 offset:40960
    ds_read_b64_tr_b16 a[234:235], v127 offset:41984
    ds_read_b64_tr_b16 a[240:241], v127 offset:49152
    ds_read_b64_tr_b16 a[242:243], v127 offset:50176
    ds_read_b64_tr_b16 a[248:249], v127 offset:57344
    ds_read_b64_tr_b16 a[250:251], v127 offset:58368
    v_xor_b32 v127, 32, v126
    v_add_u32 v127, 98304, v127
    ds_read_b64_tr_b16 a[196:197], v127 offset:0
    ds_read_b64_tr_b16 a[198:199], v127 offset:1024
    ds_read_b64_tr_b16 a[204:205], v127 offset:8192
    ds_read_b64_tr_b16 a[206:207], v127 offset:9216
    ds_read_b64_tr_b16 a[212:213], v127 offset:16384
    ds_read_b64_tr_b16 a[214:215], v127 offset:17408
    ds_read_b64_tr_b16 a[220:221], v127 offset:24576
    ds_read_b64_tr_b16 a[222:223], v127 offset:25600
    ds_read_b64_tr_b16 a[228:229], v127 offset:32768
    ds_read_b64_tr_b16 a[230:231], v127 offset:33792
    ds_read_b64_tr_b16 a[236:237], v127 offset:40960
    ds_read_b64_tr_b16 a[238:239], v127 offset:41984
    ds_read_b64_tr_b16 a[244:245], v127 offset:49152
    ds_read_b64_tr_b16 a[246:247], v127 offset:50176
    ds_read_b64_tr_b16 a[252:253], v127 offset:57344
    ds_read_b64_tr_b16 a[254:255], v127 offset:58368
    s_waitcnt lgkmcnt(0)
    s_barrier
    s_add_u32 m0, s64, 0
    s_nop 0
    buffer_load_dwordx4 v1, s[12:15], s63 offen offset:0 lds
    s_add_u32 m0, s64, 960
    s_nop 0
    buffer_load_dwordx4 v1, s[12:15], s63 offen offset:64 lds
    s_add_u32 m0, s64, 1920
    s_nop 0
    buffer_load_dwordx4 v1, s[12:15], s63 offen offset:128 lds
    s_add_u32 m0, s64, 2880
    s_nop 0
    buffer_load_dwordx4 v1, s[12:15], s63 offen offset:192 lds
    s_add_u32 m0, s64, 3840
    s_nop 0
    buffer_load_dwordx4 v1, s[12:15], s63 offen offset:256 lds
    s_add_u32 m0, s64, 4800
    s_nop 0
    buffer_load_dwordx4 v1, s[12:15], s63 offen offset:320 lds
    s_add_u32 m0, s64, 5760
    s_nop 0
    buffer_load_dwordx4 v1, s[12:15], s63 offen offset:384 lds
    s_add_u32 m0, s64, 6720
    s_nop 0
    buffer_load_dwordx4 v1, s[12:15], s63 offen offset:448 lds
    s_add_u32 s63, s63, 131072
    s_xor_b32 s64, s64, 0x8000
    v_mov_b64 v[120:121], 0
    v_mov_b64 v[122:123], 0
    ds_write_b128 v125, v[120:123]
    ds_write_b128 v125, v[120:123] offset:1024
    ds_write_b128 v125, v[120:123] offset:2048
    ds_write_b128 v125, v[120:123] offset:3072
    s_waitcnt lgkmcnt(0)
L_a_q:
    ds_read_b128 v[64:67], v2 offset:0
    ds_read_b128 v[68:71], v2 offset:16384
    ds_read_b128 v[72:75], v2 offset:1024
    ds_read_b128 v[76:79], v2 offset:17408
    s_waitcnt lgkmcnt(2)
    v_mfma_f32_16x16x32_bf16 v[32:35], a[128:131], v[64:67], 0
    v_mfma_f32_16x16x32_bf16 v[36:39], a[132:135], v[64:67], 0
    v_mfma_f32_16x16x32_bf16 v[40:43], a[128:131], v[68:71], 0
    v_mfma_f32_16x16x32_bf16 v[44:47], a[132:135], v[68:71], 0
    ds_read_b128 v[64:67], v2 offset:2048
    ds_read_b128 v[68:71], v2 offset:18432
    s_waitcnt lgkmcnt(2)
    v_mfma_f32_16x16x32_bf16 v[32:35], a[136:139], v[72:75], v[32:35]
    v_mfma_f32_16x16x32_bf16 v[36:39], a[140:143], v[72:75], v[36:39]
    v_mfma_f32_16x16x32_bf16 v[40:43], a[136:139], v[76:79], v[40:43]
    v_mfma_f32_16x16x32_bf16 v[44:47], a[140:143], v[76:79], v[44:47]
    ds_read_b128 v[72:75], v2 offset:3072
    ds_read_b128 v[76:79], v2 offset:19456
    s_waitcnt lgkmcnt(2)
    v_mfma_f32_16x16x32_bf16 v[32:35], a[144:147], v[64:67], v[32:35]
    v_mfma_f32_16x16x32_bf16 v[36:39], a[148:151], v[64:67], v[36:39]
    v_mfma_f32_16x16x32_bf16 v[40:43], a[144:147], v[68:71], v[40:43]
    v_mfma_f32_16x16x32_bf16 v[44:47], a[148:151], v[68:71], v[44:47]
    ds_read_b128 v[64:67], v2 offset:4096
    ds_read_b128 v[68:71], v2 offset:20480
    s_waitcnt lgkmcnt(2)
    v_mfma_f32_16x16x32_bf16 v[32:35], a[152:155], v[72:75], v[32:35]
    v_mfma_f32_16x16x32_bf16 v[36:39], a[156:159], v[72:75], v[36:39]
    v_mfma_f32_16x16x32_bf16 v[40:43], a[152:155], v[76:79], v[40:43]
    v_mfma_f32_16x16x32_bf16 v[44:47], a[156:159], v[76:79], v[44:47]
    ds_read_b128 v[72:75], v2 offset:5120
    ds_read_b128 v[76:79], v2 offset:21504
    s_waitcnt lgkmcnt(2)
    v_mfma_f32_16x16x32_bf16 v[32:35], a[160:163], v[64:67], v[32:35]
    v_mfma_f32_16x16x32_bf16 v[36:39], a[164:167], v[64:67], v[36:39]
    v_mfma_f32_16x16x32_bf16 v[40:43], a[160:163], v[68:71], v[40:43]
    v_mfma_f32_16x16x32_bf16 v[44:47], a[164:167], v[68:71], v[44:47]
    ds_read_b128 v[64:67], v2 offset:6144
    ds_read_b128 v[68:71], v2 offset:22528
    s_waitcnt lgkmcnt(2)
    v_mfma_f32_16x16x32_bf16 v[32:35], a[168:171], v[72:75], v[32:35]
    v_mfma_f32_16x16x32_bf16 v[36:39], a[172:175], v[72:75], v[36:39]
    v_mfma_f32_16x16x32_bf16 v[40:43], a[168:171], v[76:79], v[40:43]
    v_mfma_f32_16x16x32_bf16 v[44:47], a[172:175], v[76:79], v[44:47]
    ds_read_b128 v[72:75], v2 offset:7168
    ds_read_b128 v[76:79], v2 offset:23552
    s_waitcnt lgkmcnt(2)
    v_mfma_f32_16x16x32_bf16 v[32:35], a[176:179], v[64:67], v[32:35]
    v_mfma_f32_16x16x32_bf16 v[36:39], a[180:183], v[64:67], v[36:39]
    v_mfma_f32_16x16x32_bf16 v[40:43], a[176:179], v[68:71], v[40:43]
    v_mfma_f32_16x16x32_bf16 v[44:47], a[180:183], v[68:71], v[44:47]
    ds_read_b128 v[64:67], v2 offset:8192
    ds_read_b128 v[68:71], v2 offset:24576
    s_waitcnt lgkmcnt(2)
    v_mfma_f32_16x16x32_bf16 v[32:35], a[184:187], v[72:75], v[32:35]
    v_mfma_f32_16x16x32_bf16 v[36:39], a[188:191], v[72:75], v[36:39]
    v_mfma_f32_16x16x32_bf16 v[40:43], a[184:187], v[76:79], v[40:43]
    v_mfma_f32_16x16x32_bf16 v[44:47], a[188:191], v[76:79], v[44:47]
    ds_read_b128 v[72:75], v2 offset:9216
    ds_read_b128 v[76:79], v2 offset:25600
    s_waitcnt lgkmcnt(2)
    v_mfma_f32_16x16x32_bf16 v[32:35], a[192:195], v[64:67], v[32:35]
    v_mfma_f32_16x16x32_bf16 v[36:39], a[196:199], v[64:67], v[36:39]
    v_mfma_f32_16x16x32_bf16 v[40:43], a[192:195], v[68:71], v[40:43]
    v_mfma_f32_16x16x32_bf16 v[44:47], a[196:199], v[68:71], v[44:47]
    ds_read_b128 v[64:67], v2 offset:10240
    ds_read_b128 v[68:71], v2 offset:26624
    s_waitcnt lgkmcnt(2)
    v_mfma_f32_16x16x32_bf16 v[32:35], a[200:203], v[72:75], v[32:35]
    v_mfma_f32_16x16x32_bf16 v[36:39], a[204:207], v[72:75], v[36:39]
    v_mfma_f32_16x16x32_bf16 v[40:43], a[200:203], v[76:79], v[40:43]
    v_mfma_f32_16x16x32_bf16 v[44:47], a[204:207], v[76:79], v[44:47]
    ds_read_b128 v[72:75], v2 offset:11264
    ds_read_b128 v[76:79], v2 offset:27648
    s_waitcnt lgkmcnt(2)
    v_mfma_f32_16x16x32_bf16 v[32:35], a[208:211], v[64:67], v[32:35]
    v_mfma_f32_16x16x32_bf16 v[36:39], a[212:215], v[64:67], v[36:39]
    v_mfma_f32_16x16x32_bf16 v[40:43], a[208:211], v[68:71], v[40:43]
    v_mfma_f32_16x16x32_bf16 v[44:47], a[212:215], v[68:71], v[44:47]
    ds_read_b128 v[64:67], v2 offset:12288
    ds_read_b128 v[68:71], v2 offset:28672
    s_waitcnt lgkmcnt(2)
    v_mfma_f32_16x16x32_bf16 v[32:35], a[216:219], v[72:75], v[32:35]
    v_mfma_f32_16x16x32_bf16 v[36:39], a[220:223], v[72:75], v[36:39]
    v_mfma_f32_16x16x32_bf16 v[40:43], a[216:219], v[76:79], v[40:43]
    v_mfma_f32_16x16x32_bf16 v[44:47], a[220:223], v[76:79], v[44:47]
    ds_read_b128 v[72:75], v2 offset:13312
    ds_read_b128 v[76:79], v2 offset:29696
    s_waitcnt lgkmcnt(2)
    v_mfma_f32_16x16x32_bf16 v[32:35], a[224:227], v[64:67], v[32:35]
    v_mfma_f32_16x16x32_bf16 v[36:39], a[228:231], v[64:67], v[36:39]
    v_mfma_f32_16x16x32_bf16 v[40:43], a[224:227], v[68:71], v[40:43]
    v_mfma_f32_16x16x32_bf16 v[44:47], a[228:231], v[68:71], v[44:47]
    ds_read_b128 v[64:67], v2 offset:14336
    ds_read_b128 v[68:71], v2 offset:30720
    s_waitcnt lgkmcnt(2)
    v_mfma_f32_16x16x32_bf16 v[32:35], a[232:235], v[72:75], v[32:35]
    v_mfma_f32_16x16x32_bf16 v[36:39], a[236:239], v[72:75], v[36:39]
    v_mfma_f32_16x16x32_bf16 v[40:43], a[232:235], v[76:79], v[40:43]
    v_mfma_f32_16x16x32_bf16 v[44:47], a[236:239], v[76:79], v[44:47]
    ds_read_b128 v[72:75], v2 offset:15360
    ds_read_b128 v[76:79], v2 offset:31744
    s_waitcnt lgkmcnt(2)
    v_mfma_f32_16x16x32_bf16 v[32:35], a[240:243], v[64:67], v[32:35]
    v_mfma_f32_16x16x32_bf16 v[36:39], a[244:247], v[64:67], v[36:39]
    v_mfma_f32_16x16x32_bf16 v[40:43], a[240:243], v[68:71], v[40:43]
    v_mfma_f32_16x16x32_bf16 v[44:47], a[244:247], v[68:71], v[44:47]
    s_waitcnt lgkmcnt(0)
    v_mfma_f32_16x16x32_bf16 v[32:35], a[248:251], v[72:75], v[32:35]
    v_mfma_f32_16x16x32_bf16 v[36:39], a[252:255], v[72:75], v[36:39]
    v_mfma_f32_16x16x32_bf16 v[40:43], a[248:251], v[76:79], v[40:43]
    v_mfma_f32_16x16x32_bf16 v[44:47], a[252:255], v[76:79], v[44:47]
    s_waitcnt vmcnt(0)
    s_barrier
    s_cmp_lg_u32 s3, 0
    s_cbranch_scc1 L_fl_2
    v_mov_b32 v10, s78
    s_mov_b64 exec, 1
    buffer_store_dword v10, off, s[4:7], s66 sc1
    s_mov_b64 exec, -1
L_fl_2:
    s_add_u32 m0, s64, 0
    s_nop 0
    buffer_load_dwordx4 v1, s[12:15], s63 offen offset:0 lds
    s_add_u32 m0, s64, 960
    s_nop 0
    buffer_load_dwordx4 v1, s[12:15], s63 offen offset:64 lds
    s_add_u32 m0, s64, 1920
    s_nop 0
    buffer_load_dwordx4 v1, s[12:15], s63 offen offset:128 lds
    s_add_u32 m0, s64, 2880
    s_nop 0
    buffer_load_dwordx4 v1, s[12:15], s63 offen offset:192 lds
    s_add_u32 m0, s64, 3840
    s_nop 0
    buffer_load_dwordx4 v1, s[12:15], s63 offen offset:256 lds
    s_add_u32 m0, s64, 4800
    s_nop 0
    buffer_load_dwordx4 v1, s[12:15], s63 offen offset:320 lds
    s_add_u32 m0, s64, 5760
    s_nop 0
    buffer_load_dwordx4 v1, s[12:15], s63 offen offset:384 lds
    s_add_u32 m0, s64, 6720
    s_nop 0
    buffer_load_dwordx4 v1, s[12:15], s63 offen offset:448 lds
    v_cvt_pk_bf16_f32 v96, v32, v36
    v_cvt_pk_bf16_f32 v97, v33, v37
    v_cvt_pk_bf16_f32 v98, v34, v38
    v_cvt_pk_bf16_f32 v99, v35, v39
    v_cvt_pk_bf16_f32 v100, v40, v44
    v_cvt_pk_bf16_f32 v101, v41, v45
    v_cvt_pk_bf16_f32 v102, v42, v46
    v_cvt_pk_bf16_f32 v103, v43, v47
    ds_write_b128 v3, v[80:83] offset:0
    ds_write_b128 v3, v[84:87] offset:4096
    ds_write_b128 v3, v[88:91] offset:16384
    ds_write_b128 v3, v[92:95] offset:20480
    ds_write_b128 v3, v[96:99] offset:8192
    ds_write_b128 v3, v[100:103] offset:12288
    s_add_u32 s63, s63, 131072
    s_xor_b32 s64, s64, 0x8000
    v_xor_b32 v2, 0x8000, v2
    s_add_u32 s65, s65, 2097152
    v_xor_b32 v3, 0x8000, v3
    s_waitcnt lgkmcnt(0)
    s_barrier
    s_cmp_eq_u32 s78, 1
    s_cbranch_scc0 L_a_att
    s_mov_b32 s59, 1000000
L_a_chw:
    buffer_load_dword v10, off, s[8:11], 0 offset:196 sc1
    s_sub_u32 s59, s59, 1
    s_cbranch_scc1 L_fail
    s_waitcnt vmcnt(0)
    v_readfirstlane_b32 s73, v10
    s_nop 0
    s_cmp_lt_u32 s73, 40
    s_cbranch_scc1 L_a_chw
    s_branch L_a_proj
L_a_att:
    ds_read_b128 v[16:19], v4 offset:8192
    ds_read_b128 v[20:23], v4 offset:9216
    ds_read_b128 v[24:27], v4 offset:10240
    ds_read_b128 v[28:31], v4 offset:11264
    ds_read_b128 v[32:35], v4 offset:12288
    ds_read_b128 v[36:39], v4 offset:13312
    ds_read_b128 v[40:43], v4 offset:14336
    ds_read_b128 v[44:47], v4 offset:15360
    ds_read_b128 v[48:51], v4 offset:0
    ds_read_b128 v[52:55], v4 offset:1024
    ds_read_b128 v[56:59], v4 offset:2048
    ds_read_b128 v[60:63], v4 offset:3072
    s_waitcnt lgkmcnt(0)
    ds_read_b128 v[64:67], v4 offset:4096
    ds_read_b128 v[68:71], v4 offset:5120
    ds_read_b128 v[72:75], v4 offset:6144
    ds_read_b128 v[76:79], v4 offset:7168
    s_lshl_b32 s73, s3, 10
    v_add_u32 v10, s73, v4
    ds_read_b128 v[112:115], v10 offset:16384
    ds_read_b128 v[116:119], v10 offset:20480
    v_mfma_f32_16x16x32_bf16 v[80:83], v[48:51], v[16:19], 0
    v_mfma_f32_16x16x32_bf16 v[84:87], v[48:51], v[32:35], 0
    v_mfma_f32_16x16x32_bf16 v[80:83], v[52:55], v[20:23], v[80:83]
    v_mfma_f32_16x16x32_bf16 v[84:87], v[52:55], v[36:39], v[84:87]
    v_mfma_f32_16x16x32_bf16 v[80:83], v[56:59], v[24:27], v[80:83]
    v_mfma_f32_16x16x32_bf16 v[84:87], v[56:59], v[40:43], v[84:87]
    v_mfma_f32_16x16x32_bf16 v[80:83], v[60:63], v[28:31], v[80:83]
    v_mfma_f32_16x16x32_bf16 v[84:87], v[60:63], v[44:47], v[84:87]
    s_waitcnt lgkmcnt(0)
    v_mfma_f32_16x16x32_bf16 v[88:91], v[64:67], v[32:35], 0
    v_mfma_f32_16x16x32_bf16 v[88:91], v[68:71], v[36:39], v[88:91]
    v_mfma_f32_16x16x32_bf16 v[88:91], v[72:75], v[40:43], v[88:91]
    v_mfma_f32_16x16x32_bf16 v[88:91], v[76:79], v[44:47], v[88:91]
    s_mov_b32 s59, 1000000
    s_cmp_lg_u32 s3, 0
    s_cbranch_scc1 L_a_pre2
    s_lshl_b32 s73, s60, 8
    s_add_u32 s73, s73, s68
    s_mov_b64 exec, 1
L_a_pre:
    buffer_load_dword v10, off, s[4:7], s73 sc1
    s_sub_u32 s59, s59, 1
    s_cbranch_scc1 L_fail
    s_waitcnt vmcnt(0)
    v_cmp_eq_u32 vcc, -1, v10
    s_cbranch_vccz L_a_pre1
    s_sleep 4
    s_branch L_a_pre
L_a_pre1:
    s_mov_b64 exec, -1
L_a_pre2:
    s_barrier
L_a_poll:
    buffer_load_dwordx4 v[100:103], v5, s[4:7], s68 offen sc1
    buffer_load_dwordx4 v[104:107], v5, s[4:7], s68 offen offset:1024 sc1
    s_sub_u32 s59, s59, 1
    s_cbranch_scc1 L_fail
    s_waitcnt vmcnt(0)
    v_max3_u32 v10, v100, v101, v102
    v_max3_u32 v11, v103, v104, v105
    v_max3_u32 v10, v10, v106, v107
    v_max_u32 v10, v10, v11
    v_cmp_eq_u32 vcc, -1, v10
    s_cbranch_vccz L_a_got
    s_sleep 2
    s_branch L_a_poll
L_a_got:
    v_mov_b32_dpp v120, v100 quad_perm:[1,0,3,2] row_mask:0xf bank_mask:0xf
    v_mov_b32_dpp v121, v101 quad_perm:[1,0,3,2] row_mask:0xf bank_mask:0xf
    v_mov_b32_dpp v122, v102 quad_perm:[1,0,3,2] row_mask:0xf bank_mask:0xf
    v_mov_b32_dpp v123, v103 quad_perm:[1,0,3,2] row_mask:0xf bank_mask:0xf
    v_perm_b32 v100, v120, v100, v124
    v_perm_b32 v101, v121, v101, v124
    v_perm_b32 v102, v122, v102, v124
    v_perm_b32 v103, v123, v103, v124
    ds_write_b128 v6, v[100:103] offset:0
    v_mov_b32_dpp v120, v104 quad_perm:[1,0,3,2] row_mask:0xf bank_mask:0xf
    v_mov_b32_dpp v121, v105 quad_perm:[1,0,3,2] row_mask:0xf bank_mask:0xf
    v_mov_b32_dpp v122, v106 quad_perm:[1,0,3,2] row_mask:0xf bank_mask:0xf
    v_mov_b32_dpp v123, v107 quad_perm:[1,0,3,2] row_mask:0xf bank_mask:0xf
    v_perm_b32 v104, v120, v104, v124
    v_perm_b32 v105, v121, v105, v124
    v_perm_b32 v106, v122, v106, v124
    v_perm_b32 v107, v123, v107, v124
    ds_write_b128 v6, v[104:107] offset:8192
    s_waitcnt lgkmcnt(0)
    s_barrier
    ds_read_b128 v[48:51], v7 offset:0
    ds_read_b128 v[52:55], v7 offset:1024
    ds_read_b128 v[56:59], v7 offset:2048
    ds_read_b128 v[60:63], v7 offset:3072
    s_waitcnt lgkmcnt(3)
    v_mfma_f32_16x16x32_bf16 v[64:67], v[128:131], v[48:51], 0
    v_mfma_f32_16x16x32_bf16 v[68:71], v[132:135], v[48:51], 0
    v_cndmask_b32 v80, v8, v80, s[86:87]
    ds_read_b128 v[48:51], v7 offset:4096
    s_waitcnt lgkmcnt(3)
    v_mfma_f32_16x16x32_bf16 v[64:67], v[136:139], v[52:55], v[64:67]
    v_mfma_f32_16x16x32_bf16 v[68:71], v[140:143], v[52:55], v[68:71]
    v_cndmask_b32 v81, v8, v81, s[88:89]
    ds_read_b128 v[52:55], v7 offset:5120
    s_waitcnt lgkmcnt(3)
    v_mfma_f32_16x16x32_bf16 v[64:67], v[144:147], v[56:59], v[64:67]
    v_mfma_f32_16x16x32_bf16 v[68:71], v[148:151], v[56:59], v[68:71]
    v_cndmask_b32 v82, v8, v82, s[90:91]
    ds_read_b128 v[56:59], v7 offset:6144
    s_waitcnt lgkmcnt(3)
    v_mfma_f32_16x16x32_bf16 v[64:67], v[152:155], v[60:63], v[64:67]
    v_mfma_f32_16x16x32_bf16 v[68:71], v[156:159], v[60:63], v[68:71]
    v_cndmask_b32 v83, v8, v83, s[92:93]
    ds_read_b128 v[60:63], v7 offset:7168
    s_waitcnt lgkmcnt(3)
    v_mfma_f32_16x16x32_bf16 v[64:67], v[160:163], v[48:51], v[64:67]
    v_mfma_f32_16x16x32_bf16 v[68:71], v[164:167], v[48:51], v[68:71]
    v_cndmask_b32 v88, v8, v88, s[86:87]
    ds_read_b128 v[48:51], v7 offset:8192
    s_waitcnt lgkmcnt(3)
    v_mfma_f32_16x16x32_bf16 v[64:67], v[168:171], v[52:55], v[64:67]
    v_mfma_f32_16x16x32_bf16 v[68:71], v[172:175], v[52:55], v[68:71]
    v_cndmask_b32 v89, v8, v89, s[88:89]
    ds_read_b128 v[52:55], v7 offset:9216
    s_waitcnt lgkmcnt(3)
    v_mfma_f32_16x16x32_bf16 v[64:67], v[176:179], v[56:59], v[64:67]
    v_mfma_f32_16x16x32_bf16 v[68:71], v[180:183], v[56:59], v[68:71]
    v_cndmask_b32 v90, v8, v90, s[90:91]
    ds_read_b128 v[56:59], v7 offset:10240
    s_waitcnt lgkmcnt(3)
    v_mfma_f32_16x16x32_bf16 v[64:67], v[184:187], v[60:63], v[64:67]
    v_mfma_f32_16x16x32_bf16 v[68:71], v[188:191], v[60:63], v[68:71]
    v_cndmask_b32 v91, v8, v91, s[92:93]
    ds_read_b128 v[60:63], v7 offset:11264
    s_waitcnt lgkmcnt(3)
    v_mfma_f32_16x16x32_bf16 v[64:67], v[192:195], v[48:51], v[64:67]
    v_mfma_f32_16x16x32_bf16 v[68:71], v[196:199], v[48:51], v[68:71]
    ds_read_b128 v[48:51], v7 offset:12288
    s_waitcnt lgkmcnt(3)
    v_mfma_f32_16x16x32_bf16 v[64:67], v[200:203], v[52:55], v[64:67]
    v_mfma_f32_16x16x32_bf16 v[68:71], v[204:207], v[52:55], v[68:71]
    ds_read_b128 v[52:55], v7 offset:13312
    s_waitcnt lgkmcnt(3)
    v_mfma_f32_16x16x32_bf16 v[64:67], v[208:211], v[56:59], v[64:67]
    v_mfma_f32_16x16x32_bf16 v[68:71], v[212:215], v[56:59], v[68:71]
    ds_read_b128 v[56:59], v7 offset:14336
    s_waitcnt lgkmcnt(3)
    v_mfma_f32_16x16x32_bf16 v[64:67], v[216:219], v[60:63], v[64:67]
    v_mfma_f32_16x16x32_bf16 v[68:71], v[220:223], v[60:63], v[68:71]
    ds_read_b128 v[60:63], v7 offset:15360
    s_waitcnt lgkmcnt(3)
    v_mfma_f32_16x16x32_bf16 v[64:67], v[224:227], v[48:51], v[64:67]
    v_mfma_f32_16x16x32_bf16 v[68:71], v[228:231], v[48:51], v[68:71]
    ds_read_b128 v[48:51], v7 offset:0
    s_waitcnt lgkmcnt(3)
    v_mfma_f32_16x16x32_bf16 v[64:67], v[232:235], v[52:55], v[64:67]
    v_mfma_f32_16x16x32_bf16 v[68:71], v[236:239], v[52:55], v[68:71]
    ds_read_b128 v[52:55], v7 offset:1024
    s_waitcnt lgkmcnt(3)
    v_mfma_f32_16x16x32_bf16 v[64:67], v[240:243], v[56:59], v[64:67]
    v_mfma_f32_16x16x32_bf16 v[68:71], v[244:247], v[56:59], v[68:71]
    ds_read_b128 v[56:59], v7 offset:2048
    s_waitcnt lgkmcnt(3)
    v_mfma_f32_16x16x32_bf16 v[64:67], v[248:251], v[60:63], v[64:67]
    v_mfma_f32_16x16x32_bf16 v[68:71], v[252:255], v[60:63], v[68:71]
    ds_read_b128 v[60:63], v7 offset:3072
    s_waitcnt lgkmcnt(3)
    v_mfma_f32_16x16x32_bf16 v[72:75], v[48:51], a[0:3], 0
    v_mfma_f32_16x16x32_bf16 v[76:79], v[48:51], a[4:7], 0
    ds_read_b128 v[48:51], v7 offset:4096
    s_waitcnt lgkmcnt(3)
    v_mfma_f32_16x16x32_bf16 v[72:75], v[52:55], a[8:11], v[72:75]
    v_mfma_f32_16x16x32_bf16 v[76:79], v[52:55], a[12:15], v[76:79]
    ds_read_b128 v[52:55], v7 offset:5120
    s_waitcnt lgkmcnt(3)
    v_mfma_f32_16x16x32_bf16 v[72:75], v[56:59], a[16:19], v[72:75]
    v_mfma_f32_16x16x32_bf16 v[76:79], v[56:59], a[20:23], v[76:79]
    v_cvt_pk_bf16_f32 v100, v64, v68
    v_cvt_pk_bf16_f32 v101, v65, v69
    v_cvt_pk_bf16_f32 v102, v66, v70
    v_cvt_pk_bf16_f32 v103, v67, v71
    ds_write_b128 v9, v[100:103]
    ds_read_b128 v[56:59], v7 offset:6144
    s_waitcnt lgkmcnt(3)
    v_mfma_f32_16x16x32_bf16 v[72:75], v[60:63], a[24:27], v[72:75]
    v_mfma_f32_16x16x32_bf16 v[76:79], v[60:63], a[28:31], v[76:79]
    ds_read_b128 v[60:63], v7 offset:7168
    s_waitcnt lgkmcnt(3)
    v_mfma_f32_16x16x32_bf16 v[72:75], v[48:51], a[32:35], v[72:75]
    v_mfma_f32_16x16x32_bf16 v[76:79], v[48:51], a[36:39], v[76:79]
    ds_read_b128 v[48:51], v7 offset:8192
    s_waitcnt lgkmcnt(3)
    v_mfma_f32_16x16x32_bf16 v[72:75], v[52:55], a[40:43], v[72:75]
    v_mfma_f32_16x16x32_bf16 v[76:79], v[52:55], a[44:47], v[76:79]
    ds_read_b128 v[52:55], v7 offset:9216
    s_waitcnt lgkmcnt(3)
    v_mfma_f32_16x16x32_bf16 v[72:75], v[56:59], a[48:51], v[72:75]
    v_mfma_f32_16x16x32_bf16 v[76:79], v[56:59], a[52:55], v[76:79]
    ds_read_b128 v[56:59], v7 offset:10240
    s_waitcnt lgkmcnt(3)
    v_mfma_f32_16x16x32_bf16 v[72:75], v[60:63], a[56:59], v[72:75]
    v_mfma_f32_16x16x32_bf16 v[76:79], v[60:63], a[60:63], v[76:79]
    ds_read_b128 v[60:63], v7 offset:11264
    s_waitcnt lgkmcnt(3)
    v_mfma_f32_16x16x32_bf16 v[72:75], v[48:51], a[64:67], v[72:75]
    v_mfma_f32_16x16x32_bf16 v[76:79], v[48:51], a[68:71], v[76:79]
    s_waitcnt lgkmcnt(0)
    s_barrier
    ds_read_b128 v[100:103], v7 offset:16384
    ds_read_b128 v[120:123], v7 offset:17408
    ds_read_b128 v[64:67], v7 offset:18432
    ds_read_b128 v[68:71], v7 offset:19456
    ds_read_b128 v[48:51], v7 offset:12288
    s_waitcnt lgkmcnt(7)
    v_mfma_f32_16x16x32_bf16 v[72:75], v[52:55], a[72:75], v[72:75]
    v_mfma_f32_16x16x32_bf16 v[76:79], v[52:55], a[76:79], v[76:79]
    ds_read_b128 v[52:55], v7 offset:13312
    s_waitcnt lgkmcnt(7)
    v_mfma_f32_16x16x32_bf16 v[72:75], v[56:59], a[80:83], v[72:75]
    v_mfma_f32_16x16x32_bf16 v[76:79], v[56:59], a[84:87], v[76:79]
    ds_read_b128 v[56:59], v7 offset:14336
    s_waitcnt lgkmcnt(7)
    v_mfma_f32_16x16x32_bf16 v[72:75], v[60:63], a[88:91], v[72:75]
    v_mfma_f32_16x16x32_bf16 v[76:79], v[60:63], a[92:95], v[76:79]
    ds_read_b128 v[60:63], v7 offset:15360
    s_waitcnt lgkmcnt(3)
    v_mfma_f32_16x16x32_bf16 v[72:75], v[48:51], a[96:99], v[72:75]
    v_mfma_f32_16x16x32_bf16 v[76:79], v[48:51], a[100:103], v[76:79]
    s_waitcnt lgkmcnt(2)
    v_mfma_f32_16x16x32_bf16 v[72:75], v[52:55], a[104:107], v[72:75]
    v_mfma_f32_16x16x32_bf16 v[76:79], v[52:55], a[108:111], v[76:79]
    s_waitcnt lgkmcnt(1)
    v_mfma_f32_16x16x32_bf16 v[72:75], v[56:59], a[112:115], v[72:75]
    v_mfma_f32_16x16x32_bf16 v[76:79], v[56:59], a[116:119], v[76:79]
    s_waitcnt lgkmcnt(0)
    v_mfma_f32_16x16x32_bf16 v[72:75], v[60:63], a[120:123], v[72:75]
    v_mfma_f32_16x16x32_bf16 v[76:79], v[60:63], a[124:127], v[76:79]
    v_mfma_f32_16x16x32_bf16 v[92:95], v[100:103], v[16:19], 0
    v_mfma_f32_16x16x32_bf16 v[96:99], v[100:103], v[32:35], 0
    v_mfma_f32_16x16x32_bf16 v[92:95], v[120:123], v[20:23], v[92:95]
    v_mfma_f32_16x16x32_bf16 v[96:99], v[120:123], v[36:39], v[96:99]
    v_mfma_f32_16x16x32_bf16 v[92:95], v[64:67], v[24:27], v[92:95]
    v_mfma_f32_16x16x32_bf16 v[96:99], v[64:67], v[40:43], v[96:99]
    v_mfma_f32_16x16x32_bf16 v[92:95], v[68:71], v[28:31], v[92:95]
    v_mfma_f32_16x16x32_bf16 v[96:99], v[68:71], v[44:47], v[96:99]
    v_cvt_pk_bf16_f32 v104, v72, v73
    v_cvt_pk_bf16_f32 v105, v74, v75
    v_cvt_pk_bf16_f32 v106, v76, v77
    v_cvt_pk_bf16_f32 v107, v78, v79
    v_max3_f32 v108, v80, v81, v82
    v_max_f32 v108, v108, v83
    v_max3_f32 v109, v84, v85, v86
    v_max3_f32 v109, v109, v87, v88
    v_max3_f32 v109, v109, v89, v90
    v_max_f32 v109, v109, v91
    v_cndmask_b32 v92, v8, v92, s[94:95]
    v_cndmask_b32 v93, v8, v93, s[94:95]
    v_cndmask_b32 v94, v8, v94, s[94:95]
    v_cndmask_b32 v95, v8, v95, s[94:95]
    v_cndmask_b32 v96, v8, v96, s[94:95]
    v_cndmask_b32 v97, v8, v97, s[94:95]
    v_cndmask_b32 v98, v8, v98, s[94:95]
    v_cndmask_b32 v99, v8, v99, s[94:95]
    v_max3_f32 v108, v108, v92, v93
    v_max3_f32 v108, v108, v94, v95
    v_max3_f32 v109, v109, v96, v97
    v_max3_f32 v109, v109, v98, v99
    v_mov_b32 v110, v108
    v_mov_b32 v111, v109
    s_nop 0
    v_permlane16_swap_b32 v108, v110
    v_permlane16_swap_b32 v109, v111
    v_max_f32 v108, v108, v110
    v_max_f32 v109, v109, v111
    v_mov_b32 v110, v108
    v_mov_b32 v111, v109
    s_nop 0
    v_permlane32_swap_b32 v108, v110
    v_permlane32_swap_b32 v109, v111
    v_max_f32 v108, v108, v110
    v_max_f32 v109, v109, v111
    v_mul_f32 v108, s71, v108
    v_mul_f32 v109, s71, v109
    v_fma_f32 v80, v80, s70, v108
    v_fma_f32 v81, v81, s70, v108
    v_fma_f32 v82, v82, s70, v108
    v_fma_f32 v83, v83, s70, v108
    v_fma_f32 v84, v84, s70, v109
    v_fma_f32 v85, v85, s70, v109
    v_fma_f32 v86, v86, s70, v109
    v_fma_f32 v87, v87, s70, v109
    v_fma_f32 v88, v88, s70, v109
    v_fma_f32 v89, v89, s70, v109
    v_fma_f32 v90, v90, s70, v109
    v_fma_f32 v91, v91, s70, v109
    v_fma_f32 v92, v92, s70, v108
    v_fma_f32 v93, v93, s70, v108
    v_fma_f32 v94, v94, s70, v108
    v_fma_f32 v95, v95, s70, v108
    v_fma_f32 v96, v96, s70, v109
    v_fma_f32 v97, v97, s70, v109
    v_fma_f32 v98, v98, s70, v109
    v_fma_f32 v99, v99, s70, v109
    v_exp_f32 v80, v80
    v_exp_f32 v81, v81
    v_exp_f32 v82, v82
    v_exp_f32 v83, v83
    v_exp_f32 v84, v84
    v_exp_f32 v85, v85
    v_exp_f32 v86, v86
    v_exp_f32 v87, v87
    v_exp_f32 v88, v88
    v_exp_f32 v89, v89
    v_exp_f32 v90, v90
    v_exp_f32 v91, v91
    v_exp_f32 v92, v92
    v_exp_f32 v93, v93
    v_exp_f32 v94, v94
    v_exp_f32 v95, v95
    v_exp_f32 v96, v96
    v_exp_f32 v97, v97
    v_exp_f32 v98, v98
    v_exp_f32 v99, v99
    v_cvt_pk_bf16_f32 v16, v80, v81
    v_cvt_pk_bf16_f32 v17, v82, v83
    v_cvt_pk_bf16_f32 v20, v84, v85
    v_cvt_pk_bf16_f32 v21, v86, v87
    v_cvt_pk_bf16_f32 v22, v88, v89
    v_cvt_pk_bf16_f32 v23, v90, v91
    v_cvt_pk_bf16_f32 v24, v92, v93
    v_cvt_pk_bf16_f32 v25, v94, v95
    v_cvt_pk_bf16_f32 v26, v96, v97
    v_cvt_pk_bf16_f32 v27, v98, v99
    v_mfma_f32_16x16x16_bf16 v[48:51], v[12:13], v[16:17], 0
    v_mfma_f32_16x16x32_bf16 v[52:55], v[12:15], v[20:23], 0
    v_mfma_f32_16x16x16_bf16 v[32:35], v[112:113], v[16:17], 0
    v_mfma_f32_16x16x32_bf16 v[40:43], v[112:115], v[20:23], 0
    v_mfma_f32_16x16x16_bf16 v[36:39], v[116:117], v[16:17], 0
    v_mfma_f32_16x16x32_bf16 v[44:47], v[116:119], v[20:23], 0
    v_mfma_f32_16x16x16_bf16 v[48:51], v[12:13], v[24:25], v[48:51]
    v_mfma_f32_16x16x16_bf16 v[52:55], v[12:13], v[26:27], v[52:55]
    v_mfma_f32_16x16x16_bf16 v[32:35], v[104:105], v[24:25], v[32:35]
    v_mfma_f32_16x16x16_bf16 v[40:43], v[104:105], v[26:27], v[40:43]
    v_mfma_f32_16x16x16_bf16 v[36:39], v[106:107], v[24:25], v[36:39]
    v_mfma_f32_16x16x16_bf16 v[44:47], v[106:107], v[26:27], v[44:47]
    s_nop 2
    v_rcp_f32 v110, v48
    v_rcp_f32 v111, v52
    v_mul_f32 v32, v32, v110
    v_mul_f32 v33, v33, v110
    v_mul_f32 v34, v34, v110
    v_mul_f32 v35, v35, v110
    v_mul_f32 v36, v36, v110
    v_mul_f32 v37, v37, v110
    v_mul_f32 v38, v38, v110
    v_mul_f32 v39, v39, v110
    v_cvt_pk_bf16_f32 v56, v32, v33
    v_cvt_pk_bf16_f32 v57, v34, v35
    v_cvt_pk_bf16_f32 v58, v36, v37
    v_cvt_pk_bf16_f32 v59, v38, v39
    buffer_store_dwordx4 v[56:59], v0, s[4:7], s69 offen sc1
    v_mul_f32 v40, v40, v111
    v_mul_f32 v41, v41, v111
    v_mul_f32 v42, v42, v111
    v_mul_f32 v43, v43, v111
    v_mul_f32 v44, v44, v111
    v_mul_f32 v45, v45, v111
    v_mul_f32 v46, v46, v111
    v_mul_f32 v47, v47, v111
    v_cvt_pk_bf16_f32 v60, v40, v41
    v_cvt_pk_bf16_f32 v61, v42, v43
    v_cvt_pk_bf16_f32 v62, v44, v45
    v_cvt_pk_bf16_f32 v63, v46, v47
    s_add_u32 s73, s69, 180224
    buffer_store_dwordx4 v[60:63], v0, s[4:7], s73 offen sc1
    s_add_u32 s62, s62, 1
    s_add_u32 s68, s68, 32768
    s_add_u32 s69, s69, 1441792
    v_xor_b32 v4, 0x8000, v4
    s_waitcnt vmcnt(0)
    s_barrier
    s_cmp_lg_u32 s3, 0
    s_cbranch_scc1 L_a_arr
    v_mov_b32 v10, 1
    s_mov_b64 exec, 1
    buffer_atomic_add v10, off, s[4:7], s67 sc0
    s_waitcnt vmcnt(0)
    v_readfirstlane_b32 s73, v10
    s_nop 0
    s_cmp_lg_u32 s73, 31
    s_cbranch_scc1 L_a_arr1
    s_add_u32 s73, s67, 4096
    s_nop 0
    buffer_store_dword v10, off, s[4:7], s73 sc1
L_a_arr1:
    s_mov_b64 exec, -1
L_a_arr:
    s_add_u32 s67, s67, 256
    s_cmp_lt_u32 s78, 16
    s_cbranch_scc1 L_a_proj
    s_cmp_lt_u32 s62, 16
    s_cbranch_scc1 L_a_att
    s_branch L_end
L_frole:
    s_cmp_lt_u32 s57, 24
    s_cbranch_scc1 L_f_go
    s_sub_u32 s73, s57, 24
    s_lshl_b32 s73, s73, 16
    s_lshl_b32 s74, s3, 14
    s_add_u32 s73, s73, s74
    s_add_u32 s73, s73, 524288
    v_lshlrev_b32 v1, 4, v0
    v_mov_b64 v[4:5], -1
    v_mov_b64 v[6:7], -1
    buffer_store_dwordx4 v[4:7], v1, s[4:7], s73 offen offset:0 sc1
    buffer_store_dwordx4 v[4:7], v1, s[4:7], s73 offen offset:1024 sc1
    buffer_store_dwordx4 v[4:7], v1, s[4:7], s73 offen offset:2048 sc1
    buffer_store_dwordx4 v[4:7], v1, s[4:7], s73 offen offset:3072 sc1
    s_add_u32 s73, s73, 4096
    buffer_store_dwordx4 v[4:7], v1, s[4:7], s73 offen offset:0 sc1
    buffer_store_dwordx4 v[4:7], v1, s[4:7], s73 offen offset:1024 sc1
    buffer_store_dwordx4 v[4:7], v1, s[4:7], s73 offen offset:2048 sc1
    buffer_store_dwordx4 v[4:7], v1, s[4:7], s73 offen offset:3072 sc1
    s_add_u32 s73, s73, 4096
    buffer_store_dwordx4 v[4:7], v1, s[4:7], s73 offen offset:0 sc1
    buffer_store_dwordx4 v[4:7], v1, s[4:7], s73 offen offset:1024 sc1
    buffer_store_dwordx4 v[4:7], v1, s[4:7], s73 offen offset:2048 sc1
    buffer_store_dwordx4 v[4:7], v1, s[4:7], s73 offen offset:3072 sc1
    s_add_u32 s73, s73, 4096
    buffer_store_dwordx4 v[4:7], v1, s[4:7], s73 offen offset:0 sc1
    buffer_store_dwordx4 v[4:7], v1, s[4:7], s73 offen offset:1024 sc1
    buffer_store_dwordx4 v[4:7], v1, s[4:7], s73 offen offset:2048 sc1
    buffer_store_dwordx4 v[4:7], v1, s[4:7], s73 offen offset:3072 sc1
    s_add_u32 s73, s73, 4096
    v_mov_b32 v8, 1
    s_waitcnt vmcnt(0)
    s_barrier
    s_cmp_lg_u32 s3, 0
    s_cbranch_scc1 L_orole
    s_mov_b64 exec, 1
    buffer_atomic_add v8, off, s[8:11], 0 offset:196
    s_mov_b64 exec, -1
    s_branch L_orole
L_f_go:
    s_add_u32 s61, s57, 64
    s_branch L_f_go2
L_frole2:
    s_lshl_b32 s61, s58, 4
    s_add_u32 s61, s61, s57
    s_sub_u32 s61, s61, 32
L_f_go2:
    s_mul_i32 s60, s61, 373
    s_lshr_b32 s60, s60, 12
    s_mul_i32 s73, s60, 11
    s_sub_u32 s61, s61, s73
    v_and_b32 v20, 15, v0
    v_lshrrev_b32 v21, 4, v0
    v_and_b32 v22, 3, v0
    v_bfe_u32 v23, v0, 2, 2
    v_lshlrev_b32 v1, 10, v20
    v_lshl_add_u32 v1, v21, 4, v1
    s_lshr_b32 s73, s3, 1
    s_lshl_b32 s73, s73, 14
    s_and_b32 s74, s3, 1
    s_lshl_b32 s74, s74, 9
    s_add_u32 s73, s73, s74
    v_add_u32 v1, s73, v1
    s_lshl_b32 s63, s60, 15
    s_lshl_b32 s64, s3, 13
    s_add_u32 m0, s64, 0
    s_nop 0
    buffer_load_dwordx4 v1, s[12:15], s63 offen offset:0 lds
    s_add_u32 m0, s64, 960
    s_nop 0
    buffer_load_dwordx4 v1, s[12:15], s63 offen offset:64 lds
    s_add_u32 m0, s64, 1920
    s_nop 0
    buffer_load_dwordx4 v1, s[12:15], s63 offen offset:128 lds
    s_add_u32 m0, s64, 2880
    s_nop 0
    buffer_load_dwordx4 v1, s[12:15], s63 offen offset:192 lds
    s_add_u32 m0, s64, 3840
    s_nop 0
    buffer_load_dwordx4 v1, s[12:15], s63 offen offset:256 lds
    s_add_u32 m0, s64, 4800
    s_nop 0
    buffer_load_dwordx4 v1, s[12:15], s63 offen offset:320 lds
    s_add_u32 m0, s64, 5760
    s_nop 0
    buffer_load_dwordx4 v1, s[12:15], s63 offen offset:384 lds
    s_add_u32 m0, s64, 6720
    s_nop 0
    buffer_load_dwordx4 v1, s[12:15], s63 offen offset:448 lds
    s_lshl_b32 s75, s61, 8
    s_lshl_b32 s73, s3, 4
    v_add_u32 v24, s73, v21
    s_mov_b32 s73, 2752
    v_mul_lo_u32 v24, v24, s73
    v_add_u32 v24, s75, v24
    v_lshlrev_b32 v25, 1, v21
    v_xor_b32 v25, v25, v20
    v_lshl_add_u32 v26, v25, 4, v24
    v_xor_b32 v25, 8, v25
    v_lshl_add_u32 v27, v25, 4, v24
    v_lshl_add_u32 v24, v21, 3, v23
    v_lshlrev_b32 v24, 8, v24
    v_and_b32 v25, 1, v22
    v_lshl_add_u32 v24, v25, 3, v24
    v_and_b32 v25, 1, v21
    v_lshlrev_b32 v25, 3, v25
    v_lshl_add_u32 v25, v23, 1, v25
    v_lshrrev_b32 v29, 1, v22
    s_lshl_b32 s73, s3, 2
    v_add_u32 v29, s73, v29
    v_xor_b32 v25, v25, v29
    v_lshl_add_u32 v28, v25, 4, v24
    s_lshl_b32 s74, s3, 12
    s_add_u32 m0, s74, 32768
    s_mov_b32 s73, 0
    buffer_load_dwordx4 v26, s[36:39], s73 offen lds
    s_add_u32 m0, s74, 33792
    s_mov_b32 s73, 11008
    buffer_load_dwordx4 v26, s[36:39], s73 offen lds
    s_add_u32 m0, s74, 34816
    s_mov_b32 s73, 22016
    buffer_load_dwordx4 v27, s[36:39], s73 offen lds
    s_add_u32 m0, s74, 35840
    s_mov_b32 s73, 33024
    buffer_load_dwordx4 v27, s[36:39], s73 offen lds
    s_add_u32 m0, s74, 49152
    s_mov_b32 s73, 176128
    buffer_load_dwordx4 v26, s[36:39], s73 offen lds
    s_add_u32 m0, s74, 50176
    s_mov_b32 s73, 187136
    buffer_load_dwordx4 v26, s[36:39], s73 offen lds
    s_add_u32 m0, s74, 51200
    s_mov_b32 s73, 198144
    buffer_load_dwordx4 v27, s[36:39], s73 offen lds
    s_add_u32 m0, s74, 52224
    s_mov_b32 s73, 209152
    buffer_load_dwordx4 v27, s[36:39], s73 offen lds
    s_add_u32 m0, s74, 65536
    s_mov_b32 s73, 352256
    buffer_load_dwordx4 v26, s[36:39], s73 offen lds
    s_add_u32 m0, s74, 66560
    s_mov_b32 s73, 363264
    buffer_load_dwordx4 v26, s[36:39], s73 offen lds
    s_add_u32 m0, s74, 67584
    s_mov_b32 s73, 374272
    buffer_load_dwordx4 v27, s[36:39], s73 offen lds
    s_add_u32 m0, s74, 68608
    s_mov_b32 s73, 385280
    buffer_load_dwordx4 v27, s[36:39], s73 offen lds
    s_add_u32 m0, s74, 81920
    s_mov_b32 s73, 528384
    buffer_load_dwordx4 v26, s[36:39], s73 offen lds
    s_add_u32 m0, s74, 82944
    s_mov_b32 s73, 539392
    buffer_load_dwordx4 v26, s[36:39], s73 offen lds
    s_add_u32 m0, s74, 83968
    s_mov_b32 s73, 550400
    buffer_load_dwordx4 v27, s[36:39], s73 offen lds
    s_add_u32 m0, s74, 84992
    s_mov_b32 s73, 561408
    buffer_load_dwordx4 v27, s[36:39], s73 offen lds
    s_add_u32 m0, s74, 98304
    s_mov_b32 s73, 704512
    buffer_load_dwordx4 v26, s[36:39], s73 offen lds
    s_add_u32 m0, s74, 99328
    s_mov_b32 s73, 715520
    buffer_load_dwordx4 v26, s[36:39], s73 offen lds
    s_add_u32 m0, s74, 100352
    s_mov_b32 s73, 726528
    buffer_load_dwordx4 v27, s[36:39], s73 offen lds
    s_add_u32 m0, s74, 101376
    s_mov_b32 s73, 737536
    buffer_load_dwordx4 v27, s[36:39], s73 offen lds
    s_add_u32 m0, s74, 114688
    s_mov_b32 s73, 880640
    buffer_load_dwordx4 v26, s[36:39], s73 offen lds
    s_add_u32 m0, s74, 115712
    s_mov_b32 s73, 891648
    buffer_load_dwordx4 v26, s[36:39], s73 offen lds
    s_add_u32 m0, s74, 116736
    s_mov_b32 s73, 902656
    buffer_load_dwordx4 v27, s[36:39], s73 offen lds
    s_add_u32 m0, s74, 117760
    s_mov_b32 s73, 913664
    buffer_load_dwordx4 v27, s[36:39], s73 offen lds
    s_add_u32 m0, s74, 131072
    s_mov_b32 s73, 1056768
    buffer_load_dwordx4 v26, s[36:39], s73 offen lds
    s_add_u32 m0, s74, 132096
    s_mov_b32 s73, 1067776
    buffer_load_dwordx4 v26, s[36:39], s73 offen lds
    s_add_u32 m0, s74, 133120
    s_mov_b32 s73, 1078784
    buffer_load_dwordx4 v27, s[36:39], s73 offen lds
    s_add_u32 m0, s74, 134144
    s_mov_b32 s73, 1089792
    buffer_load_dwordx4 v27, s[36:39], s73 offen lds
    s_add_u32 m0, s74, 147456
    s_mov_b32 s73, 1232896
    buffer_load_dwordx4 v26, s[36:39], s73 offen lds
    s_add_u32 m0, s74, 148480
    s_mov_b32 s73, 1243904
    buffer_load_dwordx4 v26, s[36:39], s73 offen lds
    s_add_u32 m0, s74, 149504
    s_mov_b32 s73, 1254912
    buffer_load_dwordx4 v27, s[36:39], s73 offen lds
    s_add_u32 m0, s74, 150528
    s_mov_b32 s73, 1265920
    buffer_load_dwordx4 v27, s[36:39], s73 offen lds
    s_waitcnt vmcnt(16)
    s_barrier
    v_xor_b32 v29, 0, v28
    v_add_u32 v29, 32768, v29
    ds_read_b64_tr_b16 a[0:1], v29 offset:0
    ds_read_b64_tr_b16 a[2:3], v29 offset:1024
    ds_read_b64_tr_b16 a[8:9], v29 offset:8192
    ds_read_b64_tr_b16 a[10:11], v29 offset:9216
    ds_read_b64_tr_b16 a[16:17], v29 offset:16384
    ds_read_b64_tr_b16 a[18:19], v29 offset:17408
    ds_read_b64_tr_b16 a[24:25], v29 offset:24576
    ds_read_b64_tr_b16 a[26:27], v29 offset:25600
    ds_read_b64_tr_b16 a[32:33], v29 offset:32768
    ds_read_b64_tr_b16 a[34:35], v29 offset:33792
    ds_read_b64_tr_b16 a[40:41], v29 offset:40960
    ds_read_b64_tr_b16 a[42:43], v29 offset:41984
    ds_read_b64_tr_b16 a[48:49], v29 offset:49152
    ds_read_b64_tr_b16 a[50:51], v29 offset:50176
    ds_read_b64_tr_b16 a[56:57], v29 offset:57344
    ds_read_b64_tr_b16 a[58:59], v29 offset:58368
    v_xor_b32 v29, 32, v28
    v_add_u32 v29, 32768, v29
    ds_read_b64_tr_b16 a[4:5], v29 offset:0
    ds_read_b64_tr_b16 a[6:7], v29 offset:1024
    ds_read_b64_tr_b16 a[12:13], v29 offset:8192
    ds_read_b64_tr_b16 a[14:15], v29 offset:9216
    ds_read_b64_tr_b16 a[20:21], v29 offset:16384
    ds_read_b64_tr_b16 a[22:23], v29 offset:17408
    ds_read_b64_tr_b16 a[28:29], v29 offset:24576
    ds_read_b64_tr_b16 a[30:31], v29 offset:25600
    ds_read_b64_tr_b16 a[36:37], v29 offset:32768
    ds_read_b64_tr_b16 a[38:39], v29 offset:33792
    ds_read_b64_tr_b16 a[44:45], v29 offset:40960
    ds_read_b64_tr_b16 a[46:47], v29 offset:41984
    ds_read_b64_tr_b16 a[52:53], v29 offset:49152
    ds_read_b64_tr_b16 a[54:55], v29 offset:50176
    ds_read_b64_tr_b16 a[60:61], v29 offset:57344
    ds_read_b64_tr_b16 a[62:63], v29 offset:58368
    s_waitcnt lgkmcnt(0)
    s_barrier
    s_add_u32 m0, s74, 32768
    s_mov_b32 s73, 0
    buffer_load_dwordx4 v26, s[40:43], s73 offen lds
    s_add_u32 m0, s74, 33792
    s_mov_b32 s73, 11008
    buffer_load_dwordx4 v26, s[40:43], s73 offen lds
    s_add_u32 m0, s74, 34816
    s_mov_b32 s73, 22016
    buffer_load_dwordx4 v27, s[40:43], s73 offen lds
    s_add_u32 m0, s74, 35840
    s_mov_b32 s73, 33024
    buffer_load_dwordx4 v27, s[40:43], s73 offen lds
    s_add_u32 m0, s74, 49152
    s_mov_b32 s73, 176128
    buffer_load_dwordx4 v26, s[40:43], s73 offen lds
    s_add_u32 m0, s74, 50176
    s_mov_b32 s73, 187136
    buffer_load_dwordx4 v26, s[40:43], s73 offen lds
    s_add_u32 m0, s74, 51200
    s_mov_b32 s73, 198144
    buffer_load_dwordx4 v27, s[40:43], s73 offen lds
    s_add_u32 m0, s74, 52224
    s_mov_b32 s73, 209152
    buffer_load_dwordx4 v27, s[40:43], s73 offen lds
    s_add_u32 m0, s74, 65536
    s_mov_b32 s73, 352256
    buffer_load_dwordx4 v26, s[40:43], s73 offen lds
    s_add_u32 m0, s74, 66560
    s_mov_b32 s73, 363264
    buffer_load_dwordx4 v26, s[40:43], s73 offen lds
    s_add_u32 m0, s74, 67584
    s_mov_b32 s73, 374272
    buffer_load_dwordx4 v27, s[40:43], s73 offen lds
    s_add_u32 m0, s74, 68608
    s_mov_b32 s73, 385280
    buffer_load_dwordx4 v27, s[40:43], s73 offen lds
    s_add_u32 m0, s74, 81920
    s_mov_b32 s73, 528384
    buffer_load_dwordx4 v26, s[40:43], s73 offen lds
    s_add_u32 m0, s74, 82944
    s_mov_b32 s73, 539392
    buffer_load_dwordx4 v26, s[40:43], s73 offen lds
    s_add_u32 m0, s74, 83968
    s_mov_b32 s73, 550400
    buffer_load_dwordx4 v27, s[40:43], s73 offen lds
    s_add_u32 m0, s74, 84992
    s_mov_b32 s73, 561408
    buffer_load_dwordx4 v27, s[40:43], s73 offen lds
    s_waitcnt vmcnt(16)
    s_barrier
    v_xor_b32 v29, 0, v28
    v_add_u32 v29, 98304, v29
    ds_read_b64_tr_b16 a[64:65], v29 offset:0
    ds_read_b64_tr_b16 a[66:67], v29 offset:1024
    ds_read_b64_tr_b16 a[72:73], v29 offset:8192
    ds_read_b64_tr_b16 a[74:75], v29 offset:9216
    ds_read_b64_tr_b16 a[80:81], v29 offset:16384
    ds_read_b64_tr_b16 a[82:83], v29 offset:17408
    ds_read_b64_tr_b16 a[88:89], v29 offset:24576
    ds_read_b64_tr_b16 a[90:91], v29 offset:25600
    ds_read_b64_tr_b16 a[96:97], v29 offset:32768
    ds_read_b64_tr_b16 a[98:99], v29 offset:33792
    ds_read_b64_tr_b16 a[104:105], v29 offset:40960
    ds_read_b64_tr_b16 a[106:107], v29 offset:41984
    ds_read_b64_tr_b16 a[112:113], v29 offset:49152
    ds_read_b64_tr_b16 a[114:115], v29 offset:50176
    ds_read_b64_tr_b16 a[120:121], v29 offset:57344
    ds_read_b64_tr_b16 a[122:123], v29 offset:58368
    v_xor_b32 v29, 32, v28
    v_add_u32 v29, 98304, v29
    ds_read_b64_tr_b16 a[68:69], v29 offset:0
    ds_read_b64_tr_b16 a[70:71], v29 offset:1024
    ds_read_b64_tr_b16 a[76:77], v29 offset:8192
    ds_read_b64_tr_b16 a[78:79], v29 offset:9216
    ds_read_b64_tr_b16 a[84:85], v29 offset:16384
    ds_read_b64_tr_b16 a[86:87], v29 offset:17408
    ds_read_b64_tr_b16 a[92:93], v29 offset:24576
    ds_read_b64_tr_b16 a[94:95], v29 offset:25600
    ds_read_b64_tr_b16 a[100:101], v29 offset:32768
    ds_read_b64_tr_b16 a[102:103], v29 offset:33792
    ds_read_b64_tr_b16 a[108:109], v29 offset:40960
    ds_read_b64_tr_b16 a[110:111], v29 offset:41984
    ds_read_b64_tr_b16 a[116:117], v29 offset:49152
    ds_read_b64_tr_b16 a[118:119], v29 offset:50176
    ds_read_b64_tr_b16 a[124:125], v29 offset:57344
    ds_read_b64_tr_b16 a[126:127], v29 offset:58368
    s_waitcnt lgkmcnt(0)
    s_barrier
    s_add_u32 m0, s74, 98304
    s_mov_b32 s73, 704512
    buffer_load_dwordx4 v26, s[40:43], s73 offen lds
    s_add_u32 m0, s74, 99328
    s_mov_b32 s73, 715520
    buffer_load_dwordx4 v26, s[40:43], s73 offen lds
    s_add_u32 m0, s74, 100352
    s_mov_b32 s73, 726528
    buffer_load_dwordx4 v27, s[40:43], s73 offen lds
    s_add_u32 m0, s74, 101376
    s_mov_b32 s73, 737536
    buffer_load_dwordx4 v27, s[40:43], s73 offen lds
    s_add_u32 m0, s74, 114688
    s_mov_b32 s73, 880640
    buffer_load_dwordx4 v26, s[40:43], s73 offen lds
    s_add_u32 m0, s74, 115712
    s_mov_b32 s73, 891648
    buffer_load_dwordx4 v26, s[40:43], s73 offen lds
    s_add_u32 m0, s74, 116736
    s_mov_b32 s73, 902656
    buffer_load_dwordx4 v27, s[40:43], s73 offen lds
    s_add_u32 m0, s74, 117760
    s_mov_b32 s73, 913664
    buffer_load_dwordx4 v27, s[40:43], s73 offen lds
    s_add_u32 m0, s74, 131072
    s_mov_b32 s73, 1056768
    buffer_load_dwordx4 v26, s[40:43], s73 offen lds
    s_add_u32 m0, s74, 132096
    s_mov_b32 s73, 1067776
    buffer_load_dwordx4 v26, s[40:43], s73 offen lds
    s_add_u32 m0, s74, 133120
    s_mov_b32 s73, 1078784
    buffer_load_dwordx4 v27, s[40:43], s73 offen lds
    s_add_u32 m0, s74, 134144
    s_mov_b32 s73, 1089792
    buffer_load_dwordx4 v27, s[40:43], s73 offen lds
    s_add_u32 m0, s74, 147456
    s_mov_b32 s73, 1232896
    buffer_load_dwordx4 v26, s[40:43], s73 offen lds
    s_add_u32 m0, s74, 148480
    s_mov_b32 s73, 1243904
    buffer_load_dwordx4 v26, s[40:43], s73 offen lds
    s_add_u32 m0, s74, 149504
    s_mov_b32 s73, 1254912
    buffer_load_dwordx4 v27, s[40:43], s73 offen lds
    s_add_u32 m0, s74, 150528
    s_mov_b32 s73, 1265920
    buffer_load_dwordx4 v27, s[40:43], s73 offen lds
    s_waitcnt vmcnt(16)
    s_barrier
    v_xor_b32 v29, 0, v28
    v_add_u32 v29, 32768, v29
    ds_read_b64_tr_b16 a[128:129], v29 offset:0
    ds_read_b64_tr_b16 a[130:131], v29 offset:1024
    ds_read_b64_tr_b16 a[136:137], v29 offset:8192
    ds_read_b64_tr_b16 a[138:139], v29 offset:9216
    ds_read_b64_tr_b16 a[144:145], v29 offset:16384
    ds_read_b64_tr_b16 a[146:147], v29 offset:17408
    ds_read_b64_tr_b16 a[152:153], v29 offset:24576
    ds_read_b64_tr_b16 a[154:155], v29 offset:25600
    ds_read_b64_tr_b16 a[160:161], v29 offset:32768
    ds_read_b64_tr_b16 a[162:163], v29 offset:33792
    ds_read_b64_tr_b16 a[168:169], v29 offset:40960
    ds_read_b64_tr_b16 a[170:171], v29 offset:41984
    ds_read_b64_tr_b16 a[176:177], v29 offset:49152
    ds_read_b64_tr_b16 a[178:179], v29 offset:50176
    ds_read_b64_tr_b16 a[184:185], v29 offset:57344
    ds_read_b64_tr_b16 a[186:187], v29 offset:58368
    v_xor_b32 v29, 32, v28
    v_add_u32 v29, 32768, v29
    ds_read_b64_tr_b16 a[132:133], v29 offset:0
    ds_read_b64_tr_b16 a[134:135], v29 offset:1024
    ds_read_b64_tr_b16 a[140:141], v29 offset:8192
    ds_read_b64_tr_b16 a[142:143], v29 offset:9216
    ds_read_b64_tr_b16 a[148:149], v29 offset:16384
    ds_read_b64_tr_b16 a[150:151], v29 offset:17408
    ds_read_b64_tr_b16 a[156:157], v29 offset:24576
    ds_read_b64_tr_b16 a[158:159], v29 offset:25600
    ds_read_b64_tr_b16 a[164:165], v29 offset:32768
    ds_read_b64_tr_b16 a[166:167], v29 offset:33792
    ds_read_b64_tr_b16 a[172:173], v29 offset:40960
    ds_read_b64_tr_b16 a[174:175], v29 offset:41984
    ds_read_b64_tr_b16 a[180:181], v29 offset:49152
    ds_read_b64_tr_b16 a[182:183], v29 offset:50176
    ds_read_b64_tr_b16 a[188:189], v29 offset:57344
    ds_read_b64_tr_b16 a[190:191], v29 offset:58368
    s_waitcnt lgkmcnt(0)
    s_barrier
    s_waitcnt vmcnt(0)
    s_barrier
    v_xor_b32 v29, 0, v28
    v_add_u32 v29, 98304, v29
    ds_read_b64_tr_b16 a[192:193], v29 offset:0
    ds_read_b64_tr_b16 a[194:195], v29 offset:1024
    ds_read_b64_tr_b16 a[200:201], v29 offset:8192
    ds_read_b64_tr_b16 a[202:203], v29 offset:9216
    ds_read_b64_tr_b16 a[208:209], v29 offset:16384
    ds_read_b64_tr_b16 a[210:211], v29 offset:17408
    ds_read_b64_tr_b16 a[216:217], v29 offset:24576
    ds_read_b64_tr_b16 a[218:219], v29 offset:25600
    ds_read_b64_tr_b16 a[224:225], v29 offset:32768
    ds_read_b64_tr_b16 a[226:227], v29 offset:33792
    ds_read_b64_tr_b16 a[232:233], v29 offset:40960
    ds_read_b64_tr_b16 a[234:235], v29 offset:41984
    ds_read_b64_tr_b16 a[240:241], v29 offset:49152
    ds_read_b64_tr_b16 a[242:243], v29 offset:50176
    ds_read_b64_tr_b16 a[248:249], v29 offset:57344
    ds_read_b64_tr_b16 a[250:251], v29 offset:58368
    v_xor_b32 v29, 32, v28
    v_add_u32 v29, 98304, v29
    ds_read_b64_tr_b16 a[196:197], v29 offset:0
    ds_read_b64_tr_b16 a[198:199], v29 offset:1024
    ds_read_b64_tr_b16 a[204:205], v29 offset:8192
    ds_read_b64_tr_b16 a[206:207], v29 offset:9216
    ds_read_b64_tr_b16 a[212:213], v29 offset:16384
    ds_read_b64_tr_b16 a[214:215], v29 offset:17408
    ds_read_b64_tr_b16 a[220:221], v29 offset:24576
    ds_read_b64_tr_b16 a[222:223], v29 offset:25600
    ds_read_b64_tr_b16 a[228:229], v29 offset:32768
    ds_read_b64_tr_b16 a[230:231], v29 offset:33792
    ds_read_b64_tr_b16 a[236:237], v29 offset:40960
    ds_read_b64_tr_b16 a[238:239], v29 offset:41984
    ds_read_b64_tr_b16 a[244:245], v29 offset:49152
    ds_read_b64_tr_b16 a[246:247], v29 offset:50176
    ds_read_b64_tr_b16 a[252:253], v29 offset:57344
    ds_read_b64_tr_b16 a[254:255], v29 offset:58368
    s_waitcnt lgkmcnt(0)
    s_barrier
    s_add_u32 s63, s63, 262144
    s_xor_b32 s64, s64, 0x8000
    s_add_u32 m0, s64, 0
    s_nop 0
    buffer_load_dwordx4 v1, s[12:15], s63 offen offset:0 lds
    s_add_u32 m0, s64, 960
    s_nop 0
    buffer_load_dwordx4 v1, s[12:15], s63 offen offset:64 lds
    s_add_u32 m0, s64, 1920
    s_nop 0
    buffer_load_dwordx4 v1, s[12:15], s63 offen offset:128 lds
    s_add_u32 m0, s64, 2880
    s_nop 0
    buffer_load_dwordx4 v1, s[12:15], s63 offen offset:192 lds
    s_add_u32 m0, s64, 3840
    s_nop 0
    buffer_load_dwordx4 v1, s[12:15], s63 offen offset:256 lds
    s_add_u32 m0, s64, 4800
    s_nop 0
    buffer_load_dwordx4 v1, s[12:15], s63 offen offset:320 lds
    s_add_u32 m0, s64, 5760
    s_nop 0
    buffer_load_dwordx4 v1, s[12:15], s63 offen offset:384 lds
    s_add_u32 m0, s64, 6720
    s_nop 0
    buffer_load_dwordx4 v1, s[12:15], s63 offen offset:448 lds
    s_add_u32 s63, s63, 262144
    s_xor_b32 s64, s64, 0x8000
    v_lshlrev_b32 v0, 4, v0
    v_mov_b32 v2, v0
    s_mul_i32 s69, s60, 360448
    s_lshl_b32 s73, s61, 12
    s_add_u32 s69, s69, s73
    s_lshl_b32 s73, s3, 10
    s_add_u32 s69, s69, s73
    s_add_u32 s69, s69, 52559872
    s_mov_b32 s70, 0xbfb8aa3b
    s_mov_b32 s78, s60
    s_waitcnt vmcnt(8)
    s_mov_b32 s72, 0x70000000
    v_mov_b64 v[80:81], 0
    v_mov_b64 v[82:83], 0
    v_mov_b64 v[84:85], 0
    v_mov_b64 v[86:87], 0
    v_mov_b64 v[88:89], 0
    v_mov_b64 v[90:91], 0
    v_mov_b64 v[92:93], 0
    v_mov_b64 v[94:95], 0
    v_mov_b64 v[96:97], 0
    v_mov_b64 v[98:99], 0
    v_mov_b64 v[100:101], 0
    v_mov_b64 v[102:103], 0
    v_mov_b64 v[104:105], 0
    v_mov_b64 v[106:107], 0
    v_mov_b64 v[108:109], 0
    v_mov_b64 v[110:111], 0
L_f_loop:
    s_waitcnt vmcnt(10)
L_f_loop2:
    s_barrier
    ds_read_b128 v[64:67], v2 offset:0
    ds_read_b128 v[68:71], v2 offset:16384
    s_waitcnt lgkmcnt(0)
    v_mfma_f32_16x16x32_bf16 v[16:19], a[0:3], v[64:67], 0
    ds_read_b128 v[72:75], v2 offset:1024
    v_mfma_f32_16x16x32_bf16 v[32:35], a[128:131], v[64:67], 0
    ds_read_b128 v[76:79], v2 offset:17408
    v_mfma_f32_16x16x32_bf16 v[20:23], a[4:7], v[64:67], 0
    v_exp_f32 v80, v80
    v_mfma_f32_16x16x32_bf16 v[36:39], a[132:135], v[64:67], 0
    v_exp_f32 v81, v81
    v_mfma_f32_16x16x32_bf16 v[24:27], a[0:3], v[68:71], 0
    v_exp_f32 v82, v82
    v_mfma_f32_16x16x32_bf16 v[40:43], a[128:131], v[68:71], 0
    v_exp_f32 v83, v83
    v_mfma_f32_16x16x32_bf16 v[28:31], a[4:7], v[68:71], 0
    v_exp_f32 v84, v84
    v_mfma_f32_16x16x32_bf16 v[44:47], a[132:135], v[68:71], 0
    v_exp_f32 v85, v85
    s_waitcnt lgkmcnt(0)
    v_mfma_f32_16x16x32_bf16 v[16:19], a[8:11], v[72:75], v[16:19]
    ds_read_b128 v[64:67], v2 offset:2048
    v_mfma_f32_16x16x32_bf16 v[32:35], a[136:139], v[72:75], v[32:35]
    ds_read_b128 v[68:71], v2 offset:18432
    v_mfma_f32_16x16x32_bf16 v[20:23], a[12:15], v[72:75], v[20:23]
    v_exp_f32 v86, v86
    v_mfma_f32_16x16x32_bf16 v[36:39], a[140:143], v[72:75], v[36:39]
    v_exp_f32 v87, v87
    v_mfma_f32_16x16x32_bf16 v[24:27], a[8:11], v[76:79], v[24:27]
    v_exp_f32 v88, v88
    v_mfma_f32_16x16x32_bf16 v[40:43], a[136:139], v[76:79], v[40:43]
    v_exp_f32 v89, v89
    v_mfma_f32_16x16x32_bf16 v[28:31], a[12:15], v[76:79], v[28:31]
    v_exp_f32 v90, v90
    v_mfma_f32_16x16x32_bf16 v[44:47], a[140:143], v[76:79], v[44:47]
    v_exp_f32 v91, v91
    s_waitcnt lgkmcnt(0)
    v_mfma_f32_16x16x32_bf16 v[16:19], a[16:19], v[64:67], v[16:19]
    ds_read_b128 v[72:75], v2 offset:3072
    v_mfma_f32_16x16x32_bf16 v[32:35], a[144:147], v[64:67], v[32:35]
    ds_read_b128 v[76:79], v2 offset:19456
    v_mfma_f32_16x16x32_bf16 v[20:23], a[20:23], v[64:67], v[20:23]
    v_exp_f32 v92, v92
    v_mfma_f32_16x16x32_bf16 v[36:39], a[148:151], v[64:67], v[36:39]
    v_exp_f32 v93, v93
    v_mfma_f32_16x16x32_bf16 v[24:27], a[16:19], v[68:71], v[24:27]
    v_exp_f32 v94, v94
    v_mfma_f32_16x16x32_bf16 v[40:43], a[144:147], v[68:71], v[40:43]
    v_exp_f32 v95, v95
    v_mfma_f32_16x16x32_bf16 v[28:31], a[20:23], v[68:71], v[28:31]
    v_add_f32 v80, 1.0, v80
    v_mfma_f32_16x16x32_bf16 v[44:47], a[148:151], v[68:71], v[44:47]
    v_add_f32 v81, 1.0, v81
    s_waitcnt lgkmcnt(0)
    v_mfma_f32_16x16x32_bf16 v[16:19], a[24:27], v[72:75], v[16:19]
    ds_read_b128 v[64:67], v2 offset:4096
    v_mfma_f32_16x16x32_bf16 v[32:35], a[152:155], v[72:75], v[32:35]
    ds_read_b128 v[68:71], v2 offset:20480
    v_mfma_f32_16x16x32_bf16 v[20:23], a[28:31], v[72:75], v[20:23]
    v_add_f32 v82, 1.0, v82
    v_mfma_f32_16x16x32_bf16 v[36:39], a[156:159], v[72:75], v[36:39]
    v_add_f32 v83, 1.0, v83
    v_mfma_f32_16x16x32_bf16 v[24:27], a[24:27], v[76:79], v[24:27]
    v_add_f32 v84, 1.0, v84
    v_mfma_f32_16x16x32_bf16 v[40:43], a[152:155], v[76:79], v[40:43]
    v_add_f32 v85, 1.0, v85
    v_mfma_f32_16x16x32_bf16 v[28:31], a[28:31], v[76:79], v[28:31]
    v_add_f32 v86, 1.0, v86
    v_mfma_f32_16x16x32_bf16 v[44:47], a[156:159], v[76:79], v[44:47]
    v_add_f32 v87, 1.0, v87
    s_waitcnt lgkmcnt(0)
    v_mfma_f32_16x16x32_bf16 v[16:19], a[32:35], v[64:67], v[16:19]
    ds_read_b128 v[72:75], v2 offset:5120
    v_mfma_f32_16x16x32_bf16 v[32:35], a[160:163], v[64:67], v[32:35]
    ds_read_b128 v[76:79], v2 offset:21504
    v_mfma_f32_16x16x32_bf16 v[20:23], a[36:39], v[64:67], v[20:23]
    v_add_f32 v88, 1.0, v88
    v_mfma_f32_16x16x32_bf16 v[36:39], a[164:167], v[64:67], v[36:39]
    v_add_f32 v89, 1.0, v89
    v_mfma_f32_16x16x32_bf16 v[24:27], a[32:35], v[68:71], v[24:27]
    v_add_f32 v90, 1.0, v90
    v_mfma_f32_16x16x32_bf16 v[40:43], a[160:163], v[68:71], v[40:43]
    v_add_f32 v91, 1.0, v91
    v_mfma_f32_16x16x32_bf16 v[28:31], a[36:39], v[68:71], v[28:31]
    v_add_f32 v92, 1.0, v92
    v_mfma_f32_16x16x32_bf16 v[44:47], a[164:167], v[68:71], v[44:47]
    v_add_f32 v93, 1.0, v93
    s_waitcnt lgkmcnt(0)
    v_mfma_f32_16x16x32_bf16 v[16:19], a[40:43], v[72:75], v[16:19]
    ds_read_b128 v[64:67], v2 offset:6144
    v_mfma_f32_16x16x32_bf16 v[32:35], a[168:171], v[72:75], v[32:35]
    ds_read_b128 v[68:71], v2 offset:22528
    v_mfma_f32_16x16x32_bf16 v[20:23], a[44:47], v[72:75], v[20:23]
    v_add_f32 v94, 1.0, v94
    v_mfma_f32_16x16x32_bf16 v[36:39], a[172:175], v[72:75], v[36:39]
    v_add_f32 v95, 1.0, v95
    v_mfma_f32_16x16x32_bf16 v[24:27], a[40:43], v[76:79], v[24:27]
    v_rcp_f32 v80, v80
    v_mfma_f32_16x16x32_bf16 v[40:43], a[168:171], v[76:79], v[40:43]
    v_rcp_f32 v81, v81
    v_mfma_f32_16x16x32_bf16 v[28:31], a[44:47], v[76:79], v[28:31]
    v_rcp_f32 v82, v82
    v_mfma_f32_16x16x32_bf16 v[44:47], a[172:175], v[76:79], v[44:47]
    v_rcp_f32 v83, v83
    s_waitcnt lgkmcnt(0)
    v_mfma_f32_16x16x32_bf16 v[16:19], a[48:51], v[64:67], v[16:19]
    ds_read_b128 v[72:75], v2 offset:7168
    v_mfma_f32_16x16x32_bf16 v[32:35], a[176:179], v[64:67], v[32:35]
    ds_read_b128 v[76:79], v2 offset:23552
    v_mfma_f32_16x16x32_bf16 v[20:23], a[52:55], v[64:67], v[20:23]
    v_rcp_f32 v84, v84
    v_mfma_f32_16x16x32_bf16 v[36:39], a[180:183], v[64:67], v[36:39]
    v_rcp_f32 v85, v85
    v_mfma_f32_16x16x32_bf16 v[24:27], a[48:51], v[68:71], v[24:27]
    v_rcp_f32 v86, v86
    v_mfma_f32_16x16x32_bf16 v[40:43], a[176:179], v[68:71], v[40:43]
    v_rcp_f32 v87, v87
    v_mfma_f32_16x16x32_bf16 v[28:31], a[52:55], v[68:71], v[28:31]
    v_rcp_f32 v88, v88
    v_mfma_f32_16x16x32_bf16 v[44:47], a[180:183], v[68:71], v[44:47]
    v_rcp_f32 v89, v89
    s_waitcnt lgkmcnt(0)
    v_mfma_f32_16x16x32_bf16 v[16:19], a[56:59], v[72:75], v[16:19]
    ds_read_b128 v[64:67], v2 offset:8192
    v_mfma_f32_16x16x32_bf16 v[32:35], a[184:187], v[72:75], v[32:35]
    ds_read_b128 v[68:71], v2 offset:24576
    v_mfma_f32_16x16x32_bf16 v[20:23], a[60:63], v[72:75], v[20:23]
    v_rcp_f32 v90, v90
    v_mfma_f32_16x16x32_bf16 v[36:39], a[188:191], v[72:75], v[36:39]
    v_rcp_f32 v91, v91
    v_mfma_f32_16x16x32_bf16 v[24:27], a[56:59], v[76:79], v[24:27]
    v_rcp_f32 v92, v92
    v_mfma_f32_16x16x32_bf16 v[40:43], a[184:187], v[76:79], v[40:43]
    v_rcp_f32 v93, v93
    v_mfma_f32_16x16x32_bf16 v[28:31], a[60:63], v[76:79], v[28:31]
    v_rcp_f32 v94, v94
    v_mfma_f32_16x16x32_bf16 v[44:47], a[188:191], v[76:79], v[44:47]
    v_rcp_f32 v95, v95
    s_waitcnt lgkmcnt(0)
    v_mfma_f32_16x16x32_bf16 v[16:19], a[64:67], v[64:67], v[16:19]
    ds_read_b128 v[72:75], v2 offset:9216
    v_mfma_f32_16x16x32_bf16 v[32:35], a[192:195], v[64:67], v[32:35]
    ds_read_b128 v[76:79], v2 offset:25600
    v_mfma_f32_16x16x32_bf16 v[20:23], a[68:71], v[64:67], v[20:23]
    v_mul_f32 v96, v96, v80
    v_mfma_f32_16x16x32_bf16 v[36:39], a[196:199], v[64:67], v[36:39]
    v_mul_f32 v97, v97, v81
    v_mfma_f32_16x16x32_bf16 v[24:27], a[64:67], v[68:71], v[24:27]
    v_mul_f32 v98, v98, v82
    v_mfma_f32_16x16x32_bf16 v[40:43], a[192:195], v[68:71], v[40:43]
    v_mul_f32 v99, v99, v83
    v_mfma_f32_16x16x32_bf16 v[28:31], a[68:71], v[68:71], v[28:31]
    v_mul_f32 v100, v100, v84
    v_mfma_f32_16x16x32_bf16 v[44:47], a[196:199], v[68:71], v[44:47]
    v_mul_f32 v101, v101, v85
    s_waitcnt lgkmcnt(0)
    v_mfma_f32_16x16x32_bf16 v[16:19], a[72:75], v[72:75], v[16:19]
    ds_read_b128 v[64:67], v2 offset:10240
    v_mfma_f32_16x16x32_bf16 v[32:35], a[200:203], v[72:75], v[32:35]
    ds_read_b128 v[68:71], v2 offset:26624
    v_mfma_f32_16x16x32_bf16 v[20:23], a[76:79], v[72:75], v[20:23]
    v_mul_f32 v102, v102, v86
    v_mfma_f32_16x16x32_bf16 v[36:39], a[204:207], v[72:75], v[36:39]
    v_mul_f32 v103, v103, v87
    v_mfma_f32_16x16x32_bf16 v[24:27], a[72:75], v[76:79], v[24:27]
    v_mul_f32 v104, v104, v88
    v_mfma_f32_16x16x32_bf16 v[40:43], a[200:203], v[76:79], v[40:43]
    v_mul_f32 v105, v105, v89
    v_mfma_f32_16x16x32_bf16 v[28:31], a[76:79], v[76:79], v[28:31]
    v_mul_f32 v106, v106, v90
    v_mfma_f32_16x16x32_bf16 v[44:47], a[204:207], v[76:79], v[44:47]
    v_mul_f32 v107, v107, v91
    s_waitcnt lgkmcnt(0)
    v_mfma_f32_16x16x32_bf16 v[16:19], a[80:83], v[64:67], v[16:19]
    ds_read_b128 v[72:75], v2 offset:11264
    v_mfma_f32_16x16x32_bf16 v[32:35], a[208:211], v[64:67], v[32:35]
    ds_read_b128 v[76:79], v2 offset:27648
    v_mfma_f32_16x16x32_bf16 v[20:23], a[84:87], v[64:67], v[20:23]
    v_mul_f32 v108, v108, v92
    v_mfma_f32_16x16x32_bf16 v[36:39], a[212:215], v[64:67], v[36:39]
    v_mul_f32 v109, v109, v93
    v_mfma_f32_16x16x32_bf16 v[24:27], a[80:83], v[68:71], v[24:27]
    v_mul_f32 v110, v110, v94
    v_mfma_f32_16x16x32_bf16 v[40:43], a[208:211], v[68:71], v[40:43]
    v_mul_f32 v111, v111, v95
    v_mfma_f32_16x16x32_bf16 v[28:31], a[84:87], v[68:71], v[28:31]
    v_cvt_pk_bf16_f32 v112, v96, v97
    v_mfma_f32_16x16x32_bf16 v[44:47], a[212:215], v[68:71], v[44:47]
    v_cvt_pk_bf16_f32 v113, v98, v99
    s_waitcnt lgkmcnt(0)
    v_mfma_f32_16x16x32_bf16 v[16:19], a[88:91], v[72:75], v[16:19]
    ds_read_b128 v[64:67], v2 offset:12288
    v_mfma_f32_16x16x32_bf16 v[32:35], a[216:219], v[72:75], v[32:35]
    ds_read_b128 v[68:71], v2 offset:28672
    v_mfma_f32_16x16x32_bf16 v[20:23], a[92:95], v[72:75], v[20:23]
    v_cvt_pk_bf16_f32 v114, v100, v101
    v_mfma_f32_16x16x32_bf16 v[36:39], a[220:223], v[72:75], v[36:39]
    v_cvt_pk_bf16_f32 v115, v102, v103
    v_mfma_f32_16x16x32_bf16 v[24:27], a[88:91], v[76:79], v[24:27]
    v_cvt_pk_bf16_f32 v116, v104, v105
    v_mfma_f32_16x16x32_bf16 v[40:43], a[216:219], v[76:79], v[40:43]
    v_cvt_pk_bf16_f32 v117, v106, v107
    v_mfma_f32_16x16x32_bf16 v[28:31], a[92:95], v[76:79], v[28:31]
    v_cvt_pk_bf16_f32 v118, v108, v109
    v_mfma_f32_16x16x32_bf16 v[44:47], a[220:223], v[76:79], v[44:47]
    v_cvt_pk_bf16_f32 v119, v110, v111
    s_waitcnt lgkmcnt(0)
    v_mfma_f32_16x16x32_bf16 v[16:19], a[96:99], v[64:67], v[16:19]
    ds_read_b128 v[72:75], v2 offset:13312
    v_mfma_f32_16x16x32_bf16 v[32:35], a[224:227], v[64:67], v[32:35]
    ds_read_b128 v[76:79], v2 offset:29696
    v_mfma_f32_16x16x32_bf16 v[20:23], a[100:103], v[64:67], v[20:23]
    s_add_u32 s73, s72, 180224
    v_mfma_f32_16x16x32_bf16 v[36:39], a[228:231], v[64:67], v[36:39]
    buffer_store_dwordx4 v[112:115], v0, s[4:7], s72 offen sc1
    v_mfma_f32_16x16x32_bf16 v[24:27], a[96:99], v[68:71], v[24:27]
    buffer_store_dwordx4 v[116:119], v0, s[4:7], s73 offen sc1
    v_mfma_f32_16x16x32_bf16 v[40:43], a[224:227], v[68:71], v[40:43]
    v_mfma_f32_16x16x32_bf16 v[28:31], a[100:103], v[68:71], v[28:31]
    v_mfma_f32_16x16x32_bf16 v[44:47], a[228:231], v[68:71], v[44:47]
    s_waitcnt lgkmcnt(0)
    v_mfma_f32_16x16x32_bf16 v[16:19], a[104:107], v[72:75], v[16:19]
    ds_read_b128 v[64:67], v2 offset:14336
    v_mfma_f32_16x16x32_bf16 v[32:35], a[232:235], v[72:75], v[32:35]
    ds_read_b128 v[68:71], v2 offset:30720
    v_mfma_f32_16x16x32_bf16 v[20:23], a[108:111], v[72:75], v[20:23]
    v_mfma_f32_16x16x32_bf16 v[36:39], a[236:239], v[72:75], v[36:39]
    v_mfma_f32_16x16x32_bf16 v[24:27], a[104:107], v[76:79], v[24:27]
    v_mfma_f32_16x16x32_bf16 v[40:43], a[232:235], v[76:79], v[40:43]
    v_mfma_f32_16x16x32_bf16 v[28:31], a[108:111], v[76:79], v[28:31]
    v_mfma_f32_16x16x32_bf16 v[44:47], a[236:239], v[76:79], v[44:47]
    s_waitcnt lgkmcnt(0)
    v_mfma_f32_16x16x32_bf16 v[16:19], a[112:115], v[64:67], v[16:19]
    ds_read_b128 v[72:75], v2 offset:15360
    v_mfma_f32_16x16x32_bf16 v[32:35], a[240:243], v[64:67], v[32:35]
    ds_read_b128 v[76:79], v2 offset:31744
    v_mfma_f32_16x16x32_bf16 v[20:23], a[116:119], v[64:67], v[20:23]
    v_mfma_f32_16x16x32_bf16 v[36:39], a[244:247], v[64:67], v[36:39]
    v_mfma_f32_16x16x32_bf16 v[24:27], a[112:115], v[68:71], v[24:27]
    v_mfma_f32_16x16x32_bf16 v[40:43], a[240:243], v[68:71], v[40:43]
    v_mfma_f32_16x16x32_bf16 v[28:31], a[116:119], v[68:71], v[28:31]
    v_mfma_f32_16x16x32_bf16 v[44:47], a[244:247], v[68:71], v[44:47]
    s_waitcnt lgkmcnt(0)
    v_mfma_f32_16x16x32_bf16 v[16:19], a[120:123], v[72:75], v[16:19]
    v_mfma_f32_16x16x32_bf16 v[32:35], a[248:251], v[72:75], v[32:35]
    v_mfma_f32_16x16x32_bf16 v[20:23], a[124:127], v[72:75], v[20:23]
    v_mfma_f32_16x16x32_bf16 v[36:39], a[252:255], v[72:75], v[36:39]
    v_mfma_f32_16x16x32_bf16 v[24:27], a[120:123], v[76:79], v[24:27]
    v_mfma_f32_16x16x32_bf16 v[40:43], a[248:251], v[76:79], v[40:43]
    v_mfma_f32_16x16x32_bf16 v[28:31], a[124:127], v[76:79], v[28:31]
    v_mfma_f32_16x16x32_bf16 v[44:47], a[252:255], v[76:79], v[44:47]
    s_barrier
    s_add_u32 m0, s64, 0
    s_nop 0
    buffer_load_dwordx4 v1, s[12:15], s63 offen offset:0 lds
    s_add_u32 m0, s64, 960
    s_nop 0
    buffer_load_dwordx4 v1, s[12:15], s63 offen offset:64 lds
    s_add_u32 m0, s64, 1920
    s_nop 0
    buffer_load_dwordx4 v1, s[12:15], s63 offen offset:128 lds
    s_add_u32 m0, s64, 2880
    s_nop 0
    buffer_load_dwordx4 v1, s[12:15], s63 offen offset:192 lds
    s_add_u32 m0, s64, 3840
    s_nop 0
    buffer_load_dwordx4 v1, s[12:15], s63 offen offset:256 lds
    s_add_u32 m0, s64, 4800
    s_nop 0
    buffer_load_dwordx4 v1, s[12:15], s63 offen offset:320 lds
    s_add_u32 m0, s64, 5760
    s_nop 0
    buffer_load_dwordx4 v1, s[12:15], s63 offen offset:384 lds
    s_add_u32 m0, s64, 6720
    s_nop 0
    buffer_load_dwordx4 v1, s[12:15], s63 offen offset:448 lds
    v_mul_f32 v80, s70, v16
    v_mul_f32 v81, s70, v17
    v_mul_f32 v82, s70, v18
    v_mul_f32 v83, s70, v19
    v_mul_f32 v84, s70, v20
    v_mul_f32 v85, s70, v21
    v_mul_f32 v86, s70, v22
    v_mul_f32 v87, s70, v23
    v_mul_f32 v88, s70, v24
    v_mul_f32 v89, s70, v25
    v_mul_f32 v90, s70, v26
    v_mul_f32 v91, s70, v27
    v_mul_f32 v92, s70, v28
    v_mul_f32 v93, s70, v29
    v_mul_f32 v94, s70, v30
    v_mul_f32 v95, s70, v31
    v_mul_f32 v96, v16, v32
    v_mul_f32 v97, v17, v33
    v_mul_f32 v98, v18, v34
    v_mul_f32 v99, v19, v35
    v_mul_f32 v100, v20, v36
    v_mul_f32 v101, v21, v37
    v_mul_f32 v102, v22, v38
    v_mul_f32 v103, v23, v39
    v_mul_f32 v104, v24, v40
    v_mul_f32 v105, v25, v41
    v_mul_f32 v106, v26, v42
    v_mul_f32 v107, v27, v43
    v_mul_f32 v108, v28, v44
    v_mul_f32 v109, v29, v45
    v_mul_f32 v110, v30, v46
    v_mul_f32 v111, v31, v47
    s_add_u32 s63, s63, 262144
    s_xor_b32 s64, s64, 0x8000
    v_xor_b32 v2, 0x8000, v2
    s_mov_b32 s72, s69
    s_add_u32 s69, s69, 2883584
    s_add_u32 s78, s78, 8
    s_cmp_lt_u32 s78, 64
    s_cbranch_scc1 L_f_loop
    v_exp_f32 v80, v80
    v_exp_f32 v81, v81
    v_exp_f32 v82, v82
    v_exp_f32 v83, v83
    v_exp_f32 v84, v84
    v_exp_f32 v85, v85
    v_exp_f32 v86, v86
    v_exp_f32 v87, v87
    v_exp_f32 v88, v88
    v_exp_f32 v89, v89
    v_exp_f32 v90, v90
    v_exp_f32 v91, v91
    v_exp_f32 v92, v92
    v_exp_f32 v93, v93
    v_exp_f32 v94, v94
    v_exp_f32 v95, v95
    v_add_f32 v80, 1.0, v80
    v_add_f32 v81, 1.0, v81
    v_add_f32 v82, 1.0, v82
    v_add_f32 v83, 1.0, v83
    v_add_f32 v84, 1.0, v84
    v_add_f32 v85, 1.0, v85
    v_add_f32 v86, 1.0, v86
    v_add_f32 v87, 1.0, v87
    v_add_f32 v88, 1.0, v88
    v_add_f32 v89, 1.0, v89
    v_add_f32 v90, 1.0, v90
    v_add_f32 v91, 1.0, v91
    v_add_f32 v92, 1.0, v92
    v_add_f32 v93, 1.0, v93
    v_add_f32 v94, 1.0, v94
    v_add_f32 v95, 1.0, v95
    v_rcp_f32 v80, v80
    v_rcp_f32 v81, v81
    v_rcp_f32 v82, v82
    v_rcp_f32 v83, v83
    v_rcp_f32 v84, v84
    v_rcp_f32 v85, v85
    v_rcp_f32 v86, v86
    v_rcp_f32 v87, v87
    v_rcp_f32 v88, v88
    v_rcp_f32 v89, v89
    v_rcp_f32 v90, v90
    v_rcp_f32 v91, v91
    v_rcp_f32 v92, v92
    v_rcp_f32 v93, v93
    v_rcp_f32 v94, v94
    v_rcp_f32 v95, v95
    v_mul_f32 v96, v96, v80
    v_mul_f32 v97, v97, v81
    v_mul_f32 v98, v98, v82
    v_mul_f32 v99, v99, v83
    v_mul_f32 v100, v100, v84
    v_mul_f32 v101, v101, v85
    v_mul_f32 v102, v102, v86
    v_mul_f32 v103, v103, v87
    v_mul_f32 v104, v104, v88
    v_mul_f32 v105, v105, v89
    v_mul_f32 v106, v106, v90
    v_mul_f32 v107, v107, v91
    v_mul_f32 v108, v108, v92
    v_mul_f32 v109, v109, v93
    v_mul_f32 v110, v110, v94
    v_mul_f32 v111, v111, v95
    v_cvt_pk_bf16_f32 v112, v96, v97
    v_cvt_pk_bf16_f32 v113, v98, v99
    v_cvt_pk_bf16_f32 v114, v100, v101
    v_cvt_pk_bf16_f32 v115, v102, v103
    v_cvt_pk_bf16_f32 v116, v104, v105
    v_cvt_pk_bf16_f32 v117, v106, v107
    v_cvt_pk_bf16_f32 v118, v108, v109
    v_cvt_pk_bf16_f32 v119, v110, v111
    s_add_u32 s73, s72, 180224
    buffer_store_dwordx4 v[112:115], v0, s[4:7], s72 offen sc1
    buffer_store_dwordx4 v[116:119], v0, s[4:7], s73 offen sc1
    s_mov_b32 s59, 1000000
L_wi_f:
    buffer_load_dword v3, off, s[8:11], 0 offset:200 sc1
    s_sub_u32 s59, s59, 1
    s_cbranch_scc1 L_fail
    s_waitcnt vmcnt(0)
    v_readfirstlane_b32 s84, v3
    s_nop 0
    s_cmp_eq_u32 s84, 0
    s_cbranch_scc1 L_wi_f
    s_barrier
    s_cmp_lg_u32 s3, 0
    s_cbranch_scc1 L_f_done
    v_mov_b32 v3, 1
    s_mov_b32 s73, 274432
    s_mov_b64 exec, 1
    buffer_atomic_add v3, off, s[4:7], s73
    s_mov_b64 exec, -1
L_f_done:
    v_lshrrev_b32 v0, 4, v0
L_orole:
    s_sub_u32 s60, s58, 1
    s_lshr_b32 s73, s57, 4
    s_cmp_eq_u32 s58, 7
    s_cselect_b32 s60, s73, s60
    s_cselect_b32 s80, 63, 2
    s_cselect_b32 s73, 0, 2
    s_add_u32 s60, s60, s73
    s_cmp_eq_u32 s58, 7
    s_cselect_b32 s81, 64, 63
    s_mul_i32 s82, s80, 360448
    s_lshl_b32 s83, s80, 15
    s_and_b32 s61, s57, 15
    v_and_b32 v20, 15, v0
    v_lshrrev_b32 v21, 4, v0
    v_and_b32 v22, 3, v0
    v_bfe_u32 v23, v0, 2, 2
    s_and_b32 s74, s57, 15
    v_lshrrev_b32 v24, 2, v0
    v_lshlrev_b32 v125, 10, v24
    v_lshl_add_u32 v125, v22, 4, v125
    s_lshl_b32 s73, s74, 6
    v_add_u32 v125, s73, v125
    s_lshl_b32 s73, s3, 20
    v_add_u32 v124, s73, v125
    s_mul_i32 s73, s3, 360448
    v_add_u32 v125, s73, v125
    v_lshl_add_u32 v126, v21, 2, v23
    v_lshlrev_b32 v126, 6, v126
    v_lshl_add_u32 v126, v22, 3, v126
    s_lshl_b32 s68, s3, 15
    v_add_u32 v126, s68, v126
    s_and_b32 s67, s74, 1
    s_lshl_b32 s67, s67, 19
    v_lshlrev_b32 v24, 4, v21
    s_lshl_b32 s73, s3, 8
    buffer_load_dwordx4 v[240:243], v24, s[48:51], s73 offen offset:0
    buffer_load_dwordx4 v[244:247], v24, s[48:51], s73 offen offset:64
    buffer_load_dwordx4 v[248:251], v24, s[48:51], s73 offen offset:128
    buffer_load_dwordx4 v[252:255], v24, s[48:51], s73 offen offset:192
    s_add_u32 m0, s68, 0
    s_mov_b32 s73, 0
    buffer_load_dwordx4 v125, s[44:47], s73 offen lds
    s_add_u32 m0, s68, 1024
    s_mov_b32 s73, 16384
    buffer_load_dwordx4 v125, s[44:47], s73 offen lds
    s_add_u32 m0, s68, 2048
    s_mov_b32 s73, 32768
    buffer_load_dwordx4 v125, s[44:47], s73 offen lds
    s_add_u32 m0, s68, 3072
    s_mov_b32 s73, 49152
    buffer_load_dwordx4 v125, s[44:47], s73 offen lds
    s_add_u32 m0, s68, 4096
    s_mov_b32 s73, 65536
    buffer_load_dwordx4 v125, s[44:47], s73 offen lds
    s_add_u32 m0, s68, 5120
    s_mov_b32 s73, 81920
    buffer_load_dwordx4 v125, s[44:47], s73 offen lds
    s_add_u32 m0, s68, 6144
    s_mov_b32 s73, 98304
    buffer_load_dwordx4 v125, s[44:47], s73 offen lds
    s_add_u32 m0, s68, 7168
    s_mov_b32 s73, 114688
    buffer_load_dwordx4 v125, s[44:47], s73 offen lds
    s_add_u32 m0, s68, 8192
    s_mov_b32 s73, 131072
    buffer_load_dwordx4 v125, s[44:47], s73 offen lds
    s_add_u32 m0, s68, 9216
    s_mov_b32 s73, 147456
    buffer_load_dwordx4 v125, s[44:47], s73 offen lds
    s_add_u32 m0, s68, 10240
    s_mov_b32 s73, 163840
    buffer_load_dwordx4 v125, s[44:47], s73 offen lds
    s_add_u32 m0, s68, 11264
    s_mov_b32 s73, 180224
    buffer_load_dwordx4 v125, s[44:47], s73 offen lds
    s_add_u32 m0, s68, 12288
    s_mov_b32 s73, 196608
    buffer_load_dwordx4 v125, s[44:47], s73 offen lds
    s_add_u32 m0, s68, 13312
    s_mov_b32 s73, 212992
    buffer_load_dwordx4 v125, s[44:47], s73 offen lds
    s_add_u32 m0, s68, 14336
    s_mov_b32 s73, 229376
    buffer_load_dwordx4 v125, s[44:47], s73 offen lds
    s_add_u32 m0, s68, 15360
    s_mov_b32 s73, 245760
    buffer_load_dwordx4 v125, s[44:47], s73 offen lds
    s_add_u32 m0, s68, 16384
    s_mov_b32 s73, 262144
    buffer_load_dwordx4 v125, s[44:47], s73 offen lds
    s_add_u32 m0, s68, 17408
    s_mov_b32 s73, 278528
    buffer_load_dwordx4 v125, s[44:47], s73 offen lds
    s_add_u32 m0, s68, 18432
    s_mov_b32 s73, 294912
    buffer_load_dwordx4 v125, s[44:47], s73 offen lds
    s_add_u32 m0, s68, 19456
    s_mov_b32 s73, 311296
    buffer_load_dwordx4 v125, s[44:47], s73 offen lds
    s_add_u32 m0, s68, 20480
    s_mov_b32 s73, 327680
    buffer_load_dwordx4 v125, s[44:47], s73 offen lds
    s_add_u32 m0, s68, 21504
    s_mov_b32 s73, 344064
    buffer_load_dwordx4 v125, s[44:47], s73 offen lds
    s_waitcnt vmcnt(6)
    ds_read_b64_tr_b16 v[152:153], v126 offset:0
    ds_read_b64_tr_b16 v[154:155], v126 offset:1024
    ds_read_b64_tr_b16 v[156:157], v126 offset:32
    ds_read_b64_tr_b16 v[158:159], v126 offset:1056
    ds_read_b64_tr_b16 v[160:161], v126 offset:2048
    ds_read_b64_tr_b16 v[162:163], v126 offset:3072
    ds_read_b64_tr_b16 v[164:165], v126 offset:2080
    ds_read_b64_tr_b16 v[166:167], v126 offset:3104
    ds_read_b64_tr_b16 v[168:169], v126 offset:4096
    ds_read_b64_tr_b16 v[170:171], v126 offset:5120
    ds_read_b64_tr_b16 v[172:173], v126 offset:4128
    ds_read_b64_tr_b16 v[174:175], v126 offset:5152
    ds_read_b64_tr_b16 v[176:177], v126 offset:6144
    ds_read_b64_tr_b16 v[178:179], v126 offset:7168
    ds_read_b64_tr_b16 v[180:181], v126 offset:6176
    ds_read_b64_tr_b16 v[182:183], v126 offset:7200
    ds_read_b64_tr_b16 v[184:185], v126 offset:8192
    ds_read_b64_tr_b16 v[186:187], v126 offset:9216
    ds_read_b64_tr_b16 v[188:189], v126 offset:8224
    ds_read_b64_tr_b16 v[190:191], v126 offset:9248
    ds_read_b64_tr_b16 v[192:193], v126 offset:10240
    ds_read_b64_tr_b16 v[194:195], v126 offset:11264
    ds_read_b64_tr_b16 v[196:197], v126 offset:10272
    ds_read_b64_tr_b16 v[198:199], v126 offset:11296
    ds_read_b64_tr_b16 v[200:201], v126 offset:12288
    ds_read_b64_tr_b16 v[202:203], v126 offset:13312
    ds_read_b64_tr_b16 v[204:205], v126 offset:12320
    ds_read_b64_tr_b16 v[206:207], v126 offset:13344
    ds_read_b64_tr_b16 v[208:209], v126 offset:14336
    ds_read_b64_tr_b16 v[210:211], v126 offset:15360
    ds_read_b64_tr_b16 v[212:213], v126 offset:14368
    ds_read_b64_tr_b16 v[214:215], v126 offset:15392
    s_waitcnt lgkmcnt(0)
    s_add_u32 m0, s68, 0
    s_mov_b32 s73, 0
    s_xor_b32 s73, s73, s67
    buffer_load_dwordx4 v124, s[28:31], s73 offen lds
    s_add_u32 m0, s68, 1024
    s_mov_b32 s73, 16384
    s_xor_b32 s73, s73, s67
    buffer_load_dwordx4 v124, s[28:31], s73 offen lds
    s_add_u32 m0, s68, 2048
    s_mov_b32 s73, 32768
    s_xor_b32 s73, s73, s67
    buffer_load_dwordx4 v124, s[28:31], s73 offen lds
    s_add_u32 m0, s68, 3072
    s_mov_b32 s73, 49152
    s_xor_b32 s73, s73, s67
    buffer_load_dwordx4 v124, s[28:31], s73 offen lds
    s_add_u32 m0, s68, 4096
    s_mov_b32 s73, 65536
    s_xor_b32 s73, s73, s67
    buffer_load_dwordx4 v124, s[28:31], s73 offen lds
    s_add_u32 m0, s68, 5120
    s_mov_b32 s73, 81920
    s_xor_b32 s73, s73, s67
    buffer_load_dwordx4 v124, s[28:31], s73 offen lds
    s_add_u32 m0, s68, 6144
    s_mov_b32 s73, 98304
    s_xor_b32 s73, s73, s67
    buffer_load_dwordx4 v124, s[28:31], s73 offen lds
    s_add_u32 m0, s68, 7168
    s_mov_b32 s73, 114688
    s_xor_b32 s73, s73, s67
    buffer_load_dwordx4 v124, s[28:31], s73 offen lds
    s_add_u32 m0, s68, 8192
    s_mov_b32 s73, 131072
    s_xor_b32 s73, s73, s67
    buffer_load_dwordx4 v124, s[28:31], s73 offen lds
    s_add_u32 m0, s68, 9216
    s_mov_b32 s73, 147456
    s_xor_b32 s73, s73, s67
    buffer_load_dwordx4 v124, s[28:31], s73 offen lds
    s_add_u32 m0, s68, 10240
    s_mov_b32 s73, 163840
    s_xor_b32 s73, s73, s67
    buffer_load_dwordx4 v124, s[28:31], s73 offen lds
    s_add_u32 m0, s68, 11264
    s_mov_b32 s73, 180224
    s_xor_b32 s73, s73, s67
    buffer_load_dwordx4 v124, s[28:31], s73 offen lds
    s_add_u32 m0, s68, 12288
    s_mov_b32 s73, 196608
    s_xor_b32 s73, s73, s67
    buffer_load_dwordx4 v124, s[28:31], s73 offen lds
    s_add_u32 m0, s68, 13312
    s_mov_b32 s73, 212992
    s_xor_b32 s73, s73, s67
    buffer_load_dwordx4 v124, s[28:31], s73 offen lds
    s_add_u32 m0, s68, 14336
    s_mov_b32 s73, 229376
    s_xor_b32 s73, s73, s67
    buffer_load_dwordx4 v124, s[28:31], s73 offen lds
    s_add_u32 m0, s68, 15360
    s_mov_b32 s73, 245760
    s_xor_b32 s73, s73, s67
    buffer_load_dwordx4 v124, s[28:31], s73 offen lds
    s_waitcnt vmcnt(16)
    ds_read_b64_tr_b16 v[216:217], v126 offset:16384
    ds_read_b64_tr_b16 v[218:219], v126 offset:17408
    ds_read_b64_tr_b16 v[220:221], v126 offset:16416
    ds_read_b64_tr_b16 v[222:223], v126 offset:17440
    ds_read_b64_tr_b16 v[224:225], v126 offset:18432
    ds_read_b64_tr_b16 v[226:227], v126 offset:19456
    ds_read_b64_tr_b16 v[228:229], v126 offset:18464
    ds_read_b64_tr_b16 v[230:231], v126 offset:19488
    ds_read_b64_tr_b16 v[232:233], v126 offset:20480
    ds_read_b64_tr_b16 v[234:235], v126 offset:21504
    ds_read_b64_tr_b16 v[236:237], v126 offset:20512
    ds_read_b64_tr_b16 v[238:239], v126 offset:21536
    s_waitcnt lgkmcnt(0)
    s_add_u32 m0, s68, 16384
    s_mov_b32 s73, 262144
    s_xor_b32 s73, s73, s67
    buffer_load_dwordx4 v124, s[28:31], s73 offen lds
    s_add_u32 m0, s68, 17408
    s_mov_b32 s73, 278528
    s_xor_b32 s73, s73, s67
    buffer_load_dwordx4 v124, s[28:31], s73 offen lds
    s_add_u32 m0, s68, 18432
    s_mov_b32 s73, 294912
    s_xor_b32 s73, s73, s67
    buffer_load_dwordx4 v124, s[28:31], s73 offen lds
    s_add_u32 m0, s68, 19456
    s_mov_b32 s73, 311296
    s_xor_b32 s73, s73, s67
    buffer_load_dwordx4 v124, s[28:31], s73 offen lds
    s_add_u32 m0, s68, 20480
    s_mov_b32 s73, 327680
    s_xor_b32 s73, s73, s67
    buffer_load_dwordx4 v124, s[28:31], s73 offen lds
    s_add_u32 m0, s68, 21504
    s_mov_b32 s73, 344064
    s_xor_b32 s73, s73, s67
    buffer_load_dwordx4 v124, s[28:31], s73 offen lds
    s_add_u32 m0, s68, 22528
    s_mov_b32 s73, 360448
    s_xor_b32 s73, s73, s67
    buffer_load_dwordx4 v124, s[28:31], s73 offen lds
    s_add_u32 m0, s68, 23552
    s_mov_b32 s73, 376832
    s_xor_b32 s73, s73, s67
    buffer_load_dwordx4 v124, s[28:31], s73 offen lds
    s_add_u32 m0, s68, 24576
    s_mov_b32 s73, 393216
    s_xor_b32 s73, s73, s67
    buffer_load_dwordx4 v124, s[28:31], s73 offen lds
    s_add_u32 m0, s68, 25600
    s_mov_b32 s73, 409600
    s_xor_b32 s73, s73, s67
    buffer_load_dwordx4 v124, s[28:31], s73 offen lds
    s_add_u32 m0, s68, 26624
    s_mov_b32 s73, 425984
    s_xor_b32 s73, s73, s67
    buffer_load_dwordx4 v124, s[28:31], s73 offen lds
    s_add_u32 m0, s68, 27648
    s_mov_b32 s73, 442368
    s_xor_b32 s73, s73, s67
    buffer_load_dwordx4 v124, s[28:31], s73 offen lds
    s_add_u32 m0, s68, 28672
    s_mov_b32 s73, 458752
    s_xor_b32 s73, s73, s67
    buffer_load_dwordx4 v124, s[28:31], s73 offen lds
    s_add_u32 m0, s68, 29696
    s_mov_b32 s73, 475136
    s_xor_b32 s73, s73, s67
    buffer_load_dwordx4 v124, s[28:31], s73 offen lds
    s_add_u32 m0, s68, 30720
    s_mov_b32 s73, 491520
    s_xor_b32 s73, s73, s67
    buffer_load_dwordx4 v124, s[28:31], s73 offen lds
    s_add_u32 m0, s68, 31744
    s_mov_b32 s73, 507904
    s_xor_b32 s73, s73, s67
    buffer_load_dwordx4 v124, s[28:31], s73 offen lds
    s_waitcnt vmcnt(16)
    ds_read_b64_tr_b16 a[0:1], v126 offset:0
    ds_read_b64_tr_b16 a[2:3], v126 offset:1024
    ds_read_b64_tr_b16 a[4:5], v126 offset:32
    ds_read_b64_tr_b16 a[6:7], v126 offset:1056
    ds_read_b64_tr_b16 a[8:9], v126 offset:2048
    ds_read_b64_tr_b16 a[10:11], v126 offset:3072
    ds_read_b64_tr_b16 a[12:13], v126 offset:2080
    ds_read_b64_tr_b16 a[14:15], v126 offset:3104
    ds_read_b64_tr_b16 a[16:17], v126 offset:4096
    ds_read_b64_tr_b16 a[18:19], v126 offset:5120
    ds_read_b64_tr_b16 a[20:21], v126 offset:4128
    ds_read_b64_tr_b16 a[22:23], v126 offset:5152
    ds_read_b64_tr_b16 a[24:25], v126 offset:6144
    ds_read_b64_tr_b16 a[26:27], v126 offset:7168
    ds_read_b64_tr_b16 a[28:29], v126 offset:6176
    ds_read_b64_tr_b16 a[30:31], v126 offset:7200
    ds_read_b64_tr_b16 a[32:33], v126 offset:8192
    ds_read_b64_tr_b16 a[34:35], v126 offset:9216
    ds_read_b64_tr_b16 a[36:37], v126 offset:8224
    ds_read_b64_tr_b16 a[38:39], v126 offset:9248
    ds_read_b64_tr_b16 a[40:41], v126 offset:10240
    ds_read_b64_tr_b16 a[42:43], v126 offset:11264
    ds_read_b64_tr_b16 a[44:45], v126 offset:10272
    ds_read_b64_tr_b16 a[46:47], v126 offset:11296
    ds_read_b64_tr_b16 a[48:49], v126 offset:12288
    ds_read_b64_tr_b16 a[50:51], v126 offset:13312
    ds_read_b64_tr_b16 a[52:53], v126 offset:12320
    ds_read_b64_tr_b16 a[54:55], v126 offset:13344
    ds_read_b64_tr_b16 a[56:57], v126 offset:14336
    ds_read_b64_tr_b16 a[58:59], v126 offset:15360
    ds_read_b64_tr_b16 a[60:61], v126 offset:14368
    ds_read_b64_tr_b16 a[62:63], v126 offset:15392
    s_waitcnt lgkmcnt(0)
    s_add_u32 m0, s68, 0
    s_mov_b32 s73, 524288
    s_xor_b32 s73, s73, s67
    buffer_load_dwordx4 v124, s[28:31], s73 offen lds
    s_add_u32 m0, s68, 1024
    s_mov_b32 s73, 540672
    s_xor_b32 s73, s73, s67
    buffer_load_dwordx4 v124, s[28:31], s73 offen lds
    s_add_u32 m0, s68, 2048
    s_mov_b32 s73, 557056
    s_xor_b32 s73, s73, s67
    buffer_load_dwordx4 v124, s[28:31], s73 offen lds
    s_add_u32 m0, s68, 3072
    s_mov_b32 s73, 573440
    s_xor_b32 s73, s73, s67
    buffer_load_dwordx4 v124, s[28:31], s73 offen lds
    s_add_u32 m0, s68, 4096
    s_mov_b32 s73, 589824
    s_xor_b32 s73, s73, s67
    buffer_load_dwordx4 v124, s[28:31], s73 offen lds
    s_add_u32 m0, s68, 5120
    s_mov_b32 s73, 606208
    s_xor_b32 s73, s73, s67
    buffer_load_dwordx4 v124, s[28:31], s73 offen lds
    s_add_u32 m0, s68, 6144
    s_mov_b32 s73, 622592
    s_xor_b32 s73, s73, s67
    buffer_load_dwordx4 v124, s[28:31], s73 offen lds
    s_add_u32 m0, s68, 7168
    s_mov_b32 s73, 638976
    s_xor_b32 s73, s73, s67
    buffer_load_dwordx4 v124, s[28:31], s73 offen lds
    s_add_u32 m0, s68, 8192
    s_mov_b32 s73, 655360
    s_xor_b32 s73, s73, s67
    buffer_load_dwordx4 v124, s[28:31], s73 offen lds
    s_add_u32 m0, s68, 9216
    s_mov_b32 s73, 671744
    s_xor_b32 s73, s73, s67
    buffer_load_dwordx4 v124, s[28:31], s73 offen lds
    s_add_u32 m0, s68, 10240
    s_mov_b32 s73, 688128
    s_xor_b32 s73, s73, s67
    buffer_load_dwordx4 v124, s[28:31], s73 offen lds
    s_add_u32 m0, s68, 11264
    s_mov_b32 s73, 704512
    s_xor_b32 s73, s73, s67
    buffer_load_dwordx4 v124, s[28:31], s73 offen lds
    s_add_u32 m0, s68, 12288
    s_mov_b32 s73, 720896
    s_xor_b32 s73, s73, s67
    buffer_load_dwordx4 v124, s[28:31], s73 offen lds
    s_add_u32 m0, s68, 13312
    s_mov_b32 s73, 737280
    s_xor_b32 s73, s73, s67
    buffer_load_dwordx4 v124, s[28:31], s73 offen lds
    s_add_u32 m0, s68, 14336
    s_mov_b32 s73, 753664
    s_xor_b32 s73, s73, s67
    buffer_load_dwordx4 v124, s[28:31], s73 offen lds
    s_add_u32 m0, s68, 15360
    s_mov_b32 s73, 770048
    s_xor_b32 s73, s73, s67
    buffer_load_dwordx4 v124, s[28:31], s73 offen lds
    s_waitcnt vmcnt(16)
    ds_read_b64_tr_b16 a[64:65], v126 offset:16384
    ds_read_b64_tr_b16 a[66:67], v126 offset:17408
    ds_read_b64_tr_b16 a[68:69], v126 offset:16416
    ds_read_b64_tr_b16 a[70:71], v126 offset:17440
    ds_read_b64_tr_b16 a[72:73], v126 offset:18432
    ds_read_b64_tr_b16 a[74:75], v126 offset:19456
    ds_read_b64_tr_b16 a[76:77], v126 offset:18464
    ds_read_b64_tr_b16 a[78:79], v126 offset:19488
    ds_read_b64_tr_b16 a[80:81], v126 offset:20480
    ds_read_b64_tr_b16 a[82:83], v126 offset:21504
    ds_read_b64_tr_b16 a[84:85], v126 offset:20512
    ds_read_b64_tr_b16 a[86:87], v126 offset:21536
    ds_read_b64_tr_b16 a[88:89], v126 offset:22528
    ds_read_b64_tr_b16 a[90:91], v126 offset:23552
    ds_read_b64_tr_b16 a[92:93], v126 offset:22560
    ds_read_b64_tr_b16 a[94:95], v126 offset:23584
    ds_read_b64_tr_b16 a[96:97], v126 offset:24576
    ds_read_b64_tr_b16 a[98:99], v126 offset:25600
    ds_read_b64_tr_b16 a[100:101], v126 offset:24608
    ds_read_b64_tr_b16 a[102:103], v126 offset:25632
    ds_read_b64_tr_b16 a[104:105], v126 offset:26624
    ds_read_b64_tr_b16 a[106:107], v126 offset:27648
    ds_read_b64_tr_b16 a[108:109], v126 offset:26656
    ds_read_b64_tr_b16 a[110:111], v126 offset:27680
    ds_read_b64_tr_b16 a[112:113], v126 offset:28672
    ds_read_b64_tr_b16 a[114:115], v126 offset:29696
    ds_read_b64_tr_b16 a[116:117], v126 offset:28704
    ds_read_b64_tr_b16 a[118:119], v126 offset:29728
    ds_read_b64_tr_b16 a[120:121], v126 offset:30720
    ds_read_b64_tr_b16 a[122:123], v126 offset:31744
    ds_read_b64_tr_b16 a[124:125], v126 offset:30752
    ds_read_b64_tr_b16 a[126:127], v126 offset:31776
    s_waitcnt lgkmcnt(0)
    s_add_u32 m0, s68, 16384
    s_mov_b32 s73, 786432
    s_xor_b32 s73, s73, s67
    buffer_load_dwordx4 v124, s[28:31], s73 offen lds
    s_add_u32 m0, s68, 17408
    s_mov_b32 s73, 802816
    s_xor_b32 s73, s73, s67
    buffer_load_dwordx4 v124, s[28:31], s73 offen lds
    s_add_u32 m0, s68, 18432
    s_mov_b32 s73, 819200
    s_xor_b32 s73, s73, s67
    buffer_load_dwordx4 v124, s[28:31], s73 offen lds
    s_add_u32 m0, s68, 19456
    s_mov_b32 s73, 835584
    s_xor_b32 s73, s73, s67
    buffer_load_dwordx4 v124, s[28:31], s73 offen lds
    s_add_u32 m0, s68, 20480
    s_mov_b32 s73, 851968
    s_xor_b32 s73, s73, s67
    buffer_load_dwordx4 v124, s[28:31], s73 offen lds
    s_add_u32 m0, s68, 21504
    s_mov_b32 s73, 868352
    s_xor_b32 s73, s73, s67
    buffer_load_dwordx4 v124, s[28:31], s73 offen lds
    s_add_u32 m0, s68, 22528
    s_mov_b32 s73, 884736
    s_xor_b32 s73, s73, s67
    buffer_load_dwordx4 v124, s[28:31], s73 offen lds
    s_add_u32 m0, s68, 23552
    s_mov_b32 s73, 901120
    s_xor_b32 s73, s73, s67
    buffer_load_dwordx4 v124, s[28:31], s73 offen lds
    s_add_u32 m0, s68, 24576
    s_mov_b32 s73, 917504
    s_xor_b32 s73, s73, s67
    buffer_load_dwordx4 v124, s[28:31], s73 offen lds
    s_add_u32 m0, s68, 25600
    s_mov_b32 s73, 933888
    s_xor_b32 s73, s73, s67
    buffer_load_dwordx4 v124, s[28:31], s73 offen lds
    s_add_u32 m0, s68, 26624
    s_mov_b32 s73, 950272
    s_xor_b32 s73, s73, s67
    buffer_load_dwordx4 v124, s[28:31], s73 offen lds
    s_add_u32 m0, s68, 27648
    s_mov_b32 s73, 966656
    s_xor_b32 s73, s73, s67
    buffer_load_dwordx4 v124, s[28:31], s73 offen lds
    s_add_u32 m0, s68, 28672
    s_mov_b32 s73, 983040
    s_xor_b32 s73, s73, s67
    buffer_load_dwordx4 v124, s[28:31], s73 offen lds
    s_add_u32 m0, s68, 29696
    s_mov_b32 s73, 999424
    s_xor_b32 s73, s73, s67
    buffer_load_dwordx4 v124, s[28:31], s73 offen lds
    s_add_u32 m0, s68, 30720
    s_mov_b32 s73, 1015808
    s_xor_b32 s73, s73, s67
    buffer_load_dwordx4 v124, s[28:31], s73 offen lds
    s_add_u32 m0, s68, 31744
    s_mov_b32 s73, 1032192
    s_xor_b32 s73, s73, s67
    buffer_load_dwordx4 v124, s[28:31], s73 offen lds
    s_waitcnt vmcnt(16)
    ds_read_b64_tr_b16 a[128:129], v126 offset:0
    ds_read_b64_tr_b16 a[130:131], v126 offset:1024
    ds_read_b64_tr_b16 a[132:133], v126 offset:32
    ds_read_b64_tr_b16 a[134:135], v126 offset:1056
    ds_read_b64_tr_b16 a[136:137], v126 offset:2048
    ds_read_b64_tr_b16 a[138:139], v126 offset:3072
    ds_read_b64_tr_b16 a[140:141], v126 offset:2080
    ds_read_b64_tr_b16 a[142:143], v126 offset:3104
    ds_read_b64_tr_b16 a[144:145], v126 offset:4096
    ds_read_b64_tr_b16 a[146:147], v126 offset:5120
    ds_read_b64_tr_b16 a[148:149], v126 offset:4128
    ds_read_b64_tr_b16 a[150:151], v126 offset:5152
    ds_read_b64_tr_b16 a[152:153], v126 offset:6144
    ds_read_b64_tr_b16 a[154:155], v126 offset:7168
    ds_read_b64_tr_b16 a[156:157], v126 offset:6176
    ds_read_b64_tr_b16 a[158:159], v126 offset:7200
    ds_read_b64_tr_b16 a[160:161], v126 offset:8192
    ds_read_b64_tr_b16 a[162:163], v126 offset:9216
    ds_read_b64_tr_b16 a[164:165], v126 offset:8224
    ds_read_b64_tr_b16 a[166:167], v126 offset:9248
    ds_read_b64_tr_b16 a[168:169], v126 offset:10240
    ds_read_b64_tr_b16 a[170:171], v126 offset:11264
    ds_read_b64_tr_b16 a[172:173], v126 offset:10272
    ds_read_b64_tr_b16 a[174:175], v126 offset:11296
    ds_read_b64_tr_b16 a[176:177], v126 offset:12288
    ds_read_b64_tr_b16 a[178:179], v126 offset:13312
    ds_read_b64_tr_b16 a[180:181], v126 offset:12320
    ds_read_b64_tr_b16 a[182:183], v126 offset:13344
    ds_read_b64_tr_b16 a[184:185], v126 offset:14336
    ds_read_b64_tr_b16 a[186:187], v126 offset:15360
    ds_read_b64_tr_b16 a[188:189], v126 offset:14368
    ds_read_b64_tr_b16 a[190:191], v126 offset:15392
    s_waitcnt lgkmcnt(0)
    s_waitcnt vmcnt(0)
    ds_read_b64_tr_b16 a[192:193], v126 offset:16384
    ds_read_b64_tr_b16 a[194:195], v126 offset:17408
    ds_read_b64_tr_b16 a[196:197], v126 offset:16416
    ds_read_b64_tr_b16 a[198:199], v126 offset:17440
    ds_read_b64_tr_b16 a[200:201], v126 offset:18432
    ds_read_b64_tr_b16 a[202:203], v126 offset:19456
    ds_read_b64_tr_b16 a[204:205], v126 offset:18464
    ds_read_b64_tr_b16 a[206:207], v126 offset:19488
    ds_read_b64_tr_b16 a[208:209], v126 offset:20480
    ds_read_b64_tr_b16 a[210:211], v126 offset:21504
    ds_read_b64_tr_b16 a[212:213], v126 offset:20512
    ds_read_b64_tr_b16 a[214:215], v126 offset:21536
    ds_read_b64_tr_b16 a[216:217], v126 offset:22528
    ds_read_b64_tr_b16 a[218:219], v126 offset:23552
    ds_read_b64_tr_b16 a[220:221], v126 offset:22560
    ds_read_b64_tr_b16 a[222:223], v126 offset:23584
    ds_read_b64_tr_b16 a[224:225], v126 offset:24576
    ds_read_b64_tr_b16 a[226:227], v126 offset:25600
    ds_read_b64_tr_b16 a[228:229], v126 offset:24608
    ds_read_b64_tr_b16 a[230:231], v126 offset:25632
    ds_read_b64_tr_b16 a[232:233], v126 offset:26624
    ds_read_b64_tr_b16 a[234:235], v126 offset:27648
    ds_read_b64_tr_b16 a[236:237], v126 offset:26656
    ds_read_b64_tr_b16 a[238:239], v126 offset:27680
    ds_read_b64_tr_b16 a[240:241], v126 offset:28672
    ds_read_b64_tr_b16 a[242:243], v126 offset:29696
    ds_read_b64_tr_b16 a[244:245], v126 offset:28704
    ds_read_b64_tr_b16 a[246:247], v126 offset:29728
    ds_read_b64_tr_b16 a[248:249], v126 offset:30720
    ds_read_b64_tr_b16 a[250:251], v126 offset:31744
    ds_read_b64_tr_b16 a[252:253], v126 offset:30752
    ds_read_b64_tr_b16 a[254:255], v126 offset:31776
    s_waitcnt lgkmcnt(0)
    s_barrier
    v_lshlrev_b32 v1, 10, v20
    v_lshl_add_u32 v1, v21, 4, v1
    s_lshl_b32 s73, s3, 8
    v_add_u32 v1, s73, v1
    v_and_b32 v2, 31, v0
    v_lshlrev_b32 v2, 6, v2
    s_lshl_b32 s73, s3, 2
    v_add_u32 v24, s73, v21
    v_lshlrev_b32 v5, 4, v24
    v_bfe_u32 v25, v20, 1, 2
    v_lshl_add_u32 v4, v25, 8, v5
    v_lshrrev_b32 v25, 3, v20
    v_lshl_add_u32 v4, v25, 10, v4
    v_and_b32 v25, 1, v20
    v_lshl_add_u32 v4, v25, 3, v4
    v_lshlrev_b32 v6, 10, v24
    v_lshl_add_u32 v6, v20, 2, v6
    s_lshl_b32 s73, s61, 6
    v_add_u32 v6, s73, v6
    v_lshlrev_b32 v0, 4, v0
    s_mul_i32 s73, s3, 5120
    v_add_u32 v3, s73, v0
    s_cmp_eq_u32 s3, 3
    s_cselect_b32 s73, 0x40000000, 0
    v_add_u32 v9, s73, v0
    s_lshr_b32 s62, s60, 1
    s_mul_i32 s63, s60, 180224
    s_add_u32 s63, s63, 52428800
    s_mul_i32 s73, s3, 11264
    s_add_u32 s64, s63, s73
    s_add_u32 s64, s64, 131072
    s_lshl_b32 s73, s3, 15
    s_add_u32 s63, s63, s73
    s_lshl_b32 s65, s60, 14
    s_mov_b32 s70, 0xbfb8aa3b
    s_mov_b32 s59, 1000000
L_wi_o:
    buffer_load_dword v7, off, s[8:11], 0 offset:200 sc1
    s_sub_u32 s59, s59, 1
    s_cbranch_scc1 L_fail
    s_waitcnt vmcnt(0)
    v_readfirstlane_b32 s84, v7
    s_nop 0
    s_cmp_eq_u32 s84, 0
    s_cbranch_scc1 L_wi_o
    s_mov_b32 s77, 274432
    s_mov_b32 s75, 87
    s_mov_b32 s59, 1000000
    s_mov_b32 exec_lo, 0x1
    s_mov_b32 exec_hi, 0
L_o_h:
    buffer_load_dword v7, v2, s[4:7], s77 offen sc1
    s_sub_u32 s59, s59, 1
    s_cbranch_scc1 L_fail
    s_waitcnt vmcnt(0)
L_o_hc:
    v_cmp_ge_u32 vcc, s75, v7
    s_cbranch_vccz L_o_hok
    s_sleep 16
    s_branch L_o_h
L_o_hok:
    s_mov_b64 exec, -1
    s_lshl_b32 s72, s62, 6
    s_add_u32 s72, s72, 270336
    s_cmp_ge_u32 s62, s81
    s_cselect_b32 s72, 0x70000000, s72
    s_mov_b32 s76, 0
    buffer_load_dword v7, off, s[4:7], s72 sc1
    buffer_load_dwordx4 v[92:95], v1, s[12:15], s65 offen offset:0
    buffer_load_dwordx4 v[96:99], v1, s[12:15], s65 offen offset:64
    buffer_load_dwordx4 v[100:103], v1, s[12:15], s65 offen offset:128
    buffer_load_dwordx4 v[104:107], v1, s[12:15], s65 offen offset:192
    buffer_load_dwordx4 v[108:111], v0, s[4:7], s64 offen offset:0 sc1
    buffer_load_dwordx4 v[112:115], v0, s[4:7], s64 offen offset:1024 sc1
    buffer_load_dwordx4 v[116:119], v0, s[4:7], s64 offen offset:2048 sc1
    buffer_load_dwordx4 v[120:123], v0, s[4:7], s64 offen offset:3072 sc1
    s_add_u32 s73, s64, 4096
    buffer_load_dwordx4 v[124:127], v0, s[4:7], s73 offen offset:0 sc1
    buffer_load_dwordx4 v[128:131], v0, s[4:7], s73 offen offset:1024 sc1
    buffer_load_dwordx4 v[132:135], v0, s[4:7], s73 offen offset:2048 sc1
    buffer_load_dwordx4 v[136:139], v0, s[4:7], s73 offen offset:3072 sc1
    s_add_u32 s73, s64, 8192
    buffer_load_dwordx4 v[140:143], v0, s[4:7], s73 offen offset:0 sc1
    buffer_load_dwordx4 v[144:147], v0, s[4:7], s73 offen offset:1024 sc1
    buffer_load_dwordx4 v[148:151], v9, s[4:7], s73 offen offset:2048 sc1
    s_lshr_b32 s67, s67, 5
    s_xor_b32 s69, s67, 0x4000
    s_add_u32 s69, s69, s63
    s_add_u32 s63, s63, s67
    s_mov_b32 s79, 0
    v_mov_b32 v11, 0x10000
    v_mov_b32 v10, -1
    ds_write_b32 v11, v10
    s_waitcnt vmcnt(0) lgkmcnt(0)
    s_barrier
L_o_task:
    s_cmp_lg_u32 s62, 63
    s_cbranch_scc1 L_o_near
    s_mov_b32 s80, 1
    s_mov_b32 s82, 360448
    s_mov_b32 s83, 32768
    s_cmp_lg_u32 s3, 0
    s_cbranch_scc1 L_o_nb
    s_mov_b32 s77, 274112
    s_mov_b32 s75, 0
    s_mov_b32 s59, 1000000
    s_mov_b32 exec_lo, 0x1
    s_mov_b32 exec_hi, 0
L_o_n:
    buffer_load_dword v7, v2, s[4:7], s77 offen sc1
    s_sub_u32 s59, s59, 1
    s_cbranch_scc1 L_fail
    s_waitcnt vmcnt(0)
L_o_nc:
    v_cmp_ge_u32 vcc, s75, v7
    s_cbranch_vccz L_o_nok
    s_sleep 40
    s_branch L_o_n
L_o_nok:
    s_mov_b64 exec, -1
L_o_nb:
    s_barrier
L_o_near:
    s_cmp_eq_u32 s79, 1
    s_cbranch_scc1 L_o_rdy
    s_waitcnt vmcnt(1)
    v_mfma_f32_16x16x32_bf16 v[28:31], v[240:243], v[92:95], 0
    v_mfma_f32_16x16x32_bf16 v[28:31], v[244:247], v[96:99], v[28:31]
    v_mfma_f32_16x16x32_bf16 v[28:31], v[248:251], v[100:103], v[28:31]
    v_mfma_f32_16x16x32_bf16 v[28:31], v[252:255], v[104:107], v[28:31]
    v_mfma_f32_16x16x32_bf16 v[20:23], v[152:155], v[108:111], 0
    v_mfma_f32_16x16x32_bf16 v[24:27], v[156:159], v[108:111], 0
    v_mfma_f32_16x16x32_bf16 v[20:23], v[160:163], v[112:115], v[20:23]
    v_mfma_f32_16x16x32_bf16 v[24:27], v[164:167], v[112:115], v[24:27]
    v_mfma_f32_16x16x32_bf16 v[20:23], v[168:171], v[116:119], v[20:23]
    v_mfma_f32_16x16x32_bf16 v[24:27], v[172:175], v[116:119], v[24:27]
    v_mfma_f32_16x16x32_bf16 v[20:23], v[176:179], v[120:123], v[20:23]
    v_mfma_f32_16x16x32_bf16 v[24:27], v[180:183], v[120:123], v[24:27]
    v_mfma_f32_16x16x32_bf16 v[20:23], v[184:187], v[124:127], v[20:23]
    v_mfma_f32_16x16x32_bf16 v[24:27], v[188:191], v[124:127], v[24:27]
    v_mfma_f32_16x16x32_bf16 v[20:23], v[192:195], v[128:131], v[20:23]
    v_mfma_f32_16x16x32_bf16 v[24:27], v[196:199], v[128:131], v[24:27]
    v_mfma_f32_16x16x32_bf16 v[20:23], v[200:203], v[132:135], v[20:23]
    v_mfma_f32_16x16x32_bf16 v[24:27], v[204:207], v[132:135], v[24:27]
    v_mfma_f32_16x16x32_bf16 v[20:23], v[208:211], v[136:139], v[20:23]
    v_mfma_f32_16x16x32_bf16 v[24:27], v[212:215], v[136:139], v[24:27]
    v_mfma_f32_16x16x32_bf16 v[20:23], v[216:219], v[140:143], v[20:23]
    v_mfma_f32_16x16x32_bf16 v[24:27], v[220:223], v[140:143], v[24:27]
    v_mfma_f32_16x16x32_bf16 v[20:23], v[224:227], v[144:147], v[20:23]
    v_mfma_f32_16x16x32_bf16 v[24:27], v[228:231], v[144:147], v[24:27]
    v_mfma_f32_16x16x32_bf16 v[20:23], v[232:235], v[148:151], v[20:23]
    v_mfma_f32_16x16x32_bf16 v[24:27], v[236:239], v[148:151], v[24:27]
    s_cmp_lg_u32 s3, 0
    s_cbranch_scc1 L_o_lw
    s_mov_b32 s59, 1000000
    s_mov_b32 exec_lo, 0x1
    s_mov_b32 exec_hi, 0
L_o_o:
    buffer_load_dword v7, v2, s[4:7], s72 offen sc1
    s_sub_u32 s59, s59, 1
    s_cbranch_scc1 L_fail
    s_waitcnt vmcnt(0)
L_o_oc:
    v_cmp_ge_u32 vcc, s76, v7
    s_cbranch_vccz L_o_ook
    s_sleep 3
    s_branch L_o_o
L_o_ook:
    s_mov_b64 exec, -1
    v_mov_b32 v7, s62
    ds_write_b32 v11, v7
    s_branch L_o_lwok
L_o_lw:
    s_mov_b32 s59, 4000000
L_o_lw1:
    s_sleep 1
    ds_read_b32 v7, v11
    s_sub_u32 s59, s59, 1
    s_cbranch_scc1 L_fail
    s_waitcnt lgkmcnt(0)
    v_readfirstlane_b32 s73, v7
    s_nop 0
    s_cmp_ge_i32 s73, s62
    s_cbranch_scc0 L_o_lw1
L_o_lwok:
    s_add_u32 s74, s63, 0
    buffer_load_dwordx4 v[32:35], v0, s[4:7], s74 offen offset:0 sc1
    buffer_load_dwordx4 v[36:39], v0, s[4:7], s74 offen offset:1024 sc1
    buffer_load_dwordx4 v[40:43], v0, s[4:7], s74 offen offset:2048 sc1
    buffer_load_dwordx4 v[44:47], v0, s[4:7], s74 offen offset:3072 sc1
    s_add_u32 s74, s63, 4096
    buffer_load_dwordx4 v[48:51], v0, s[4:7], s74 offen offset:0 sc1
    buffer_load_dwordx4 v[52:55], v0, s[4:7], s74 offen offset:1024 sc1
    buffer_load_dwordx4 v[56:59], v0, s[4:7], s74 offen offset:2048 sc1
    buffer_load_dwordx4 v[60:63], v0, s[4:7], s74 offen offset:3072 sc1
    s_add_u32 s74, s63, 8192
    buffer_load_dwordx4 v[64:67], v0, s[4:7], s74 offen offset:0 sc1
    buffer_load_dwordx4 v[68:71], v0, s[4:7], s74 offen offset:1024 sc1
    buffer_load_dwordx4 v[72:75], v0, s[4:7], s74 offen offset:2048 sc1
    buffer_load_dwordx4 v[76:79], v0, s[4:7], s74 offen offset:3072 sc1
    s_add_u32 s74, s63, 12288
    buffer_load_dwordx4 v[80:83], v0, s[4:7], s74 offen offset:0 sc1
    buffer_load_dwordx4 v[84:87], v0, s[4:7], s74 offen offset:1024 sc1
    buffer_load_dwordx4 v[88:91], v0, s[4:7], s74 offen offset:2048 sc1
    s_branch L_o_go
L_o_rdy:
    s_waitcnt vmcnt(16)
    v_mfma_f32_16x16x32_bf16 v[28:31], v[240:243], v[92:95], 0
    v_mfma_f32_16x16x32_bf16 v[28:31], v[244:247], v[96:99], v[28:31]
    v_mfma_f32_16x16x32_bf16 v[28:31], v[248:251], v[100:103], v[28:31]
    v_mfma_f32_16x16x32_bf16 v[28:31], v[252:255], v[104:107], v[28:31]
    v_mfma_f32_16x16x32_bf16 v[20:23], v[152:155], v[108:111], 0
    v_mfma_f32_16x16x32_bf16 v[24:27], v[156:159], v[108:111], 0
    v_mfma_f32_16x16x32_bf16 v[20:23], v[160:163], v[112:115], v[20:23]
    v_mfma_f32_16x16x32_bf16 v[24:27], v[164:167], v[112:115], v[24:27]
    v_mfma_f32_16x16x32_bf16 v[20:23], v[168:171], v[116:119], v[20:23]
    v_mfma_f32_16x16x32_bf16 v[24:27], v[172:175], v[116:119], v[24:27]
    v_mfma_f32_16x16x32_bf16 v[20:23], v[176:179], v[120:123], v[20:23]
    v_mfma_f32_16x16x32_bf16 v[24:27], v[180:183], v[120:123], v[24:27]
    v_mfma_f32_16x16x32_bf16 v[20:23], v[184:187], v[124:127], v[20:23]
    v_mfma_f32_16x16x32_bf16 v[24:27], v[188:191], v[124:127], v[24:27]
    v_mfma_f32_16x16x32_bf16 v[20:23], v[192:195], v[128:131], v[20:23]
    v_mfma_f32_16x16x32_bf16 v[24:27], v[196:199], v[128:131], v[24:27]
    v_mfma_f32_16x16x32_bf16 v[20:23], v[200:203], v[132:135], v[20:23]
    v_mfma_f32_16x16x32_bf16 v[24:27], v[204:207], v[132:135], v[24:27]
    v_mfma_f32_16x16x32_bf16 v[20:23], v[208:211], v[136:139], v[20:23]
    v_mfma_f32_16x16x32_bf16 v[24:27], v[212:215], v[136:139], v[24:27]
    v_mfma_f32_16x16x32_bf16 v[20:23], v[216:219], v[140:143], v[20:23]
    v_mfma_f32_16x16x32_bf16 v[24:27], v[220:223], v[140:143], v[24:27]
    v_mfma_f32_16x16x32_bf16 v[20:23], v[224:227], v[144:147], v[20:23]
    v_mfma_f32_16x16x32_bf16 v[24:27], v[228:231], v[144:147], v[24:27]
    v_mfma_f32_16x16x32_bf16 v[20:23], v[232:235], v[148:151], v[20:23]
    v_mfma_f32_16x16x32_bf16 v[24:27], v[236:239], v[148:151], v[24:27]
L_o_go:
    s_mov_b32 s66, s65
    s_add_u32 s62, s62, s80
    s_add_u32 s64, s64, s82
    s_add_u32 s65, s65, s83
    s_cmp_ge_u32 s62, s81
    s_cbranch_scc1 L_o_nopf
    s_waitcnt vmcnt(14)
    v_mfma_f32_16x16x32_bf16 v[12:15], a[0:3], v[32:35], 0
    v_mfma_f32_16x16x32_bf16 v[16:19], a[4:7], v[32:35], 0
    s_add_u32 s74, s63, 12288
    buffer_load_dwordx4 v[32:35], v0, s[4:7], s74 offen offset:3072 sc1
    s_waitcnt vmcnt(14)
    v_mfma_f32_16x16x32_bf16 v[12:15], a[8:11], v[36:39], v[12:15]
    v_mfma_f32_16x16x32_bf16 v[16:19], a[12:15], v[36:39], v[16:19]
    s_add_u32 s74, s69, 0
    buffer_load_dwordx4 v[36:39], v0, s[4:7], s74 offen offset:0 sc1
    s_waitcnt vmcnt(14)
    v_mfma_f32_16x16x32_bf16 v[12:15], a[16:19], v[40:43], v[12:15]
    v_mfma_f32_16x16x32_bf16 v[16:19], a[20:23], v[40:43], v[16:19]
    buffer_load_dwordx4 v[40:43], v0, s[4:7], s74 offen offset:1024 sc1
    s_waitcnt vmcnt(14)
    v_mfma_f32_16x16x32_bf16 v[12:15], a[24:27], v[44:47], v[12:15]
    v_mfma_f32_16x16x32_bf16 v[16:19], a[28:31], v[44:47], v[16:19]
    buffer_load_dwordx4 v[44:47], v0, s[4:7], s74 offen offset:2048 sc1
    s_waitcnt vmcnt(14)
    v_mfma_f32_16x16x32_bf16 v[12:15], a[32:35], v[48:51], v[12:15]
    v_mfma_f32_16x16x32_bf16 v[16:19], a[36:39], v[48:51], v[16:19]
    buffer_load_dwordx4 v[48:51], v0, s[4:7], s74 offen offset:3072 sc1
    s_waitcnt vmcnt(14)
    v_mfma_f32_16x16x32_bf16 v[12:15], a[40:43], v[52:55], v[12:15]
    v_mfma_f32_16x16x32_bf16 v[16:19], a[44:47], v[52:55], v[16:19]
    s_add_u32 s74, s69, 4096
    buffer_load_dwordx4 v[52:55], v0, s[4:7], s74 offen offset:0 sc1
    s_waitcnt vmcnt(14)
    v_mfma_f32_16x16x32_bf16 v[12:15], a[48:51], v[56:59], v[12:15]
    v_mfma_f32_16x16x32_bf16 v[16:19], a[52:55], v[56:59], v[16:19]
    buffer_load_dwordx4 v[56:59], v0, s[4:7], s74 offen offset:1024 sc1
    s_waitcnt vmcnt(14)
    v_mfma_f32_16x16x32_bf16 v[12:15], a[56:59], v[60:63], v[12:15]
    v_mfma_f32_16x16x32_bf16 v[16:19], a[60:63], v[60:63], v[16:19]
    buffer_load_dwordx4 v[60:63], v0, s[4:7], s74 offen offset:2048 sc1
    s_waitcnt vmcnt(14)
    v_mfma_f32_16x16x32_bf16 v[12:15], a[64:67], v[64:67], v[12:15]
    v_mfma_f32_16x16x32_bf16 v[16:19], a[68:71], v[64:67], v[16:19]
    buffer_load_dwordx4 v[64:67], v0, s[4:7], s74 offen offset:3072 sc1
    s_waitcnt vmcnt(14)
    v_mfma_f32_16x16x32_bf16 v[12:15], a[72:75], v[68:71], v[12:15]
    v_mfma_f32_16x16x32_bf16 v[16:19], a[76:79], v[68:71], v[16:19]
    s_add_u32 s74, s69, 8192
    buffer_load_dwordx4 v[68:71], v0, s[4:7], s74 offen offset:0 sc1
    s_waitcnt vmcnt(14)
    v_mfma_f32_16x16x32_bf16 v[12:15], a[80:83], v[72:75], v[12:15]
    v_mfma_f32_16x16x32_bf16 v[16:19], a[84:87], v[72:75], v[16:19]
    buffer_load_dwordx4 v[72:75], v0, s[4:7], s74 offen offset:1024 sc1
    s_waitcnt vmcnt(14)
    v_mfma_f32_16x16x32_bf16 v[12:15], a[88:91], v[76:79], v[12:15]
    v_mfma_f32_16x16x32_bf16 v[16:19], a[92:95], v[76:79], v[16:19]
    buffer_load_dwordx4 v[76:79], v0, s[4:7], s74 offen offset:2048 sc1
    s_waitcnt vmcnt(14)
    v_mfma_f32_16x16x32_bf16 v[12:15], a[96:99], v[80:83], v[12:15]
    v_mfma_f32_16x16x32_bf16 v[16:19], a[100:103], v[80:83], v[16:19]
    buffer_load_dwordx4 v[80:83], v0, s[4:7], s74 offen offset:3072 sc1
    s_waitcnt vmcnt(14)
    v_mfma_f32_16x16x32_bf16 v[12:15], a[104:107], v[84:87], v[12:15]
    v_mfma_f32_16x16x32_bf16 v[16:19], a[108:111], v[84:87], v[16:19]
    s_add_u32 s74, s69, 12288
    buffer_load_dwordx4 v[84:87], v0, s[4:7], s74 offen offset:0 sc1
    s_waitcnt vmcnt(14)
    v_mfma_f32_16x16x32_bf16 v[12:15], a[112:115], v[88:91], v[12:15]
    v_mfma_f32_16x16x32_bf16 v[16:19], a[116:119], v[88:91], v[16:19]
    buffer_load_dwordx4 v[88:91], v0, s[4:7], s74 offen offset:1024 sc1
    s_waitcnt vmcnt(14)
    v_mfma_f32_16x16x32_bf16 v[12:15], a[120:123], v[32:35], v[12:15]
    v_mfma_f32_16x16x32_bf16 v[16:19], a[124:127], v[32:35], v[16:19]
    buffer_load_dwordx4 v[32:35], v0, s[4:7], s74 offen offset:2048 sc1
    s_waitcnt vmcnt(14)
    v_mfma_f32_16x16x32_bf16 v[12:15], a[128:131], v[36:39], v[12:15]
    v_mfma_f32_16x16x32_bf16 v[16:19], a[132:135], v[36:39], v[16:19]
    buffer_load_dwordx4 v[36:39], v0, s[4:7], s74 offen offset:3072 sc1
    s_lshl_b32 s72, s62, 6
    s_add_u32 s72, s72, 270336
    s_cmp_ge_u32 s62, s81
    s_cselect_b32 s72, 0x70000000, s72
    s_mov_b32 s76, 0
    buffer_load_dword v7, off, s[4:7], s72 sc1
    buffer_load_dwordx4 v[92:95], v1, s[12:15], s65 offen offset:0
    buffer_load_dwordx4 v[96:99], v1, s[12:15], s65 offen offset:64
    buffer_load_dwordx4 v[100:103], v1, s[12:15], s65 offen offset:128
    buffer_load_dwordx4 v[104:107], v1, s[12:15], s65 offen offset:192
    buffer_load_dwordx4 v[108:111], v0, s[4:7], s64 offen offset:0 sc1
    buffer_load_dwordx4 v[112:115], v0, s[4:7], s64 offen offset:1024 sc1
    buffer_load_dwordx4 v[116:119], v0, s[4:7], s64 offen offset:2048 sc1
    buffer_load_dwordx4 v[120:123], v0, s[4:7], s64 offen offset:3072 sc1
    s_add_u32 s73, s64, 4096
    buffer_load_dwordx4 v[124:127], v0, s[4:7], s73 offen offset:0 sc1
    buffer_load_dwordx4 v[128:131], v0, s[4:7], s73 offen offset:1024 sc1
    buffer_load_dwordx4 v[132:135], v0, s[4:7], s73 offen offset:2048 sc1
    buffer_load_dwordx4 v[136:139], v0, s[4:7], s73 offen offset:3072 sc1
    s_add_u32 s73, s64, 8192
    buffer_load_dwordx4 v[140:143], v0, s[4:7], s73 offen offset:0 sc1
    buffer_load_dwordx4 v[144:147], v0, s[4:7], s73 offen offset:1024 sc1
    buffer_load_dwordx4 v[148:151], v9, s[4:7], s73 offen offset:2048 sc1
    s_waitcnt vmcnt(30)
    v_mfma_f32_16x16x32_bf16 v[12:15], a[136:139], v[40:43], v[12:15]
    v_mfma_f32_16x16x32_bf16 v[16:19], a[140:143], v[40:43], v[16:19]
    s_waitcnt vmcnt(29)
    v_mfma_f32_16x16x32_bf16 v[12:15], a[144:147], v[44:47], v[12:15]
    v_mfma_f32_16x16x32_bf16 v[16:19], a[148:151], v[44:47], v[16:19]
    s_waitcnt vmcnt(28)
    v_mfma_f32_16x16x32_bf16 v[12:15], a[152:155], v[48:51], v[12:15]
    v_mfma_f32_16x16x32_bf16 v[16:19], a[156:159], v[48:51], v[16:19]
    s_waitcnt vmcnt(27)
    v_mfma_f32_16x16x32_bf16 v[12:15], a[160:163], v[52:55], v[12:15]
    v_mfma_f32_16x16x32_bf16 v[16:19], a[164:167], v[52:55], v[16:19]
    s_waitcnt vmcnt(26)
    v_mfma_f32_16x16x32_bf16 v[12:15], a[168:171], v[56:59], v[12:15]
    v_mfma_f32_16x16x32_bf16 v[16:19], a[172:175], v[56:59], v[16:19]
    s_waitcnt vmcnt(25)
    v_mfma_f32_16x16x32_bf16 v[12:15], a[176:179], v[60:63], v[12:15]
    v_mfma_f32_16x16x32_bf16 v[16:19], a[180:183], v[60:63], v[16:19]
    s_waitcnt vmcnt(24)
    v_mfma_f32_16x16x32_bf16 v[12:15], a[184:187], v[64:67], v[12:15]
    v_mfma_f32_16x16x32_bf16 v[16:19], a[188:191], v[64:67], v[16:19]
    s_waitcnt vmcnt(23)
    v_mfma_f32_16x16x32_bf16 v[12:15], a[192:195], v[68:71], v[12:15]
    v_mfma_f32_16x16x32_bf16 v[16:19], a[196:199], v[68:71], v[16:19]
    s_waitcnt vmcnt(22)
    v_mfma_f32_16x16x32_bf16 v[12:15], a[200:203], v[72:75], v[12:15]
    v_mfma_f32_16x16x32_bf16 v[16:19], a[204:207], v[72:75], v[16:19]
    s_waitcnt vmcnt(21)
    v_mfma_f32_16x16x32_bf16 v[12:15], a[208:211], v[76:79], v[12:15]
    v_mfma_f32_16x16x32_bf16 v[16:19], a[212:215], v[76:79], v[16:19]
    s_waitcnt vmcnt(20)
    v_mfma_f32_16x16x32_bf16 v[12:15], a[216:219], v[80:83], v[12:15]
    v_mfma_f32_16x16x32_bf16 v[16:19], a[220:223], v[80:83], v[16:19]
    s_waitcnt vmcnt(19)
    v_mfma_f32_16x16x32_bf16 v[12:15], a[224:227], v[84:87], v[12:15]
    v_mfma_f32_16x16x32_bf16 v[16:19], a[228:231], v[84:87], v[16:19]
    s_waitcnt vmcnt(18)
    v_mfma_f32_16x16x32_bf16 v[12:15], a[232:235], v[88:91], v[12:15]
    v_mfma_f32_16x16x32_bf16 v[16:19], a[236:239], v[88:91], v[16:19]
    s_waitcnt vmcnt(17)
    v_mfma_f32_16x16x32_bf16 v[12:15], a[240:243], v[32:35], v[12:15]
    v_mfma_f32_16x16x32_bf16 v[16:19], a[244:247], v[32:35], v[16:19]
    s_waitcnt vmcnt(16)
    v_mfma_f32_16x16x32_bf16 v[12:15], a[248:251], v[36:39], v[12:15]
    v_mfma_f32_16x16x32_bf16 v[16:19], a[252:255], v[36:39], v[16:19]
    s_branch L_o_fin
L_o_nopf:
    s_waitcnt vmcnt(14)
    v_mfma_f32_16x16x32_bf16 v[12:15], a[0:3], v[32:35], 0
    v_mfma_f32_16x16x32_bf16 v[16:19], a[4:7], v[32:35], 0
    s_add_u32 s74, s63, 12288
    buffer_load_dwordx4 v[32:35], v0, s[4:7], s74 offen offset:3072 sc1
    s_waitcnt vmcnt(14)
    v_mfma_f32_16x16x32_bf16 v[12:15], a[8:11], v[36:39], v[12:15]
    v_mfma_f32_16x16x32_bf16 v[16:19], a[12:15], v[36:39], v[16:19]
    s_add_u32 s74, s69, 0
    buffer_load_dwordx4 v[36:39], v0, s[4:7], s74 offen offset:0 sc1
    s_waitcnt vmcnt(14)
    v_mfma_f32_16x16x32_bf16 v[12:15], a[16:19], v[40:43], v[12:15]
    v_mfma_f32_16x16x32_bf16 v[16:19], a[20:23], v[40:43], v[16:19]
    buffer_load_dwordx4 v[40:43], v0, s[4:7], s74 offen offset:1024 sc1
    s_waitcnt vmcnt(14)
    v_mfma_f32_16x16x32_bf16 v[12:15], a[24:27], v[44:47], v[12:15]
    v_mfma_f32_16x16x32_bf16 v[16:19], a[28:31], v[44:47], v[16:19]
    buffer_load_dwordx4 v[44:47], v0, s[4:7], s74 offen offset:2048 sc1
    s_waitcnt vmcnt(14)
    v_mfma_f32_16x16x32_bf16 v[12:15], a[32:35], v[48:51], v[12:15]
    v_mfma_f32_16x16x32_bf16 v[16:19], a[36:39], v[48:51], v[16:19]
    buffer_load_dwordx4 v[48:51], v0, s[4:7], s74 offen offset:3072 sc1
    s_waitcnt vmcnt(14)
    v_mfma_f32_16x16x32_bf16 v[12:15], a[40:43], v[52:55], v[12:15]
    v_mfma_f32_16x16x32_bf16 v[16:19], a[44:47], v[52:55], v[16:19]
    s_add_u32 s74, s69, 4096
    buffer_load_dwordx4 v[52:55], v0, s[4:7], s74 offen offset:0 sc1
    s_waitcnt vmcnt(14)
    v_mfma_f32_16x16x32_bf16 v[12:15], a[48:51], v[56:59], v[12:15]
    v_mfma_f32_16x16x32_bf16 v[16:19], a[52:55], v[56:59], v[16:19]
    buffer_load_dwordx4 v[56:59], v0, s[4:7], s74 offen offset:1024 sc1
    s_waitcnt vmcnt(14)
    v_mfma_f32_16x16x32_bf16 v[12:15], a[56:59], v[60:63], v[12:15]
    v_mfma_f32_16x16x32_bf16 v[16:19], a[60:63], v[60:63], v[16:19]
    buffer_load_dwordx4 v[60:63], v0, s[4:7], s74 offen offset:2048 sc1
    s_waitcnt vmcnt(14)
    v_mfma_f32_16x16x32_bf16 v[12:15], a[64:67], v[64:67], v[12:15]
    v_mfma_f32_16x16x32_bf16 v[16:19], a[68:71], v[64:67], v[16:19]
    buffer_load_dwordx4 v[64:67], v0, s[4:7], s74 offen offset:3072 sc1
    s_waitcnt vmcnt(14)
    v_mfma_f32_16x16x32_bf16 v[12:15], a[72:75], v[68:71], v[12:15]
    v_mfma_f32_16x16x32_bf16 v[16:19], a[76:79], v[68:71], v[16:19]
    s_add_u32 s74, s69, 8192
    buffer_load_dwordx4 v[68:71], v0, s[4:7], s74 offen offset:0 sc1
    s_waitcnt vmcnt(14)
    v_mfma_f32_16x16x32_bf16 v[12:15], a[80:83], v[72:75], v[12:15]
    v_mfma_f32_16x16x32_bf16 v[16:19], a[84:87], v[72:75], v[16:19]
    buffer_load_dwordx4 v[72:75], v0, s[4:7], s74 offen offset:1024 sc1
    s_waitcnt vmcnt(14)
    v_mfma_f32_16x16x32_bf16 v[12:15], a[88:91], v[76:79], v[12:15]
    v_mfma_f32_16x16x32_bf16 v[16:19], a[92:95], v[76:79], v[16:19]
    buffer_load_dwordx4 v[76:79], v0, s[4:7], s74 offen offset:2048 sc1
    s_waitcnt vmcnt(14)
    v_mfma_f32_16x16x32_bf16 v[12:15], a[96:99], v[80:83], v[12:15]
    v_mfma_f32_16x16x32_bf16 v[16:19], a[100:103], v[80:83], v[16:19]
    buffer_load_dwordx4 v[80:83], v0, s[4:7], s74 offen offset:3072 sc1
    s_waitcnt vmcnt(14)
    v_mfma_f32_16x16x32_bf16 v[12:15], a[104:107], v[84:87], v[12:15]
    v_mfma_f32_16x16x32_bf16 v[16:19], a[108:111], v[84:87], v[16:19]
    s_add_u32 s74, s69, 12288
    buffer_load_dwordx4 v[84:87], v0, s[4:7], s74 offen offset:0 sc1
    s_waitcnt vmcnt(14)
    v_mfma_f32_16x16x32_bf16 v[12:15], a[112:115], v[88:91], v[12:15]
    v_mfma_f32_16x16x32_bf16 v[16:19], a[116:119], v[88:91], v[16:19]
    buffer_load_dwordx4 v[88:91], v0, s[4:7], s74 offen offset:1024 sc1
    s_waitcnt vmcnt(14)
    v_mfma_f32_16x16x32_bf16 v[12:15], a[120:123], v[32:35], v[12:15]
    v_mfma_f32_16x16x32_bf16 v[16:19], a[124:127], v[32:35], v[16:19]
    buffer_load_dwordx4 v[32:35], v0, s[4:7], s74 offen offset:2048 sc1
    s_waitcnt vmcnt(14)
    v_mfma_f32_16x16x32_bf16 v[12:15], a[128:131], v[36:39], v[12:15]
    v_mfma_f32_16x16x32_bf16 v[16:19], a[132:135], v[36:39], v[16:19]
    buffer_load_dwordx4 v[36:39], v0, s[4:7], s74 offen offset:3072 sc1
    s_waitcnt vmcnt(14)
    v_mfma_f32_16x16x32_bf16 v[12:15], a[136:139], v[40:43], v[12:15]
    v_mfma_f32_16x16x32_bf16 v[16:19], a[140:143], v[40:43], v[16:19]
    s_waitcnt vmcnt(13)
    v_mfma_f32_16x16x32_bf16 v[12:15], a[144:147], v[44:47], v[12:15]
    v_mfma_f32_16x16x32_bf16 v[16:19], a[148:151], v[44:47], v[16:19]
    s_waitcnt vmcnt(12)
    v_mfma_f32_16x16x32_bf16 v[12:15], a[152:155], v[48:51], v[12:15]
    v_mfma_f32_16x16x32_bf16 v[16:19], a[156:159], v[48:51], v[16:19]
    s_waitcnt vmcnt(11)
    v_mfma_f32_16x16x32_bf16 v[12:15], a[160:163], v[52:55], v[12:15]
    v_mfma_f32_16x16x32_bf16 v[16:19], a[164:167], v[52:55], v[16:19]
    s_waitcnt vmcnt(10)
    v_mfma_f32_16x16x32_bf16 v[12:15], a[168:171], v[56:59], v[12:15]
    v_mfma_f32_16x16x32_bf16 v[16:19], a[172:175], v[56:59], v[16:19]
    s_waitcnt vmcnt(9)
    v_mfma_f32_16x16x32_bf16 v[12:15], a[176:179], v[60:63], v[12:15]
    v_mfma_f32_16x16x32_bf16 v[16:19], a[180:183], v[60:63], v[16:19]
    s_waitcnt vmcnt(8)
    v_mfma_f32_16x16x32_bf16 v[12:15], a[184:187], v[64:67], v[12:15]
    v_mfma_f32_16x16x32_bf16 v[16:19], a[188:191], v[64:67], v[16:19]
    s_waitcnt vmcnt(7)
    v_mfma_f32_16x16x32_bf16 v[12:15], a[192:195], v[68:71], v[12:15]
    v_mfma_f32_16x16x32_bf16 v[16:19], a[196:199], v[68:71], v[16:19]
    s_waitcnt vmcnt(6)
    v_mfma_f32_16x16x32_bf16 v[12:15], a[200:203], v[72:75], v[12:15]
    v_mfma_f32_16x16x32_bf16 v[16:19], a[204:207], v[72:75], v[16:19]
    s_waitcnt vmcnt(5)
    v_mfma_f32_16x16x32_bf16 v[12:15], a[208:211], v[76:79], v[12:15]
    v_mfma_f32_16x16x32_bf16 v[16:19], a[212:215], v[76:79], v[16:19]
    s_waitcnt vmcnt(4)
    v_mfma_f32_16x16x32_bf16 v[12:15], a[216:219], v[80:83], v[12:15]
    v_mfma_f32_16x16x32_bf16 v[16:19], a[220:223], v[80:83], v[16:19]
    s_waitcnt vmcnt(3)
    v_mfma_f32_16x16x32_bf16 v[12:15], a[224:227], v[84:87], v[12:15]
    v_mfma_f32_16x16x32_bf16 v[16:19], a[228:231], v[84:87], v[16:19]
    s_waitcnt vmcnt(2)
    v_mfma_f32_16x16x32_bf16 v[12:15], a[232:235], v[88:91], v[12:15]
    v_mfma_f32_16x16x32_bf16 v[16:19], a[236:239], v[88:91], v[16:19]
    s_waitcnt vmcnt(1)
    v_mfma_f32_16x16x32_bf16 v[12:15], a[240:243], v[32:35], v[12:15]
    v_mfma_f32_16x16x32_bf16 v[16:19], a[244:247], v[32:35], v[16:19]
    s_waitcnt vmcnt(0)
    v_mfma_f32_16x16x32_bf16 v[12:15], a[248:251], v[36:39], v[12:15]
    v_mfma_f32_16x16x32_bf16 v[16:19], a[252:255], v[36:39], v[16:19]
L_o_fin:
    s_add_u32 s63, s63, s82
    s_add_u32 s69, s69, s82
    s_nop 4
    ds_write_b128 v3, v[12:15] offset:0
    ds_write_b128 v3, v[16:19] offset:1024
    ds_write_b128 v3, v[20:23] offset:2048
    ds_write_b128 v3, v[24:27] offset:3072
    ds_write_b128 v3, v[28:31] offset:4096
    s_mov_b32 s79, 0
    s_cmp_ge_u32 s62, s81
    s_cbranch_scc1 L_o_nrdy
    s_waitcnt vmcnt(15)
    v_cmp_ge_u32 vcc, s76, v7
    s_cbranch_vccnz L_o_nrdy
    s_mov_b32 s79, 1
    v_mov_b32 v7, s62
    ds_write_b32 v11, v7
    s_add_u32 s74, s63, 0
    buffer_load_dwordx4 v[32:35], v0, s[4:7], s74 offen offset:0 sc1
    buffer_load_dwordx4 v[36:39], v0, s[4:7], s74 offen offset:1024 sc1
    buffer_load_dwordx4 v[40:43], v0, s[4:7], s74 offen offset:2048 sc1
    buffer_load_dwordx4 v[44:47], v0, s[4:7], s74 offen offset:3072 sc1
    s_add_u32 s74, s63, 4096
    buffer_load_dwordx4 v[48:51], v0, s[4:7], s74 offen offset:0 sc1
    buffer_load_dwordx4 v[52:55], v0, s[4:7], s74 offen offset:1024 sc1
    buffer_load_dwordx4 v[56:59], v0, s[4:7], s74 offen offset:2048 sc1
    buffer_load_dwordx4 v[60:63], v0, s[4:7], s74 offen offset:3072 sc1
    s_add_u32 s74, s63, 8192
    buffer_load_dwordx4 v[64:67], v0, s[4:7], s74 offen offset:0 sc1
    buffer_load_dwordx4 v[68:71], v0, s[4:7], s74 offen offset:1024 sc1
    buffer_load_dwordx4 v[72:75], v0, s[4:7], s74 offen offset:2048 sc1
    buffer_load_dwordx4 v[76:79], v0, s[4:7], s74 offen offset:3072 sc1
    s_add_u32 s74, s63, 12288
    buffer_load_dwordx4 v[80:83], v0, s[4:7], s74 offen offset:0 sc1
    buffer_load_dwordx4 v[84:87], v0, s[4:7], s74 offen offset:1024 sc1
    buffer_load_dwordx4 v[88:91], v0, s[4:7], s74 offen offset:2048 sc1
L_o_nrdy:
    s_waitcnt lgkmcnt(0)
    s_barrier
    ds_read_b64 v[12:13], v4 offset:0
    ds_read_b64 v[20:21], v4 offset:2048
    ds_read_b32 v28, v5 offset:4096
    ds_read_b64 v[14:15], v4 offset:5120
    ds_read_b64 v[22:23], v4 offset:7168
    ds_read_b32 v29, v5 offset:9216
    ds_read_b64 v[16:17], v4 offset:10240
    ds_read_b64 v[24:25], v4 offset:12288
    ds_read_b32 v30, v5 offset:14336
    ds_read_b64 v[18:19], v4 offset:15360
    ds_read_b64 v[26:27], v4 offset:17408
    ds_read_b32 v31, v5 offset:19456
    v_xor_b32 v3, 0x8000, v3
    v_xor_b32 v4, 0x8000, v4
    v_xor_b32 v5, 0x8000, v5
    s_waitcnt lgkmcnt(0)
    v_add_f32 v28, v28, v29
    v_add_f32 v30, v30, v31
    v_add_f32 v28, v28, v30
    v_mul_f32 v28, s70, v28
    v_exp_f32 v28, v28
    v_add_f32 v12, v12, v14
    v_add_f32 v16, v16, v18
    v_add_f32 v12, v12, v16
    v_add_f32 v13, v13, v15
    v_add_f32 v17, v17, v19
    v_add_f32 v13, v13, v17
    v_add_f32 v20, v20, v22
    v_add_f32 v24, v24, v26
    v_add_f32 v20, v20, v24
    v_add_f32 v21, v21, v23
    v_add_f32 v25, v25, v27
    v_add_f32 v21, v21, v25
    v_add_f32 v28, 1.0, v28
    v_rcp_f32 v28, v28
    s_nop 0
    v_sub_f32 v29, 1.0, v28
    v_mul_f32 v20, v20, v29
    v_mul_f32 v21, v21, v29
    v_fma_f32 v12, v12, v28, v20
    v_fma_f32 v13, v13, v28, v21
    v_cvt_pk_bf16_f32 v8, v12, v13
    buffer_store_dword v8, v6, s[52:55], s66 offen
    s_cmp_lt_u32 s62, s81
    s_cbranch_scc1 L_o_task
    s_branch L_end
.section .rodata,"a"
.p2align 6
.amdhsa_kernel gated_mix__memory_aug_recurrent_mem_tr__swiglu_ffn__prompt_kernel
  .amdhsa_next_free_vgpr 512
  .amdhsa_next_free_sgpr 102
  .amdhsa_accum_offset 256
  .amdhsa_group_segment_fixed_size 0
  .amdhsa_kernarg_size 120
  .amdhsa_user_sgpr_count 2
  .amdhsa_user_sgpr_kernarg_segment_ptr 1
  .amdhsa_system_sgpr_workgroup_id_x 1
  .amdhsa_float_denorm_mode_32 3
.end_amdhsa_kernel
```
